```python
import torch

def _softmax(x, axis=-1):
    return torch.softmax(x, dim=axis)
def _gelu(x):
    return torch.nn.functional.gelu(x, approximate="tanh")
def _silu(x):
    return torch.nn.functional.silu(x)
def _sigmoid(x):
    return torch.sigmoid(x)
def _layernorm(x, axis=-1, eps=1e-5):
    m = x.mean(dim=axis, keepdim=True)
    v = x.var(dim=axis, keepdim=True, unbiased=False)
    return (x - m) / torch.sqrt(v + eps)
def _scatter_add(tgt, idx, src, axis=0):
    return tgt.clone().index_add_(axis, idx, src)
def _segment_sum(src, seg, n):
    out = torch.zeros((n,) + src.shape[1:], dtype=src.dtype)
    return out.index_add_(0, seg, src)
def _pad(x, pw):
    flat = tuple(v for pair in reversed(pw) for v in pair)
    return torch.nn.functional.pad(x, flat)

kernel_name = 'interleave_layers__sliding_block__mixer_channel_mlp__prompt'

def setup_inputs():

    _w = (lambda a: (lambda t: t.to(torch.bfloat16) if t.is_floating_point() else t)(torch.as_tensor(a)))
    def _A_setup():
        B, S, D = 1, 2048, 576
        return {
            "x": _w((lambda *s: torch.randn(*s, dtype=torch.bfloat16) * 0.05)(B, S, D)),
            "wqkv": _w((lambda *s: torch.randn(*s, dtype=torch.bfloat16) * 0.05)(D, 3 * D)),
            "wo": _w((lambda *s: torch.randn(*s, dtype=torch.bfloat16) * 0.05)(D, D)),
        }
    _A_in = _A_setup()

    def _B_setup():
        B, S, D, F = 1, 2048, 576, 4608
        return {
            "x": _w((lambda *s: torch.randn(*s, dtype=torch.bfloat16) * 0.05)(B, S, D)),
            "w1": _w((lambda *s: torch.randn(*s, dtype=torch.bfloat16) * 3.2)(D, F) * (D ** -0.5)),
            "b1": _w((lambda *s: torch.randn(*s, dtype=torch.bfloat16) * 3.2)(F)),
            "w2": _w((lambda *s: torch.randn(*s, dtype=torch.bfloat16) * 0.4)(F, D) * (F ** -0.5)),
            "b2": _w((lambda *s: torch.randn(*s, dtype=torch.bfloat16) * 0.4)(D)),
        }
    _B_in = _B_setup()

    return {
        "A_x": _A_in["x"],
        "A_wqkv": _A_in["wqkv"],
        "A_wo": _A_in["wo"],
        "B_x": _B_in["x"],
        "B_w1": _B_in["w1"],
        "B_b1": _B_in["b1"],
        "B_w2": _B_in["w2"],
        "B_b2": _B_in["b2"],
    }

def reference(A_x, A_wqkv, A_wo, B_x, B_w1, B_b1, B_w2, B_b2):
    def _A_ref(x, wqkv, wo):
        B, S, D = x.shape
        H = 32; Dh = D // H; W = 256
        qkv = (lambda x, *d: x.permute(*d))((x @ wqkv).reshape(B, S, 3, H, Dh), 2, 0, 3, 1, 4)
        q, k, v = qkv[0], qkv[1], qkv[2]
        scores = torch.einsum("bhqd,bhkd->bhqk", q, k) * (Dh ** -0.5)
        idx = torch.arange(S)
        mask = (idx[:, None] - idx[None, :] >= 0) & (idx[:, None] - idx[None, :] < W)
        scores = torch.where(mask[None, None], scores, -1e9)
        p = _softmax(scores, axis=-1)
        o = torch.einsum("bhqk,bhkd->bhqd", p, v)
        return (lambda x, *d: x.permute(*d))(o, 0, 2, 1, 3).reshape(B, S, D) @ wo

    def _B_ref(x, w1, b1, w2, b2):
        y = _layernorm(x, axis=-1)
        h = _gelu(torch.einsum("bsd,df->bsf", y, w1) + b1)
        return torch.einsum("bsf,fd->bsd", h, w2) + b2

    x = A_x
    x = x + _A_ref(_layernorm(x, axis=-1), A_wqkv, A_wo)
    x = x + _B_ref(_layernorm(x, axis=-1), B_w1, B_b1, B_w2, B_b2)
    x = x + _A_ref(_layernorm(x, axis=-1), A_wqkv, A_wo)
    x = x + _B_ref(_layernorm(x, axis=-1), B_w1, B_b1, B_w2, B_b2)
    return x
```

```asm
; @launch grid=(256,1,1) block=(256,1,1) lds=163840
.amdgcn_target "amdgcn-amd-amdhsa--gfx950"
.text
.globl interleave_layers__sliding_block__mixer_channel_mlp__prompt_kernel
.p2align 8
.type interleave_layers__sliding_block__mixer_channel_mlp__prompt_kernel,@function
interleave_layers__sliding_block__mixer_channel_mlp__prompt_kernel:
  s_cmp_ge_u32 s2, 256
  s_cbranch_scc1 Lend
  s_load_dwordx16 s[76:91], s[0:1], 0
  s_load_dwordx4 s[92:95], s[0:1], 64
  s_load_dwordx2 s[96:97], s[0:1], 80
  v_and_b32 v56, 63, v0
  v_lshrrev_b32 v57, 6, v0
  v_lshlrev_b32 v1, 4, v56
  v_readfirstlane_b32 s46, v57
  v_and_b32 v2, 31, v56
  v_lshrrev_b32 v3, 5, v56
  s_getpc_b64 s[70:71]
Lpc:
  s_lshr_b32 s54, s2, 3
  s_lshl_b32 s54, s54, 2
  s_add_u32 s54, s54, s46
  s_mul_i32 s54, s54, 640
  v_lshl_add_u32 v58, v56, 6, s54
  v_min_u32 v58, Lend-Lpc, v58
  v_mov_b32 v59, s71
  v_add_co_u32 v58, vcc, s70, v58
  s_nop 1
  v_addc_co_u32 v59, vcc, 0, v59, vcc
  s_mov_b32 exec_lo, 0x3ff
  s_mov_b32 exec_hi, 0
  global_load_dword v250, v[58:59], off
  s_mov_b64 exec, -1
  s_and_b32 s54, s2, 7
  s_lshr_b32 s55, s2, 3
  s_and_b32 s56, s54, 3
  s_lshl_b32 s56, s56, 1
  s_and_b32 s57, s55, 1
  s_add_u32 s45, s56, s57
  s_lshr_b32 s56, s54, 2
  s_lshl_b32 s56, s56, 4
  s_lshr_b32 s57, s55, 1
  s_add_u32 s44, s56, s57
  s_lshr_b32 s47, s46, 1
  s_and_b32 s48, s46, 1
  s_mov_b32 s49, 0
  s_mov_b32 s50, 1048576
  s_mov_b32 s51, 0x40000
  s_mov_b32 s52, 0x3f803f80
  s_mov_b32 s98, 0xffffff
  s_mov_b32 s99, 0xffffff
  s_waitcnt lgkmcnt(0)
  s_mov_b32 s4, s76
  s_mov_b32 s5, s77
  s_mov_b32 s6, 2359296
  s_mov_b32 s7, 0x20000
  s_mov_b32 s8, s78
  s_mov_b32 s9, s79
  s_mov_b32 s10, 1990656
  s_mov_b32 s11, 0x20000
  s_mov_b32 s12, s80
  s_mov_b32 s13, s81
  s_mov_b32 s14, 663552
  s_mov_b32 s15, 0x20000
  s_mov_b32 s16, s84
  s_mov_b32 s17, s85
  s_mov_b32 s18, 5308416
  s_mov_b32 s19, 0x20000
  s_mov_b32 s20, s88
  s_mov_b32 s21, s89
  s_mov_b32 s22, 5308416
  s_mov_b32 s23, 0x20000
  s_mov_b32 s24, s86
  s_mov_b32 s25, s87
  s_mov_b32 s26, 9216
  s_mov_b32 s27, 0x20000
  s_mov_b32 s28, s90
  s_mov_b32 s29, s91
  s_mov_b32 s30, 1152
  s_mov_b32 s31, 0x20000
  s_mov_b32 s32, s96
  s_mov_b32 s33, s97
  s_mov_b32 s34, 268435456
  s_mov_b32 s35, 0x20000
  s_mov_b32 s40, s94
  s_mov_b32 s41, s95
  s_mov_b32 s42, 256
  s_mov_b32 s43, 0x20000
  s_add_u32 s36, s96, 12582912
  s_addc_u32 s37, s97, 0
  s_mov_b32 s38, 2359296
  s_mov_b32 s39, 0x20000
  v_lshlrev_b32 v19, 7, v56
  v_lshlrev_b32 v20, 10, v56
  v_lshlrev_b32 v57, 15, v56
  v_mov_b32 v60, 0
  v_mov_b32 v61, 0
  v_mov_b32 v62, 0
  v_mov_b32 v63, 0
  s_lshl_b32 s54, s44, 3
  s_add_u32 s54, s54, s45
  s_lshl_b32 s54, s54, 7
  s_mov_b32 exec_lo, 4095
  s_mov_b32 exec_hi, 0
  buffer_store_dwordx4 v[60:63], v57, s[32:35], s54 offen sc1
  s_mov_b64 exec, -1
  v_lshrrev_b32 v57, 2, v56
  v_and_b32 v58, 3, v56
  v_mul_u32_u24 v8, 1152, v57
  v_lshl_add_u32 v8, v58, 4, v8
  s_lshl_b32 s54, s48, 4
  s_mul_i32 s55, s47, 36864
  s_add_u32 s55, s55, 86016
  v_lshl_add_u32 v59, v58, 1, v57
  v_add_u32 v59, s54, v59
  v_and_b32 v59, 31, v59
  v_lshlrev_b32 v59, 4, v59
  v_lshl_add_u32 v59, v58, 9, v59
  v_add_u32 v6, s55, v59
  s_lshl_b32 s54, s44, 2
  s_add_u32 s54, s54, s46
  s_mul_i32 s54, s54, 18432
  buffer_load_dwordx4 v[112:115], v8, s[4:7], s54 offen offset:0 sc1
  buffer_load_dwordx4 v[116:119], v8, s[4:7], s54 offen offset:64 sc1
  buffer_load_dwordx4 v[120:123], v8, s[4:7], s54 offen offset:128 sc1
  buffer_load_dwordx4 v[124:127], v8, s[4:7], s54 offen offset:192 sc1
  buffer_load_dwordx4 v[128:131], v8, s[4:7], s54 offen offset:256 sc1
  buffer_load_dwordx4 v[132:135], v8, s[4:7], s54 offen offset:320 sc1
  buffer_load_dwordx4 v[136:139], v8, s[4:7], s54 offen offset:384 sc1
  buffer_load_dwordx4 v[140:143], v8, s[4:7], s54 offen offset:448 sc1
  buffer_load_dwordx4 v[144:147], v8, s[4:7], s54 offen offset:512 sc1
  buffer_load_dwordx4 v[148:151], v8, s[4:7], s54 offen offset:576 sc1
  buffer_load_dwordx4 v[152:155], v8, s[4:7], s54 offen offset:640 sc1
  buffer_load_dwordx4 v[156:159], v8, s[4:7], s54 offen offset:704 sc1
  buffer_load_dwordx4 v[160:163], v8, s[4:7], s54 offen offset:768 sc1
  buffer_load_dwordx4 v[164:167], v8, s[4:7], s54 offen offset:832 sc1
  buffer_load_dwordx4 v[168:171], v8, s[4:7], s54 offen offset:896 sc1
  buffer_load_dwordx4 v[172:175], v8, s[4:7], s54 offen offset:960 sc1
  buffer_load_dwordx4 v[176:179], v8, s[4:7], s54 offen offset:1024 sc1
  buffer_load_dwordx4 v[180:183], v8, s[4:7], s54 offen offset:1088 sc1
  v_add_u32 v57, 0, v56
  v_mul_u32_u24 v58, 2341, v57
  v_lshrrev_b32 v58, 16, v58
  v_mul_u32_u24 v59, 28, v58
  v_sub_u32 v59, v57, v59
  v_lshlrev_b32 v60, 4, v59
  v_mov_b32 v61, 0
  v_cmp_le_u32 vcc, 9, v59
  s_nop 1
  v_cndmask_b32 v61, v61, -16, vcc
  v_mov_b32 v57, 992
  v_cmp_le_u32 vcc, 10, v59
  s_nop 1
  v_cndmask_b32 v61, v61, v57, vcc
  v_mov_b32 v57, 2000
  v_cmp_le_u32 vcc, 19, v59
  s_nop 1
  v_cndmask_b32 v61, v61, v57, vcc
  v_add_u32 v60, v60, v61
  v_mul_u32_u24 v58, 3456, v58
  v_add_u32 v60, v60, v58
  v_subrev_u32 v24, 0, v60
  v_add_u32 v57, 64, v56
  v_mul_u32_u24 v58, 2341, v57
  v_lshrrev_b32 v58, 16, v58
  v_mul_u32_u24 v59, 28, v58
  v_sub_u32 v59, v57, v59
  v_lshlrev_b32 v60, 4, v59
  v_mov_b32 v61, 0
  v_cmp_le_u32 vcc, 9, v59
  s_nop 1
  v_cndmask_b32 v61, v61, -16, vcc
  v_mov_b32 v57, 992
  v_cmp_le_u32 vcc, 10, v59
  s_nop 1
  v_cndmask_b32 v61, v61, v57, vcc
  v_mov_b32 v57, 2000
  v_cmp_le_u32 vcc, 19, v59
  s_nop 1
  v_cndmask_b32 v61, v61, v57, vcc
  v_add_u32 v60, v60, v61
  v_mul_u32_u24 v58, 3456, v58
  v_add_u32 v60, v60, v58
  v_subrev_u32 v25, 1024, v60
  v_add_u32 v57, 128, v56
  v_mul_u32_u24 v58, 2341, v57
  v_lshrrev_b32 v58, 16, v58
  v_mul_u32_u24 v59, 28, v58
  v_sub_u32 v59, v57, v59
  v_lshlrev_b32 v60, 4, v59
  v_mov_b32 v61, 0
  v_cmp_le_u32 vcc, 9, v59
  s_nop 1
  v_cndmask_b32 v61, v61, -16, vcc
  v_mov_b32 v57, 992
  v_cmp_le_u32 vcc, 10, v59
  s_nop 1
  v_cndmask_b32 v61, v61, v57, vcc
  v_mov_b32 v57, 2000
  v_cmp_le_u32 vcc, 19, v59
  s_nop 1
  v_cndmask_b32 v61, v61, v57, vcc
  v_add_u32 v60, v60, v61
  v_mul_u32_u24 v58, 3456, v58
  v_add_u32 v60, v60, v58
  v_subrev_u32 v26, 2048, v60
  v_add_u32 v57, 192, v56
  v_mul_u32_u24 v58, 2341, v57
  v_lshrrev_b32 v58, 16, v58
  v_mul_u32_u24 v59, 28, v58
  v_sub_u32 v59, v57, v59
  v_lshlrev_b32 v60, 4, v59
  v_mov_b32 v61, 0
  v_cmp_le_u32 vcc, 9, v59
  s_nop 1
  v_cndmask_b32 v61, v61, -16, vcc
  v_mov_b32 v57, 992
  v_cmp_le_u32 vcc, 10, v59
  s_nop 1
  v_cndmask_b32 v61, v61, v57, vcc
  v_mov_b32 v57, 2000
  v_cmp_le_u32 vcc, 19, v59
  s_nop 1
  v_cndmask_b32 v61, v61, v57, vcc
  v_add_u32 v60, v60, v61
  v_mul_u32_u24 v58, 3456, v58
  v_add_u32 v60, v60, v58
  v_subrev_u32 v27, 3072, v60
  v_add_u32 v57, 256, v56
  v_mul_u32_u24 v58, 2341, v57
  v_lshrrev_b32 v58, 16, v58
  v_mul_u32_u24 v59, 28, v58
  v_sub_u32 v59, v57, v59
  v_lshlrev_b32 v60, 4, v59
  v_mov_b32 v61, 0
  v_cmp_le_u32 vcc, 9, v59
  s_nop 1
  v_cndmask_b32 v61, v61, -16, vcc
  v_mov_b32 v57, 992
  v_cmp_le_u32 vcc, 10, v59
  s_nop 1
  v_cndmask_b32 v61, v61, v57, vcc
  v_mov_b32 v57, 2000
  v_cmp_le_u32 vcc, 19, v59
  s_nop 1
  v_cndmask_b32 v61, v61, v57, vcc
  v_add_u32 v60, v60, v61
  v_mul_u32_u24 v58, 3456, v58
  v_add_u32 v60, v60, v58
  v_subrev_u32 v28, 0, v60
  v_add_u32 v57, 320, v56
  v_mul_u32_u24 v58, 2341, v57
  v_lshrrev_b32 v58, 16, v58
  v_mul_u32_u24 v59, 28, v58
  v_sub_u32 v59, v57, v59
  v_lshlrev_b32 v60, 4, v59
  v_mov_b32 v61, 0
  v_cmp_le_u32 vcc, 9, v59
  s_nop 1
  v_cndmask_b32 v61, v61, -16, vcc
  v_mov_b32 v57, 992
  v_cmp_le_u32 vcc, 10, v59
  s_nop 1
  v_cndmask_b32 v61, v61, v57, vcc
  v_mov_b32 v57, 2000
  v_cmp_le_u32 vcc, 19, v59
  s_nop 1
  v_cndmask_b32 v61, v61, v57, vcc
  v_add_u32 v60, v60, v61
  v_mul_u32_u24 v58, 3456, v58
  v_add_u32 v60, v60, v58
  v_subrev_u32 v29, 1024, v60
  v_add_u32 v57, 384, v56
  v_mul_u32_u24 v58, 2341, v57
  v_lshrrev_b32 v58, 16, v58
  v_mul_u32_u24 v59, 28, v58
  v_sub_u32 v59, v57, v59
  v_lshlrev_b32 v60, 4, v59
  v_mov_b32 v61, 0
  v_cmp_le_u32 vcc, 9, v59
  s_nop 1
  v_cndmask_b32 v61, v61, -16, vcc
  v_mov_b32 v57, 992
  v_cmp_le_u32 vcc, 10, v59
  s_nop 1
  v_cndmask_b32 v61, v61, v57, vcc
  v_mov_b32 v57, 2000
  v_cmp_le_u32 vcc, 19, v59
  s_nop 1
  v_cndmask_b32 v61, v61, v57, vcc
  v_add_u32 v60, v60, v61
  v_mul_u32_u24 v58, 3456, v58
  v_add_u32 v60, v60, v58
  v_subrev_u32 v30, 2048, v60
  s_mul_i32 s64, s46, 55296
  s_mul_i32 s65, s45, 144
  s_add_u32 s64, s64, s65
  s_mul_i32 s65, s46, 7168
  s_add_u32 m0, s65, 0
  s_nop 0
  buffer_load_dwordx4 v24, s[8:11], s64 offen offset:0 lds
  buffer_load_dwordx4 v25, s[8:11], s64 offen offset:1024 lds
  buffer_load_dwordx4 v26, s[8:11], s64 offen offset:2048 lds
  buffer_load_dwordx4 v27, s[8:11], s64 offen offset:3072 lds
  s_add_u32 m0, s65, 4096
  s_nop 0
  buffer_load_dwordx4 v28, s[8:11], s64 offen offset:0 lds
  buffer_load_dwordx4 v29, s[8:11], s64 offen offset:1024 lds
  buffer_load_dwordx4 v30, s[8:11], s64 offen offset:2048 lds
  s_add_u32 s64, s64, 221184
  s_add_u32 m0, s65, 28672
  s_nop 0
  buffer_load_dwordx4 v24, s[8:11], s64 offen offset:0 lds
  buffer_load_dwordx4 v25, s[8:11], s64 offen offset:1024 lds
  buffer_load_dwordx4 v26, s[8:11], s64 offen offset:2048 lds
  buffer_load_dwordx4 v27, s[8:11], s64 offen offset:3072 lds
  s_add_u32 m0, s65, 32768
  s_nop 0
  buffer_load_dwordx4 v28, s[8:11], s64 offen offset:0 lds
  buffer_load_dwordx4 v29, s[8:11], s64 offen offset:1024 lds
  buffer_load_dwordx4 v30, s[8:11], s64 offen offset:2048 lds
  s_add_u32 s64, s64, 221184
  s_add_u32 m0, s65, 57344
  s_nop 0
  buffer_load_dwordx4 v24, s[8:11], s64 offen offset:0 lds
  buffer_load_dwordx4 v25, s[8:11], s64 offen offset:1024 lds
  buffer_load_dwordx4 v26, s[8:11], s64 offen offset:2048 lds
  buffer_load_dwordx4 v27, s[8:11], s64 offen offset:3072 lds
  s_add_u32 m0, s65, 61440
  s_nop 0
  buffer_load_dwordx4 v28, s[8:11], s64 offen offset:0 lds
  buffer_load_dwordx4 v29, s[8:11], s64 offen offset:1024 lds
  buffer_load_dwordx4 v30, s[8:11], s64 offen offset:2048 lds
  v_mul_u32_u24 v57, 7282, v56
  v_lshrrev_b32 v57, 16, v57
  v_mul_u32_u24 v58, 9, v57
  v_sub_u32 v58, v56, v58
  v_mul_u32_u24 v59, 21846, v58
  v_lshrrev_b32 v59, 16, v59
  v_mul_u32_u24 v60, 960, v59
  v_lshl_add_u32 v60, v58, 6, v60
  v_mul_u32_u24 v57, 3456, v57
  v_add_u32 v60, v60, v57
  s_and_b32 s54, s44, 15
  s_lshl_b32 s54, s54, 2
  s_add_u32 s54, s54, s46
  s_mul_i32 s54, s54, 20736
  s_mul_i32 s55, s45, 144
  s_add_u32 s54, s54, s55
  s_add_u32 s54, s54, 663564
  s_mov_b32 exec_lo, 0xffffffff
  s_mov_b32 exec_hi, 0x3fffff
  buffer_load_dword v250, v60, s[8:11], s54 offen
  s_mov_b64 exec, -1
  v_mul_u32_u24 v57, 21846, v56
  v_lshrrev_b32 v57, 16, v57
  v_mul_u32_u24 v57, 960, v57
  v_lshl_add_u32 v57, v56, 6, v57
  s_mul_i32 s54, s44, 20736
  s_mul_i32 s55, s45, 144
  s_add_u32 s54, s54, s55
  s_cmp_lg_u32 s46, 3
  s_cbranch_scc1 Lnwo
  s_mov_b32 exec_lo, -1
  s_mov_b32 exec_hi, 4194303
  buffer_load_dword v250, v57, s[12:15], s54 offen offset:12
  s_mov_b64 exec, -1
Lnwo:
  s_and_b32 s54, s44, 31
  s_mul_i32 s56, s54, 165888
  s_mul_i32 s57, s45, 1152
  s_add_u32 s56, s56, s57
  s_mul_i32 s57, s57, 576
  s_mul_i32 s54, s54, 20736
  s_add_u32 s57, s57, s54
  v_add_u32 v60, 0, v0
  v_min_u32 v60, 161, v60
  v_mul_u32_u24 v57, 7282, v60
  v_lshrrev_b32 v57, 16, v57
  v_mul_u32_u24 v57, 8064, v57
  v_mul_u32_u24 v60, 128, v60
  v_add_u32 v57, v57, v60
  buffer_load_dword v250, v57, s[16:19], s56 offen
  v_and_b32 v57, 15, v56
  v_lshrrev_b32 v58, 4, v56
  v_lshlrev_b32 v9, 10, v58
  v_lshl_add_u32 v9, v57, 4, v9
  s_lshl_b32 s54, s48, 4
  s_mul_i32 s55, s47, 36864
  s_add_u32 s55, s55, 86016
  v_lshl_add_u32 v59, v58, 1, v57
  v_add_u32 v59, s54, v59
  v_and_b32 v59, 31, v59
  v_lshlrev_b32 v59, 4, v59
  v_lshl_add_u32 v59, v58, 9, v59
  v_add_u32 v7, s55, v59
  v_add_u32 v59, 0, v3
  v_lshl_add_u32 v59, v59, 1, v2
  v_and_b32 v59, 31, v59
  v_lshlrev_b32 v59, 4, v59
  v_lshl_add_u32 v59, v3, 9, v59
  v_add_u32 v4, s55, v59
  v_add_u32 v59, 2, v3
  v_lshl_add_u32 v59, v59, 1, v2
  v_and_b32 v59, 31, v59
  v_lshlrev_b32 v59, 4, v59
  v_lshl_add_u32 v59, v3, 9, v59
  v_add_u32 v5, s55, v59
  v_lshrrev_b32 v57, 3, v56
  v_and_b32 v58, 7, v56
  v_bfe_u32 v59, v57, 1, 1
  v_lshlrev_b32 v59, 2, v59
  v_xor_b32 v58, v58, v59
  v_lshlrev_b32 v58, 4, v58
  v_mul_u32_u24 v59, 9216, v57
  v_add_u32 v10, v59, v58
  v_add_u32 v11, 72704, v10
  v_add_u32 v12, 145408, v10
  v_mul_u32_u24 v59, 1152, v57
  v_add_u32 v13, v59, v58
  v_add_u32 v14, 8192, v13
  v_add_u32 v15, 16384, v13
  v_bfe_u32 v57, v56, 2, 2
  v_bfe_u32 v58, v56, 4, 1
  v_and_b32 v59, 1, v56
  v_lshlrev_b32 v59, 4, v59
  v_bfe_u32 v60, v56, 1, 1
  v_lshl_add_u32 v59, v60, 3, v59
  v_lshl_add_u32 v60, v3, 3, v57
  v_lshrrev_b32 v61, 1, v57
  v_xor_b32 v61, s48, v61
  v_lshlrev_b32 v61, 6, v61
  v_lshl_add_u32 v61, v60, 7, v61
  v_lshl_add_u32 v61, v58, 5, v61
  v_add_u32 v16, v61, v59
  s_mul_i32 s54, s48, 72
  v_mul_u32_u24 v61, 448, v60
  v_add_u32 v61, s54, v61
  v_mul_u32_u24 v62, 160, v58
  v_add3_u32 v21, v61, v62, v59
  v_and_b32 v62, 3, v56
  v_mov_b32 v63, 192
  v_cmp_eq_u32 vcc, 1, v62
  s_nop 1
  v_cndmask_b32 v63, v63, 32, vcc
  v_mov_b32 v57, 336
  v_cmp_eq_u32 vcc, 0, v62
  s_nop 1
  v_cndmask_b32 v63, v63, v57, vcc
  v_add_u32 v62, 304, v59
  v_cmp_eq_u32 vcc, 1, v58
  s_nop 1
  v_cndmask_b32 v22, v62, v63, vcc
  v_add_u32 v62, 40, v62
  v_cndmask_b32 v23, v62, v63, vcc
  v_add_u32 v22, v22, v61
  v_add_u32 v23, v23, v61
  v_mov_b32 v17, 0xc0135761
  v_mov_b32 v31, 0
  v_lshrrev_b32 v57, 3, v2
  v_and_b32 v58, 7, v2
  v_mul_u32_u24 v57, 73728, v57
  v_lshl_add_u32 v57, v3, 7, v57
  v_lshl_add_u32 v18, v58, 4, v57
  v_accvgpr_write_b32 a144, 0
  v_accvgpr_write_b32 a145, 0
  v_accvgpr_write_b32 a146, 0
  v_accvgpr_write_b32 a147, 0
  v_accvgpr_write_b32 a148, 0
  v_accvgpr_write_b32 a149, 0
  v_accvgpr_write_b32 a150, 0
  v_accvgpr_write_b32 a151, 0
  v_accvgpr_write_b32 a152, 0
  v_accvgpr_write_b32 a153, 0
  v_accvgpr_write_b32 a154, 0
  v_accvgpr_write_b32 a155, 0
  v_accvgpr_write_b32 a156, 0
  v_accvgpr_write_b32 a157, 0
  v_accvgpr_write_b32 a158, 0
  v_accvgpr_write_b32 a159, 0
  v_accvgpr_write_b32 a160, 0
  v_accvgpr_write_b32 a161, 0
  v_accvgpr_write_b32 a162, 0
  v_accvgpr_write_b32 a163, 0
  v_accvgpr_write_b32 a164, 0
  v_accvgpr_write_b32 a165, 0
  v_accvgpr_write_b32 a166, 0
  v_accvgpr_write_b32 a167, 0
  v_mov_b32 v57, 0x3f80
  v_cmp_eq_u32 vcc, 0, v3
  s_nop 1
  v_cndmask_b32 v57, 0, v57, vcc
  v_accvgpr_write_b32 a164, v57
  v_lshlrev_b32 v57, 2, v3
  v_sub_u32 v57, v2, v57
  v_mov_b32 v58, 0x3f80
  v_mov_b32 v59, 0x3f800000
  v_cmp_eq_u32 vcc, 0, v57
  s_nop 1
  v_cndmask_b32 v60, 0, v58, vcc
  v_cmp_eq_u32 vcc, 1, v57
  s_nop 1
  v_cndmask_b32 v60, v60, v59, vcc
  v_accvgpr_write_b32 a168, v60
  v_cmp_eq_u32 vcc, 2, v57
  s_nop 1
  v_cndmask_b32 v60, 0, v58, vcc
  v_cmp_eq_u32 vcc, 3, v57
  s_nop 1
  v_cndmask_b32 v60, v60, v59, vcc
  v_accvgpr_write_b32 a169, v60
  v_cmp_eq_u32 vcc, 8, v57
  s_nop 1
  v_cndmask_b32 v60, 0, v58, vcc
  v_cmp_eq_u32 vcc, 9, v57
  s_nop 1
  v_cndmask_b32 v60, v60, v59, vcc
  v_accvgpr_write_b32 a170, v60
  v_cmp_eq_u32 vcc, 10, v57
  s_nop 1
  v_cndmask_b32 v60, 0, v58, vcc
  v_cmp_eq_u32 vcc, 11, v57
  s_nop 1
  v_cndmask_b32 v60, v60, v59, vcc
  v_accvgpr_write_b32 a171, v60
  v_cmp_eq_u32 vcc, 16, v57
  s_nop 1
  v_cndmask_b32 v60, 0, v58, vcc
  v_cmp_eq_u32 vcc, 17, v57
  s_nop 1
  v_cndmask_b32 v60, v60, v59, vcc
  v_accvgpr_write_b32 a172, v60
  v_cmp_eq_u32 vcc, 18, v57
  s_nop 1
  v_cndmask_b32 v60, 0, v58, vcc
  v_cmp_eq_u32 vcc, 19, v57
  s_nop 1
  v_cndmask_b32 v60, v60, v59, vcc
  v_accvgpr_write_b32 a173, v60
  v_cmp_eq_u32 vcc, 24, v57
  s_nop 1
  v_cndmask_b32 v60, 0, v58, vcc
  v_cmp_eq_u32 vcc, 25, v57
  s_nop 1
  v_cndmask_b32 v60, v60, v59, vcc
  v_accvgpr_write_b32 a174, v60
  v_cmp_eq_u32 vcc, 26, v57
  s_nop 1
  v_cndmask_b32 v60, 0, v58, vcc
  v_cmp_eq_u32 vcc, 27, v57
  s_nop 1
  v_cndmask_b32 v60, v60, v59, vcc
  v_accvgpr_write_b32 a175, v60
  v_and_b32 v57, 0x13, v2
  v_bfe_u32 v58, v2, 2, 1
  v_lshl_add_u32 v57, v58, 3, v57
  v_bfe_u32 v58, v2, 3, 1
  v_lshl_add_u32 v57, v58, 2, v57
  v_lshlrev_b32 v57, 1, v57
  s_mul_i32 s54, s45, 1152
  s_lshl_b32 s55, s48, 6
  s_add_u32 s54, s54, s55
  buffer_load_ushort a144, v57, s[24:27], s54 offen offset:0
  buffer_load_ushort a146, v57, s[24:27], s54 offen offset:128
  buffer_load_ushort a148, v57, s[24:27], s54 offen offset:256
  buffer_load_ushort a150, v57, s[24:27], s54 offen offset:384
  buffer_load_ushort a152, v57, s[24:27], s54 offen offset:512
  buffer_load_ushort a154, v57, s[24:27], s54 offen offset:640
  buffer_load_ushort a156, v57, s[24:27], s54 offen offset:768
  buffer_load_ushort a158, v57, s[24:27], s54 offen offset:896
  buffer_load_ushort a160, v57, s[24:27], s54 offen offset:1024
  s_mov_b32 s100, 1024
  s_waitcnt vmcnt(50)
  s_cmp_lg_u32 s46, 0
  s_cbranch_scc1 Lz
  s_mov_b32 exec_lo, 1
  s_mov_b32 exec_hi, 0
  v_mov_b32 v58, 1
  s_lshl_b32 s55, s44, 2
  v_mov_b32 v59, s55
  buffer_atomic_add v58, v59, s[40:43], 0 offen sc1
  s_mov_b64 exec, -1
Lz:
  v_mov_b32 v56, 0
  v_mov_b32 v57, 0
  v_mov_b32 v58, 0
  v_mov_b32 v59, 0
  s_waitcnt vmcnt(47)
  v_dot2_f32_bf16 v56, v112, s52, v56
  v_dot2_f32_bf16 v58, v112, v112, v58
  v_dot2_f32_bf16 v57, v113, s52, v57
  v_dot2_f32_bf16 v59, v113, v113, v59
  v_dot2_f32_bf16 v56, v114, s52, v56
  v_dot2_f32_bf16 v58, v114, v114, v58
  v_dot2_f32_bf16 v57, v115, s52, v57
  v_dot2_f32_bf16 v59, v115, v115, v59
  v_dot2_f32_bf16 v56, v116, s52, v56
  v_dot2_f32_bf16 v58, v116, v116, v58
  v_dot2_f32_bf16 v57, v117, s52, v57
  v_dot2_f32_bf16 v59, v117, v117, v59
  v_dot2_f32_bf16 v56, v118, s52, v56
  v_dot2_f32_bf16 v58, v118, v118, v58
  v_dot2_f32_bf16 v57, v119, s52, v57
  v_dot2_f32_bf16 v59, v119, v119, v59
  v_dot2_f32_bf16 v56, v120, s52, v56
  v_dot2_f32_bf16 v58, v120, v120, v58
  v_dot2_f32_bf16 v57, v121, s52, v57
  v_dot2_f32_bf16 v59, v121, v121, v59
  v_dot2_f32_bf16 v56, v122, s52, v56
  v_dot2_f32_bf16 v58, v122, v122, v58
  v_dot2_f32_bf16 v57, v123, s52, v57
  v_dot2_f32_bf16 v59, v123, v123, v59
  s_waitcnt vmcnt(44)
  v_dot2_f32_bf16 v56, v124, s52, v56
  v_dot2_f32_bf16 v58, v124, v124, v58
  v_dot2_f32_bf16 v57, v125, s52, v57
  v_dot2_f32_bf16 v59, v125, v125, v59
  v_dot2_f32_bf16 v56, v126, s52, v56
  v_dot2_f32_bf16 v58, v126, v126, v58
  v_dot2_f32_bf16 v57, v127, s52, v57
  v_dot2_f32_bf16 v59, v127, v127, v59
  v_dot2_f32_bf16 v56, v128, s52, v56
  v_dot2_f32_bf16 v58, v128, v128, v58
  v_dot2_f32_bf16 v57, v129, s52, v57
  v_dot2_f32_bf16 v59, v129, v129, v59
  v_dot2_f32_bf16 v56, v130, s52, v56
  v_dot2_f32_bf16 v58, v130, v130, v58
  v_dot2_f32_bf16 v57, v131, s52, v57
  v_dot2_f32_bf16 v59, v131, v131, v59
  v_dot2_f32_bf16 v56, v132, s52, v56
  v_dot2_f32_bf16 v58, v132, v132, v58
  v_dot2_f32_bf16 v57, v133, s52, v57
  v_dot2_f32_bf16 v59, v133, v133, v59
  v_dot2_f32_bf16 v56, v134, s52, v56
  v_dot2_f32_bf16 v58, v134, v134, v58
  v_dot2_f32_bf16 v57, v135, s52, v57
  v_dot2_f32_bf16 v59, v135, v135, v59
  s_waitcnt vmcnt(41)
  v_dot2_f32_bf16 v56, v136, s52, v56
  v_dot2_f32_bf16 v58, v136, v136, v58
  v_dot2_f32_bf16 v57, v137, s52, v57
  v_dot2_f32_bf16 v59, v137, v137, v59
  v_dot2_f32_bf16 v56, v138, s52, v56
  v_dot2_f32_bf16 v58, v138, v138, v58
  v_dot2_f32_bf16 v57, v139, s52, v57
  v_dot2_f32_bf16 v59, v139, v139, v59
  v_dot2_f32_bf16 v56, v140, s52, v56
  v_dot2_f32_bf16 v58, v140, v140, v58
  v_dot2_f32_bf16 v57, v141, s52, v57
  v_dot2_f32_bf16 v59, v141, v141, v59
  v_dot2_f32_bf16 v56, v142, s52, v56
  v_dot2_f32_bf16 v58, v142, v142, v58
  v_dot2_f32_bf16 v57, v143, s52, v57
  v_dot2_f32_bf16 v59, v143, v143, v59
  v_dot2_f32_bf16 v56, v144, s52, v56
  v_dot2_f32_bf16 v58, v144, v144, v58
  v_dot2_f32_bf16 v57, v145, s52, v57
  v_dot2_f32_bf16 v59, v145, v145, v59
  v_dot2_f32_bf16 v56, v146, s52, v56
  v_dot2_f32_bf16 v58, v146, v146, v58
  v_dot2_f32_bf16 v57, v147, s52, v57
  v_dot2_f32_bf16 v59, v147, v147, v59
  s_waitcnt vmcnt(38)
  v_dot2_f32_bf16 v56, v148, s52, v56
  v_dot2_f32_bf16 v58, v148, v148, v58
  v_dot2_f32_bf16 v57, v149, s52, v57
  v_dot2_f32_bf16 v59, v149, v149, v59
  v_dot2_f32_bf16 v56, v150, s52, v56
  v_dot2_f32_bf16 v58, v150, v150, v58
  v_dot2_f32_bf16 v57, v151, s52, v57
  v_dot2_f32_bf16 v59, v151, v151, v59
  v_dot2_f32_bf16 v56, v152, s52, v56
  v_dot2_f32_bf16 v58, v152, v152, v58
  v_dot2_f32_bf16 v57, v153, s52, v57
  v_dot2_f32_bf16 v59, v153, v153, v59
  v_dot2_f32_bf16 v56, v154, s52, v56
  v_dot2_f32_bf16 v58, v154, v154, v58
  v_dot2_f32_bf16 v57, v155, s52, v57
  v_dot2_f32_bf16 v59, v155, v155, v59
  v_dot2_f32_bf16 v56, v156, s52, v56
  v_dot2_f32_bf16 v58, v156, v156, v58
  v_dot2_f32_bf16 v57, v157, s52, v57
  v_dot2_f32_bf16 v59, v157, v157, v59
  v_dot2_f32_bf16 v56, v158, s52, v56
  v_dot2_f32_bf16 v58, v158, v158, v58
  v_dot2_f32_bf16 v57, v159, s52, v57
  v_dot2_f32_bf16 v59, v159, v159, v59
  s_waitcnt vmcnt(35)
  v_dot2_f32_bf16 v56, v160, s52, v56
  v_dot2_f32_bf16 v58, v160, v160, v58
  v_dot2_f32_bf16 v57, v161, s52, v57
  v_dot2_f32_bf16 v59, v161, v161, v59
  v_dot2_f32_bf16 v56, v162, s52, v56
  v_dot2_f32_bf16 v58, v162, v162, v58
  v_dot2_f32_bf16 v57, v163, s52, v57
  v_dot2_f32_bf16 v59, v163, v163, v59
  v_dot2_f32_bf16 v56, v164, s52, v56
  v_dot2_f32_bf16 v58, v164, v164, v58
  v_dot2_f32_bf16 v57, v165, s52, v57
  v_dot2_f32_bf16 v59, v165, v165, v59
  v_dot2_f32_bf16 v56, v166, s52, v56
  v_dot2_f32_bf16 v58, v166, v166, v58
  v_dot2_f32_bf16 v57, v167, s52, v57
  v_dot2_f32_bf16 v59, v167, v167, v59
  v_dot2_f32_bf16 v56, v168, s52, v56
  v_dot2_f32_bf16 v58, v168, v168, v58
  v_dot2_f32_bf16 v57, v169, s52, v57
  v_dot2_f32_bf16 v59, v169, v169, v59
  v_dot2_f32_bf16 v56, v170, s52, v56
  v_dot2_f32_bf16 v58, v170, v170, v58
  v_dot2_f32_bf16 v57, v171, s52, v57
  v_dot2_f32_bf16 v59, v171, v171, v59
  s_waitcnt vmcnt(32)
  v_dot2_f32_bf16 v56, v172, s52, v56
  v_dot2_f32_bf16 v58, v172, v172, v58
  v_dot2_f32_bf16 v57, v173, s52, v57
  v_dot2_f32_bf16 v59, v173, v173, v59
  v_dot2_f32_bf16 v56, v174, s52, v56
  v_dot2_f32_bf16 v58, v174, v174, v58
  v_dot2_f32_bf16 v57, v175, s52, v57
  v_dot2_f32_bf16 v59, v175, v175, v59
  v_dot2_f32_bf16 v56, v176, s52, v56
  v_dot2_f32_bf16 v58, v176, v176, v58
  v_dot2_f32_bf16 v57, v177, s52, v57
  v_dot2_f32_bf16 v59, v177, v177, v59
  v_dot2_f32_bf16 v56, v178, s52, v56
  v_dot2_f32_bf16 v58, v178, v178, v58
  v_dot2_f32_bf16 v57, v179, s52, v57
  v_dot2_f32_bf16 v59, v179, v179, v59
  v_dot2_f32_bf16 v56, v180, s52, v56
  v_dot2_f32_bf16 v58, v180, v180, v58
  v_dot2_f32_bf16 v57, v181, s52, v57
  v_dot2_f32_bf16 v59, v181, v181, v59
  v_dot2_f32_bf16 v56, v182, s52, v56
  v_dot2_f32_bf16 v58, v182, v182, v58
  v_dot2_f32_bf16 v57, v183, s52, v57
  v_dot2_f32_bf16 v59, v183, v183, v59
  s_nop 1
  v_add_f32 v56, v56, v57
  v_add_f32 v58, v58, v59
  s_nop 0
  v_add_f32_dpp v56, v56, v56 quad_perm:[1,0,3,2] row_mask:0xf bank_mask:0xf
  v_add_f32_dpp v58, v58, v58 quad_perm:[1,0,3,2] row_mask:0xf bank_mask:0xf
  s_nop 0
  v_add_f32_dpp v56, v56, v56 quad_perm:[2,3,0,1] row_mask:0xf bank_mask:0xf
  v_add_f32_dpp v58, v58, v58 quad_perm:[2,3,0,1] row_mask:0xf bank_mask:0xf
  v_mul_f32 v56, 0x3ae38e39, v56
  v_mul_f32 v58, 0x3ae38e39, v58
  v_fma_f32 v58, -v56, v56, v58
  v_max_f32 v58, 0, v58
  v_add_f32 v57, 0x3727c5ac, v58
  v_rsq_f32 v60, v57
  s_nop 0
  v_mul_f32 v58, v56, v60
  v_sub_f32 v58, 0, v58
  v_lshlrev_b32 v64, 16, v112
  v_and_b32 v65, 0xffff0000, v112
  v_lshlrev_b32 v66, 16, v113
  v_and_b32 v67, 0xffff0000, v113
  v_lshlrev_b32 v68, 16, v114
  v_and_b32 v69, 0xffff0000, v114
  v_lshlrev_b32 v70, 16, v115
  v_and_b32 v71, 0xffff0000, v115
  v_pk_fma_f32 v[64:65], v[64:65], v[60:61], v[58:59] op_sel_hi:[1,0,0]
  v_pk_fma_f32 v[66:67], v[66:67], v[60:61], v[58:59] op_sel_hi:[1,0,0]
  v_pk_fma_f32 v[68:69], v[68:69], v[60:61], v[58:59] op_sel_hi:[1,0,0]
  v_pk_fma_f32 v[70:71], v[70:71], v[60:61], v[58:59] op_sel_hi:[1,0,0]
  v_cvt_pk_bf16_f32 v112, v64, v65
  v_cvt_pk_bf16_f32 v113, v66, v67
  v_cvt_pk_bf16_f32 v114, v68, v69
  v_cvt_pk_bf16_f32 v115, v70, v71
  ds_write_b128 v6, v[112:115] offset:0
  v_lshlrev_b32 v64, 16, v116
  v_and_b32 v65, 0xffff0000, v116
  v_lshlrev_b32 v66, 16, v117
  v_and_b32 v67, 0xffff0000, v117
  v_lshlrev_b32 v68, 16, v118
  v_and_b32 v69, 0xffff0000, v118
  v_lshlrev_b32 v70, 16, v119
  v_and_b32 v71, 0xffff0000, v119
  v_pk_fma_f32 v[64:65], v[64:65], v[60:61], v[58:59] op_sel_hi:[1,0,0]
  v_pk_fma_f32 v[66:67], v[66:67], v[60:61], v[58:59] op_sel_hi:[1,0,0]
  v_pk_fma_f32 v[68:69], v[68:69], v[60:61], v[58:59] op_sel_hi:[1,0,0]
  v_pk_fma_f32 v[70:71], v[70:71], v[60:61], v[58:59] op_sel_hi:[1,0,0]
  v_cvt_pk_bf16_f32 v116, v64, v65
  v_cvt_pk_bf16_f32 v117, v66, v67
  v_cvt_pk_bf16_f32 v118, v68, v69
  v_cvt_pk_bf16_f32 v119, v70, v71
  ds_write_b128 v6, v[116:119] offset:2048
  v_lshlrev_b32 v64, 16, v120
  v_and_b32 v65, 0xffff0000, v120
  v_lshlrev_b32 v66, 16, v121
  v_and_b32 v67, 0xffff0000, v121
  v_lshlrev_b32 v68, 16, v122
  v_and_b32 v69, 0xffff0000, v122
  v_lshlrev_b32 v70, 16, v123
  v_and_b32 v71, 0xffff0000, v123
  v_pk_fma_f32 v[64:65], v[64:65], v[60:61], v[58:59] op_sel_hi:[1,0,0]
  v_pk_fma_f32 v[66:67], v[66:67], v[60:61], v[58:59] op_sel_hi:[1,0,0]
  v_pk_fma_f32 v[68:69], v[68:69], v[60:61], v[58:59] op_sel_hi:[1,0,0]
  v_pk_fma_f32 v[70:71], v[70:71], v[60:61], v[58:59] op_sel_hi:[1,0,0]
  v_cvt_pk_bf16_f32 v120, v64, v65
  v_cvt_pk_bf16_f32 v121, v66, v67
  v_cvt_pk_bf16_f32 v122, v68, v69
  v_cvt_pk_bf16_f32 v123, v70, v71
  ds_write_b128 v6, v[120:123] offset:4096
  v_lshlrev_b32 v64, 16, v124
  v_and_b32 v65, 0xffff0000, v124
  v_lshlrev_b32 v66, 16, v125
  v_and_b32 v67, 0xffff0000, v125
  v_lshlrev_b32 v68, 16, v126
  v_and_b32 v69, 0xffff0000, v126
  v_lshlrev_b32 v70, 16, v127
  v_and_b32 v71, 0xffff0000, v127
  v_pk_fma_f32 v[64:65], v[64:65], v[60:61], v[58:59] op_sel_hi:[1,0,0]
  v_pk_fma_f32 v[66:67], v[66:67], v[60:61], v[58:59] op_sel_hi:[1,0,0]
  v_pk_fma_f32 v[68:69], v[68:69], v[60:61], v[58:59] op_sel_hi:[1,0,0]
  v_pk_fma_f32 v[70:71], v[70:71], v[60:61], v[58:59] op_sel_hi:[1,0,0]
  v_cvt_pk_bf16_f32 v124, v64, v65
  v_cvt_pk_bf16_f32 v125, v66, v67
  v_cvt_pk_bf16_f32 v126, v68, v69
  v_cvt_pk_bf16_f32 v127, v70, v71
  ds_write_b128 v6, v[124:127] offset:6144
  v_lshlrev_b32 v64, 16, v128
  v_and_b32 v65, 0xffff0000, v128
  v_lshlrev_b32 v66, 16, v129
  v_and_b32 v67, 0xffff0000, v129
  v_lshlrev_b32 v68, 16, v130
  v_and_b32 v69, 0xffff0000, v130
  v_lshlrev_b32 v70, 16, v131
  v_and_b32 v71, 0xffff0000, v131
  v_pk_fma_f32 v[64:65], v[64:65], v[60:61], v[58:59] op_sel_hi:[1,0,0]
  v_pk_fma_f32 v[66:67], v[66:67], v[60:61], v[58:59] op_sel_hi:[1,0,0]
  v_pk_fma_f32 v[68:69], v[68:69], v[60:61], v[58:59] op_sel_hi:[1,0,0]
  v_pk_fma_f32 v[70:71], v[70:71], v[60:61], v[58:59] op_sel_hi:[1,0,0]
  v_cvt_pk_bf16_f32 v128, v64, v65
  v_cvt_pk_bf16_f32 v129, v66, v67
  v_cvt_pk_bf16_f32 v130, v68, v69
  v_cvt_pk_bf16_f32 v131, v70, v71
  ds_write_b128 v6, v[128:131] offset:8192
  v_lshlrev_b32 v64, 16, v132
  v_and_b32 v65, 0xffff0000, v132
  v_lshlrev_b32 v66, 16, v133
  v_and_b32 v67, 0xffff0000, v133
  v_lshlrev_b32 v68, 16, v134
  v_and_b32 v69, 0xffff0000, v134
  v_lshlrev_b32 v70, 16, v135
  v_and_b32 v71, 0xffff0000, v135
  v_pk_fma_f32 v[64:65], v[64:65], v[60:61], v[58:59] op_sel_hi:[1,0,0]
  v_pk_fma_f32 v[66:67], v[66:67], v[60:61], v[58:59] op_sel_hi:[1,0,0]
  v_pk_fma_f32 v[68:69], v[68:69], v[60:61], v[58:59] op_sel_hi:[1,0,0]
  v_pk_fma_f32 v[70:71], v[70:71], v[60:61], v[58:59] op_sel_hi:[1,0,0]
  v_cvt_pk_bf16_f32 v132, v64, v65
  v_cvt_pk_bf16_f32 v133, v66, v67
  v_cvt_pk_bf16_f32 v134, v68, v69
  v_cvt_pk_bf16_f32 v135, v70, v71
  ds_write_b128 v6, v[132:135] offset:10240
  v_lshlrev_b32 v64, 16, v136
  v_and_b32 v65, 0xffff0000, v136
  v_lshlrev_b32 v66, 16, v137
  v_and_b32 v67, 0xffff0000, v137
  v_lshlrev_b32 v68, 16, v138
  v_and_b32 v69, 0xffff0000, v138
  v_lshlrev_b32 v70, 16, v139
  v_and_b32 v71, 0xffff0000, v139
  v_pk_fma_f32 v[64:65], v[64:65], v[60:61], v[58:59] op_sel_hi:[1,0,0]
  v_pk_fma_f32 v[66:67], v[66:67], v[60:61], v[58:59] op_sel_hi:[1,0,0]
  v_pk_fma_f32 v[68:69], v[68:69], v[60:61], v[58:59] op_sel_hi:[1,0,0]
  v_pk_fma_f32 v[70:71], v[70:71], v[60:61], v[58:59] op_sel_hi:[1,0,0]
  v_cvt_pk_bf16_f32 v136, v64, v65
  v_cvt_pk_bf16_f32 v137, v66, v67
  v_cvt_pk_bf16_f32 v138, v68, v69
  v_cvt_pk_bf16_f32 v139, v70, v71
  ds_write_b128 v6, v[136:139] offset:12288
  v_lshlrev_b32 v64, 16, v140
  v_and_b32 v65, 0xffff0000, v140
  v_lshlrev_b32 v66, 16, v141
  v_and_b32 v67, 0xffff0000, v141
  v_lshlrev_b32 v68, 16, v142
  v_and_b32 v69, 0xffff0000, v142
  v_lshlrev_b32 v70, 16, v143
  v_and_b32 v71, 0xffff0000, v143
  v_pk_fma_f32 v[64:65], v[64:65], v[60:61], v[58:59] op_sel_hi:[1,0,0]
  v_pk_fma_f32 v[66:67], v[66:67], v[60:61], v[58:59] op_sel_hi:[1,0,0]
  v_pk_fma_f32 v[68:69], v[68:69], v[60:61], v[58:59] op_sel_hi:[1,0,0]
  v_pk_fma_f32 v[70:71], v[70:71], v[60:61], v[58:59] op_sel_hi:[1,0,0]
  v_cvt_pk_bf16_f32 v140, v64, v65
  v_cvt_pk_bf16_f32 v141, v66, v67
  v_cvt_pk_bf16_f32 v142, v68, v69
  v_cvt_pk_bf16_f32 v143, v70, v71
  ds_write_b128 v6, v[140:143] offset:14336
  v_lshlrev_b32 v64, 16, v144
  v_and_b32 v65, 0xffff0000, v144
  v_lshlrev_b32 v66, 16, v145
  v_and_b32 v67, 0xffff0000, v145
  v_lshlrev_b32 v68, 16, v146
  v_and_b32 v69, 0xffff0000, v146
  v_lshlrev_b32 v70, 16, v147
  v_and_b32 v71, 0xffff0000, v147
  v_pk_fma_f32 v[64:65], v[64:65], v[60:61], v[58:59] op_sel_hi:[1,0,0]
  v_pk_fma_f32 v[66:67], v[66:67], v[60:61], v[58:59] op_sel_hi:[1,0,0]
  v_pk_fma_f32 v[68:69], v[68:69], v[60:61], v[58:59] op_sel_hi:[1,0,0]
  v_pk_fma_f32 v[70:71], v[70:71], v[60:61], v[58:59] op_sel_hi:[1,0,0]
  v_cvt_pk_bf16_f32 v144, v64, v65
  v_cvt_pk_bf16_f32 v145, v66, v67
  v_cvt_pk_bf16_f32 v146, v68, v69
  v_cvt_pk_bf16_f32 v147, v70, v71
  ds_write_b128 v6, v[144:147] offset:16384
  v_lshlrev_b32 v64, 16, v148
  v_and_b32 v65, 0xffff0000, v148
  v_lshlrev_b32 v66, 16, v149
  v_and_b32 v67, 0xffff0000, v149
  v_lshlrev_b32 v68, 16, v150
  v_and_b32 v69, 0xffff0000, v150
  v_lshlrev_b32 v70, 16, v151
  v_and_b32 v71, 0xffff0000, v151
  v_pk_fma_f32 v[64:65], v[64:65], v[60:61], v[58:59] op_sel_hi:[1,0,0]
  v_pk_fma_f32 v[66:67], v[66:67], v[60:61], v[58:59] op_sel_hi:[1,0,0]
  v_pk_fma_f32 v[68:69], v[68:69], v[60:61], v[58:59] op_sel_hi:[1,0,0]
  v_pk_fma_f32 v[70:71], v[70:71], v[60:61], v[58:59] op_sel_hi:[1,0,0]
  v_cvt_pk_bf16_f32 v148, v64, v65
  v_cvt_pk_bf16_f32 v149, v66, v67
  v_cvt_pk_bf16_f32 v150, v68, v69
  v_cvt_pk_bf16_f32 v151, v70, v71
  ds_write_b128 v6, v[148:151] offset:18432
  v_lshlrev_b32 v64, 16, v152
  v_and_b32 v65, 0xffff0000, v152
  v_lshlrev_b32 v66, 16, v153
  v_and_b32 v67, 0xffff0000, v153
  v_lshlrev_b32 v68, 16, v154
  v_and_b32 v69, 0xffff0000, v154
  v_lshlrev_b32 v70, 16, v155
  v_and_b32 v71, 0xffff0000, v155
  v_pk_fma_f32 v[64:65], v[64:65], v[60:61], v[58:59] op_sel_hi:[1,0,0]
  v_pk_fma_f32 v[66:67], v[66:67], v[60:61], v[58:59] op_sel_hi:[1,0,0]
  v_pk_fma_f32 v[68:69], v[68:69], v[60:61], v[58:59] op_sel_hi:[1,0,0]
  v_pk_fma_f32 v[70:71], v[70:71], v[60:61], v[58:59] op_sel_hi:[1,0,0]
  v_cvt_pk_bf16_f32 v152, v64, v65
  v_cvt_pk_bf16_f32 v153, v66, v67
  v_cvt_pk_bf16_f32 v154, v68, v69
  v_cvt_pk_bf16_f32 v155, v70, v71
  ds_write_b128 v6, v[152:155] offset:20480
  v_lshlrev_b32 v64, 16, v156
  v_and_b32 v65, 0xffff0000, v156
  v_lshlrev_b32 v66, 16, v157
  v_and_b32 v67, 0xffff0000, v157
  v_lshlrev_b32 v68, 16, v158
  v_and_b32 v69, 0xffff0000, v158
  v_lshlrev_b32 v70, 16, v159
  v_and_b32 v71, 0xffff0000, v159
  v_pk_fma_f32 v[64:65], v[64:65], v[60:61], v[58:59] op_sel_hi:[1,0,0]
  v_pk_fma_f32 v[66:67], v[66:67], v[60:61], v[58:59] op_sel_hi:[1,0,0]
  v_pk_fma_f32 v[68:69], v[68:69], v[60:61], v[58:59] op_sel_hi:[1,0,0]
  v_pk_fma_f32 v[70:71], v[70:71], v[60:61], v[58:59] op_sel_hi:[1,0,0]
  v_cvt_pk_bf16_f32 v156, v64, v65
  v_cvt_pk_bf16_f32 v157, v66, v67
  v_cvt_pk_bf16_f32 v158, v68, v69
  v_cvt_pk_bf16_f32 v159, v70, v71
  ds_write_b128 v6, v[156:159] offset:22528
  v_lshlrev_b32 v64, 16, v160
  v_and_b32 v65, 0xffff0000, v160
  v_lshlrev_b32 v66, 16, v161
  v_and_b32 v67, 0xffff0000, v161
  v_lshlrev_b32 v68, 16, v162
  v_and_b32 v69, 0xffff0000, v162
  v_lshlrev_b32 v70, 16, v163
  v_and_b32 v71, 0xffff0000, v163
  v_pk_fma_f32 v[64:65], v[64:65], v[60:61], v[58:59] op_sel_hi:[1,0,0]
  v_pk_fma_f32 v[66:67], v[66:67], v[60:61], v[58:59] op_sel_hi:[1,0,0]
  v_pk_fma_f32 v[68:69], v[68:69], v[60:61], v[58:59] op_sel_hi:[1,0,0]
  v_pk_fma_f32 v[70:71], v[70:71], v[60:61], v[58:59] op_sel_hi:[1,0,0]
  v_cvt_pk_bf16_f32 v160, v64, v65
  v_cvt_pk_bf16_f32 v161, v66, v67
  v_cvt_pk_bf16_f32 v162, v68, v69
  v_cvt_pk_bf16_f32 v163, v70, v71
  ds_write_b128 v6, v[160:163] offset:24576
  v_lshlrev_b32 v64, 16, v164
  v_and_b32 v65, 0xffff0000, v164
  v_lshlrev_b32 v66, 16, v165
  v_and_b32 v67, 0xffff0000, v165
  v_lshlrev_b32 v68, 16, v166
  v_and_b32 v69, 0xffff0000, v166
  v_lshlrev_b32 v70, 16, v167
  v_and_b32 v71, 0xffff0000, v167
  v_pk_fma_f32 v[64:65], v[64:65], v[60:61], v[58:59] op_sel_hi:[1,0,0]
  v_pk_fma_f32 v[66:67], v[66:67], v[60:61], v[58:59] op_sel_hi:[1,0,0]
  v_pk_fma_f32 v[68:69], v[68:69], v[60:61], v[58:59] op_sel_hi:[1,0,0]
  v_pk_fma_f32 v[70:71], v[70:71], v[60:61], v[58:59] op_sel_hi:[1,0,0]
  v_cvt_pk_bf16_f32 v164, v64, v65
  v_cvt_pk_bf16_f32 v165, v66, v67
  v_cvt_pk_bf16_f32 v166, v68, v69
  v_cvt_pk_bf16_f32 v167, v70, v71
  ds_write_b128 v6, v[164:167] offset:26624
  v_lshlrev_b32 v64, 16, v168
  v_and_b32 v65, 0xffff0000, v168
  v_lshlrev_b32 v66, 16, v169
  v_and_b32 v67, 0xffff0000, v169
  v_lshlrev_b32 v68, 16, v170
  v_and_b32 v69, 0xffff0000, v170
  v_lshlrev_b32 v70, 16, v171
  v_and_b32 v71, 0xffff0000, v171
  v_pk_fma_f32 v[64:65], v[64:65], v[60:61], v[58:59] op_sel_hi:[1,0,0]
  v_pk_fma_f32 v[66:67], v[66:67], v[60:61], v[58:59] op_sel_hi:[1,0,0]
  v_pk_fma_f32 v[68:69], v[68:69], v[60:61], v[58:59] op_sel_hi:[1,0,0]
  v_pk_fma_f32 v[70:71], v[70:71], v[60:61], v[58:59] op_sel_hi:[1,0,0]
  v_cvt_pk_bf16_f32 v168, v64, v65
  v_cvt_pk_bf16_f32 v169, v66, v67
  v_cvt_pk_bf16_f32 v170, v68, v69
  v_cvt_pk_bf16_f32 v171, v70, v71
  ds_write_b128 v6, v[168:171] offset:28672
  v_lshlrev_b32 v64, 16, v172
  v_and_b32 v65, 0xffff0000, v172
  v_lshlrev_b32 v66, 16, v173
  v_and_b32 v67, 0xffff0000, v173
  v_lshlrev_b32 v68, 16, v174
  v_and_b32 v69, 0xffff0000, v174
  v_lshlrev_b32 v70, 16, v175
  v_and_b32 v71, 0xffff0000, v175
  v_pk_fma_f32 v[64:65], v[64:65], v[60:61], v[58:59] op_sel_hi:[1,0,0]
  v_pk_fma_f32 v[66:67], v[66:67], v[60:61], v[58:59] op_sel_hi:[1,0,0]
  v_pk_fma_f32 v[68:69], v[68:69], v[60:61], v[58:59] op_sel_hi:[1,0,0]
  v_pk_fma_f32 v[70:71], v[70:71], v[60:61], v[58:59] op_sel_hi:[1,0,0]
  v_cvt_pk_bf16_f32 v172, v64, v65
  v_cvt_pk_bf16_f32 v173, v66, v67
  v_cvt_pk_bf16_f32 v174, v68, v69
  v_cvt_pk_bf16_f32 v175, v70, v71
  ds_write_b128 v6, v[172:175] offset:30720
  v_lshlrev_b32 v64, 16, v176
  v_and_b32 v65, 0xffff0000, v176
  v_lshlrev_b32 v66, 16, v177
  v_and_b32 v67, 0xffff0000, v177
  v_lshlrev_b32 v68, 16, v178
  v_and_b32 v69, 0xffff0000, v178
  v_lshlrev_b32 v70, 16, v179
  v_and_b32 v71, 0xffff0000, v179
  v_pk_fma_f32 v[64:65], v[64:65], v[60:61], v[58:59] op_sel_hi:[1,0,0]
  v_pk_fma_f32 v[66:67], v[66:67], v[60:61], v[58:59] op_sel_hi:[1,0,0]
  v_pk_fma_f32 v[68:69], v[68:69], v[60:61], v[58:59] op_sel_hi:[1,0,0]
  v_pk_fma_f32 v[70:71], v[70:71], v[60:61], v[58:59] op_sel_hi:[1,0,0]
  v_cvt_pk_bf16_f32 v176, v64, v65
  v_cvt_pk_bf16_f32 v177, v66, v67
  v_cvt_pk_bf16_f32 v178, v68, v69
  v_cvt_pk_bf16_f32 v179, v70, v71
  ds_write_b128 v6, v[176:179] offset:32768
  v_lshlrev_b32 v64, 16, v180
  v_and_b32 v65, 0xffff0000, v180
  v_lshlrev_b32 v66, 16, v181
  v_and_b32 v67, 0xffff0000, v181
  v_lshlrev_b32 v68, 16, v182
  v_and_b32 v69, 0xffff0000, v182
  v_lshlrev_b32 v70, 16, v183
  v_and_b32 v71, 0xffff0000, v183
  v_pk_fma_f32 v[64:65], v[64:65], v[60:61], v[58:59] op_sel_hi:[1,0,0]
  v_pk_fma_f32 v[66:67], v[66:67], v[60:61], v[58:59] op_sel_hi:[1,0,0]
  v_pk_fma_f32 v[68:69], v[68:69], v[60:61], v[58:59] op_sel_hi:[1,0,0]
  v_pk_fma_f32 v[70:71], v[70:71], v[60:61], v[58:59] op_sel_hi:[1,0,0]
  v_cvt_pk_bf16_f32 v180, v64, v65
  v_cvt_pk_bf16_f32 v181, v66, v67
  v_cvt_pk_bf16_f32 v182, v68, v69
  v_cvt_pk_bf16_f32 v183, v70, v71
  ds_write_b128 v6, v[180:183] offset:34816
  s_waitcnt lgkmcnt(0)
  s_barrier
  ds_read_b128 a[0:3], v4 offset:0
  ds_read_b128 a[4:7], v5 offset:1024
  ds_read_b128 a[8:11], v4 offset:2048
  ds_read_b128 a[12:15], v5 offset:3072
  ds_read_b128 a[16:19], v4 offset:4096
  ds_read_b128 a[20:23], v5 offset:5120
  ds_read_b128 a[24:27], v4 offset:6144
  ds_read_b128 a[28:31], v5 offset:7168
  ds_read_b128 a[32:35], v4 offset:8192
  ds_read_b128 a[36:39], v5 offset:9216
  ds_read_b128 a[40:43], v4 offset:10240
  ds_read_b128 a[44:47], v5 offset:11264
  ds_read_b128 a[48:51], v4 offset:12288
  ds_read_b128 a[52:55], v5 offset:13312
  ds_read_b128 a[56:59], v4 offset:14336
  ds_read_b128 a[60:63], v5 offset:15360
  ds_read_b128 a[64:67], v4 offset:16384
  ds_read_b128 a[68:71], v5 offset:17408
  ds_read_b128 a[72:75], v4 offset:18432
  ds_read_b128 a[76:79], v5 offset:19456
  ds_read_b128 a[80:83], v4 offset:20480
  ds_read_b128 a[84:87], v5 offset:21504
  ds_read_b128 a[88:91], v4 offset:22528
  ds_read_b128 a[92:95], v5 offset:23552
  ds_read_b128 a[96:99], v4 offset:24576
  ds_read_b128 a[100:103], v5 offset:25600
  ds_read_b128 a[104:107], v4 offset:26624
  ds_read_b128 a[108:111], v5 offset:27648
  ds_read_b128 a[112:115], v4 offset:28672
  ds_read_b128 a[116:119], v5 offset:29696
  ds_read_b128 a[120:123], v4 offset:30720
  ds_read_b128 a[124:127], v5 offset:31744
  ds_read_b128 a[128:131], v4 offset:32768
  ds_read_b128 a[132:135], v5 offset:33792
  ds_read_b128 a[136:139], v4 offset:34816
  ds_read_b128 a[140:143], v5 offset:35840
  s_and_b32 s54, s44, 31
  s_mul_i32 s56, s54, 165888
  s_mul_i32 s57, s45, 1152
  s_add_u32 s56, s56, s57
  s_mul_i32 s57, s57, 576
  s_mul_i32 s54, s54, 20736
  s_add_u32 s57, s57, s54
  v_add_u32 v60, 0, v0
  v_min_u32 v60, 161, v60
  v_mul_u32_u24 v57, 7282, v60
  v_lshrrev_b32 v57, 16, v57
  v_mul_u32_u24 v57, 8064, v57
  v_mul_u32_u24 v60, 128, v60
  v_add_u32 v57, v57, v60
  buffer_load_dword v250, v60, s[20:23], s57 offen
  v_add_u32 v160, 0, v21
  v_add_u32 v161, 0, v22
  v_add_u32 v162, 0, v23
  v_add_u32 v163, 57344, v21
  v_add_u32 v164, 57344, v22
  v_add_u32 v165, 57344, v23
  v_add_u32 v166, 114688, v21
  v_add_u32 v167, 114688, v22
  v_add_u32 v168, 114688, v23
  s_waitcnt vmcnt(26) lgkmcnt(0)
  s_barrier
  ds_read_b64_tr_b16 v[128:129], v160 offset:0
  ds_read_b64_tr_b16 v[130:131], v160 offset:1792
  ds_read_b64_tr_b16 v[132:133], v160 offset:40
  ds_read_b64_tr_b16 v[134:135], v160 offset:1832
  ds_read_b64_tr_b16 v[136:137], v161 offset:0
  ds_read_b64_tr_b16 v[138:139], v161 offset:1792
  ds_read_b64_tr_b16 v[140:141], v162 offset:0
  ds_read_b64_tr_b16 v[142:143], v162 offset:1792
  s_waitcnt lgkmcnt(4)
  v_mfma_f32_32x32x16_bf16 v[64:79], v[128:131], a[0:3], 0
  ds_read_b64_tr_b16 v[144:145], v160 offset:7168
  ds_read_b64_tr_b16 v[146:147], v160 offset:8960
  s_add_u32 s64, s64, 221184
  v_mfma_f32_32x32x16_bf16 v[80:95], v[132:135], a[0:3], 0
  ds_read_b64_tr_b16 v[148:149], v160 offset:7208
  ds_read_b64_tr_b16 v[150:151], v160 offset:9000
  s_add_u32 m0, s65, 86016
  s_waitcnt lgkmcnt(4)
  v_mfma_f32_32x32x16_bf16 v[96:111], a[0:3], v[136:139], 0
  ds_read_b64_tr_b16 v[152:153], v161 offset:7168
  ds_read_b64_tr_b16 v[154:155], v161 offset:8960
  buffer_load_dwordx4 v24, s[8:11], s64 offen offset:0 lds
  v_mfma_f32_32x32x16_bf16 v[112:127], a[0:3], v[140:143], 0
  ds_read_b64_tr_b16 v[156:157], v162 offset:7168
  ds_read_b64_tr_b16 v[158:159], v162 offset:8960
  buffer_load_dwordx4 v25, s[8:11], s64 offen offset:1024 lds
  s_waitcnt lgkmcnt(4)
  v_mfma_f32_32x32x16_bf16 v[64:79], v[144:147], a[4:7], v[64:79]
  ds_read_b64_tr_b16 v[128:129], v160 offset:14336
  ds_read_b64_tr_b16 v[130:131], v160 offset:16128
  buffer_load_dwordx4 v26, s[8:11], s64 offen offset:2048 lds
  v_mfma_f32_32x32x16_bf16 v[80:95], v[148:151], a[4:7], v[80:95]
  ds_read_b64_tr_b16 v[132:133], v160 offset:14376
  ds_read_b64_tr_b16 v[134:135], v160 offset:16168
  s_waitcnt lgkmcnt(4)
  v_mfma_f32_32x32x16_bf16 v[96:111], a[4:7], v[152:155], v[96:111]
  ds_read_b64_tr_b16 v[136:137], v161 offset:14336
  ds_read_b64_tr_b16 v[138:139], v161 offset:16128
  buffer_load_dwordx4 v27, s[8:11], s64 offen offset:3072 lds
  v_mfma_f32_32x32x16_bf16 v[112:127], a[4:7], v[156:159], v[112:127]
  ds_read_b64_tr_b16 v[140:141], v162 offset:14336
  ds_read_b64_tr_b16 v[142:143], v162 offset:16128
  s_add_u32 m0, s65, 90112
  s_waitcnt lgkmcnt(4)
  v_mfma_f32_32x32x16_bf16 v[64:79], v[128:131], a[8:11], v[64:79]
  ds_read_b64_tr_b16 v[144:145], v160 offset:21504
  ds_read_b64_tr_b16 v[146:147], v160 offset:23296
  buffer_load_dwordx4 v28, s[8:11], s64 offen offset:0 lds
  v_mfma_f32_32x32x16_bf16 v[80:95], v[132:135], a[8:11], v[80:95]
  ds_read_b64_tr_b16 v[148:149], v160 offset:21544
  ds_read_b64_tr_b16 v[150:151], v160 offset:23336
  buffer_load_dwordx4 v29, s[8:11], s64 offen offset:1024 lds
  s_waitcnt lgkmcnt(4)
  v_mfma_f32_32x32x16_bf16 v[96:111], a[8:11], v[136:139], v[96:111]
  ds_read_b64_tr_b16 v[152:153], v161 offset:21504
  ds_read_b64_tr_b16 v[154:155], v161 offset:23296
  buffer_load_dwordx4 v30, s[8:11], s64 offen offset:2048 lds
  v_mfma_f32_32x32x16_bf16 v[112:127], a[8:11], v[140:143], v[112:127]
  ds_read_b64_tr_b16 v[156:157], v162 offset:21504
  ds_read_b64_tr_b16 v[158:159], v162 offset:23296
  s_waitcnt lgkmcnt(4)
  v_mfma_f32_32x32x16_bf16 v[64:79], v[144:147], a[12:15], v[64:79]
  s_waitcnt vmcnt(26)
  s_barrier
  ds_read_b64_tr_b16 v[128:129], v160 offset:28672
  ds_read_b64_tr_b16 v[130:131], v160 offset:30464
  v_mfma_f32_32x32x16_bf16 v[80:95], v[148:151], a[12:15], v[80:95]
  ds_read_b64_tr_b16 v[132:133], v160 offset:28712
  ds_read_b64_tr_b16 v[134:135], v160 offset:30504
  s_add_u32 s64, s64, 221184
  s_waitcnt lgkmcnt(4)
  v_mfma_f32_32x32x16_bf16 v[96:111], a[12:15], v[152:155], v[96:111]
  ds_read_b64_tr_b16 v[136:137], v161 offset:28672
  ds_read_b64_tr_b16 v[138:139], v161 offset:30464
  v_mfma_f32_32x32x16_bf16 v[112:127], a[12:15], v[156:159], v[112:127]
  ds_read_b64_tr_b16 v[140:141], v162 offset:28672
  ds_read_b64_tr_b16 v[142:143], v162 offset:30464
  s_add_u32 m0, s65, 114688
  s_waitcnt lgkmcnt(4)
  v_mfma_f32_32x32x16_bf16 v[64:79], v[128:131], a[16:19], v[64:79]
  ds_read_b64_tr_b16 v[144:145], v160 offset:35840
  ds_read_b64_tr_b16 v[146:147], v160 offset:37632
  buffer_load_dwordx4 v24, s[8:11], s64 offen offset:0 lds
  v_mfma_f32_32x32x16_bf16 v[80:95], v[132:135], a[16:19], v[80:95]
  ds_read_b64_tr_b16 v[148:149], v160 offset:35880
  ds_read_b64_tr_b16 v[150:151], v160 offset:37672
  buffer_load_dwordx4 v25, s[8:11], s64 offen offset:1024 lds
  s_waitcnt lgkmcnt(4)
  v_mfma_f32_32x32x16_bf16 v[96:111], a[16:19], v[136:139], v[96:111]
  ds_read_b64_tr_b16 v[152:153], v161 offset:35840
  ds_read_b64_tr_b16 v[154:155], v161 offset:37632
  v_mfma_f32_32x32x16_bf16 v[112:127], a[16:19], v[140:143], v[112:127]
  ds_read_b64_tr_b16 v[156:157], v162 offset:35840
  ds_read_b64_tr_b16 v[158:159], v162 offset:37632
  buffer_load_dwordx4 v26, s[8:11], s64 offen offset:2048 lds
  s_waitcnt lgkmcnt(4)
  v_mfma_f32_32x32x16_bf16 v[64:79], v[144:147], a[20:23], v[64:79]
  ds_read_b64_tr_b16 v[128:129], v160 offset:43008
  ds_read_b64_tr_b16 v[130:131], v160 offset:44800
  buffer_load_dwordx4 v27, s[8:11], s64 offen offset:3072 lds
  v_mfma_f32_32x32x16_bf16 v[80:95], v[148:151], a[20:23], v[80:95]
  ds_read_b64_tr_b16 v[132:133], v160 offset:43048
  ds_read_b64_tr_b16 v[134:135], v160 offset:44840
  s_waitcnt lgkmcnt(4)
  v_mfma_f32_32x32x16_bf16 v[96:111], a[20:23], v[152:155], v[96:111]
  ds_read_b64_tr_b16 v[136:137], v161 offset:43008
  ds_read_b64_tr_b16 v[138:139], v161 offset:44800
  s_add_u32 m0, s65, 118784
  v_mfma_f32_32x32x16_bf16 v[112:127], a[20:23], v[156:159], v[112:127]
  ds_read_b64_tr_b16 v[140:141], v162 offset:43008
  ds_read_b64_tr_b16 v[142:143], v162 offset:44800
  buffer_load_dwordx4 v28, s[8:11], s64 offen offset:0 lds
  s_waitcnt lgkmcnt(4)
  v_mfma_f32_32x32x16_bf16 v[64:79], v[128:131], a[24:27], v[64:79]
  ds_read_b64_tr_b16 v[144:145], v160 offset:50176
  ds_read_b64_tr_b16 v[146:147], v160 offset:51968
  buffer_load_dwordx4 v29, s[8:11], s64 offen offset:1024 lds
  v_mfma_f32_32x32x16_bf16 v[80:95], v[132:135], a[24:27], v[80:95]
  ds_read_b64_tr_b16 v[148:149], v160 offset:50216
  ds_read_b64_tr_b16 v[150:151], v160 offset:52008
  s_waitcnt lgkmcnt(4)
  v_mfma_f32_32x32x16_bf16 v[96:111], a[24:27], v[136:139], v[96:111]
  ds_read_b64_tr_b16 v[152:153], v161 offset:50176
  ds_read_b64_tr_b16 v[154:155], v161 offset:51968
  buffer_load_dwordx4 v30, s[8:11], s64 offen offset:2048 lds
  v_mfma_f32_32x32x16_bf16 v[112:127], a[24:27], v[140:143], v[112:127]
  ds_read_b64_tr_b16 v[156:157], v162 offset:50176
  ds_read_b64_tr_b16 v[158:159], v162 offset:51968
  s_waitcnt lgkmcnt(4)
  v_mfma_f32_32x32x16_bf16 v[64:79], v[144:147], a[28:31], v[64:79]
  s_waitcnt vmcnt(26)
  s_barrier
  ds_read_b64_tr_b16 v[128:129], v163 offset:0
  ds_read_b64_tr_b16 v[130:131], v163 offset:1792
  v_mfma_f32_32x32x16_bf16 v[80:95], v[148:151], a[28:31], v[80:95]
  ds_read_b64_tr_b16 v[132:133], v163 offset:40
  ds_read_b64_tr_b16 v[134:135], v163 offset:1832
  s_add_u32 s64, s64, 221184
  s_waitcnt lgkmcnt(4)
  v_mfma_f32_32x32x16_bf16 v[96:111], a[28:31], v[152:155], v[96:111]
  ds_read_b64_tr_b16 v[136:137], v164 offset:0
  ds_read_b64_tr_b16 v[138:139], v164 offset:1792
  v_mfma_f32_32x32x16_bf16 v[112:127], a[28:31], v[156:159], v[112:127]
  ds_read_b64_tr_b16 v[140:141], v165 offset:0
  ds_read_b64_tr_b16 v[142:143], v165 offset:1792
  s_add_u32 m0, s65, 0
  s_waitcnt lgkmcnt(4)
  v_mfma_f32_32x32x16_bf16 v[64:79], v[128:131], a[32:35], v[64:79]
  ds_read_b64_tr_b16 v[144:145], v163 offset:7168
  ds_read_b64_tr_b16 v[146:147], v163 offset:8960
  buffer_load_dwordx4 v24, s[8:11], s64 offen offset:0 lds
  v_mfma_f32_32x32x16_bf16 v[80:95], v[132:135], a[32:35], v[80:95]
  ds_read_b64_tr_b16 v[148:149], v163 offset:7208
  ds_read_b64_tr_b16 v[150:151], v163 offset:9000
  buffer_load_dwordx4 v25, s[8:11], s64 offen offset:1024 lds
  s_waitcnt lgkmcnt(4)
  v_mfma_f32_32x32x16_bf16 v[96:111], a[32:35], v[136:139], v[96:111]
  ds_read_b64_tr_b16 v[152:153], v164 offset:7168
  ds_read_b64_tr_b16 v[154:155], v164 offset:8960
  v_mfma_f32_32x32x16_bf16 v[112:127], a[32:35], v[140:143], v[112:127]
  ds_read_b64_tr_b16 v[156:157], v165 offset:7168
  ds_read_b64_tr_b16 v[158:159], v165 offset:8960
  buffer_load_dwordx4 v26, s[8:11], s64 offen offset:2048 lds
  s_waitcnt lgkmcnt(4)
  v_mfma_f32_32x32x16_bf16 v[64:79], v[144:147], a[36:39], v[64:79]
  ds_read_b64_tr_b16 v[128:129], v163 offset:14336
  ds_read_b64_tr_b16 v[130:131], v163 offset:16128
  buffer_load_dwordx4 v27, s[8:11], s64 offen offset:3072 lds
  v_mfma_f32_32x32x16_bf16 v[80:95], v[148:151], a[36:39], v[80:95]
  ds_read_b64_tr_b16 v[132:133], v163 offset:14376
  ds_read_b64_tr_b16 v[134:135], v163 offset:16168
  s_waitcnt lgkmcnt(4)
  v_mfma_f32_32x32x16_bf16 v[96:111], a[36:39], v[152:155], v[96:111]
  ds_read_b64_tr_b16 v[136:137], v164 offset:14336
  ds_read_b64_tr_b16 v[138:139], v164 offset:16128
  s_add_u32 m0, s65, 4096
  v_mfma_f32_32x32x16_bf16 v[112:127], a[36:39], v[156:159], v[112:127]
  ds_read_b64_tr_b16 v[140:141], v165 offset:14336
  ds_read_b64_tr_b16 v[142:143], v165 offset:16128
  buffer_load_dwordx4 v28, s[8:11], s64 offen offset:0 lds
  s_waitcnt lgkmcnt(4)
  v_mfma_f32_32x32x16_bf16 v[64:79], v[128:131], a[40:43], v[64:79]
  ds_read_b64_tr_b16 v[144:145], v163 offset:21504
  ds_read_b64_tr_b16 v[146:147], v163 offset:23296
  buffer_load_dwordx4 v29, s[8:11], s64 offen offset:1024 lds
  v_mfma_f32_32x32x16_bf16 v[80:95], v[132:135], a[40:43], v[80:95]
  ds_read_b64_tr_b16 v[148:149], v163 offset:21544
  ds_read_b64_tr_b16 v[150:151], v163 offset:23336
  s_waitcnt lgkmcnt(4)
  v_mfma_f32_32x32x16_bf16 v[96:111], a[40:43], v[136:139], v[96:111]
  ds_read_b64_tr_b16 v[152:153], v164 offset:21504
  ds_read_b64_tr_b16 v[154:155], v164 offset:23296
  buffer_load_dwordx4 v30, s[8:11], s64 offen offset:2048 lds
  v_mfma_f32_32x32x16_bf16 v[112:127], a[40:43], v[140:143], v[112:127]
  ds_read_b64_tr_b16 v[156:157], v165 offset:21504
  ds_read_b64_tr_b16 v[158:159], v165 offset:23296
  s_waitcnt lgkmcnt(4)
  v_mfma_f32_32x32x16_bf16 v[64:79], v[144:147], a[44:47], v[64:79]
  s_waitcnt vmcnt(14)
  s_barrier
  ds_read_b64_tr_b16 v[128:129], v163 offset:28672
  ds_read_b64_tr_b16 v[130:131], v163 offset:30464
  v_mfma_f32_32x32x16_bf16 v[80:95], v[148:151], a[44:47], v[80:95]
  ds_read_b64_tr_b16 v[132:133], v163 offset:28712
  ds_read_b64_tr_b16 v[134:135], v163 offset:30504
  s_add_u32 s64, s64, 221184
  s_waitcnt lgkmcnt(4)
  v_mfma_f32_32x32x16_bf16 v[96:111], a[44:47], v[152:155], v[96:111]
  ds_read_b64_tr_b16 v[136:137], v164 offset:28672
  ds_read_b64_tr_b16 v[138:139], v164 offset:30464
  v_mfma_f32_32x32x16_bf16 v[112:127], a[44:47], v[156:159], v[112:127]
  ds_read_b64_tr_b16 v[140:141], v165 offset:28672
  ds_read_b64_tr_b16 v[142:143], v165 offset:30464
  s_add_u32 m0, s65, 28672
  s_waitcnt lgkmcnt(4)
  v_mfma_f32_32x32x16_bf16 v[64:79], v[128:131], a[48:51], v[64:79]
  ds_read_b64_tr_b16 v[144:145], v163 offset:35840
  ds_read_b64_tr_b16 v[146:147], v163 offset:37632
  buffer_load_dwordx4 v24, s[8:11], s64 offen offset:0 lds
  v_mfma_f32_32x32x16_bf16 v[80:95], v[132:135], a[48:51], v[80:95]
  ds_read_b64_tr_b16 v[148:149], v163 offset:35880
  ds_read_b64_tr_b16 v[150:151], v163 offset:37672
  buffer_load_dwordx4 v25, s[8:11], s64 offen offset:1024 lds
  s_waitcnt lgkmcnt(4)
  v_mfma_f32_32x32x16_bf16 v[96:111], a[48:51], v[136:139], v[96:111]
  ds_read_b64_tr_b16 v[152:153], v164 offset:35840
  ds_read_b64_tr_b16 v[154:155], v164 offset:37632
  v_mfma_f32_32x32x16_bf16 v[112:127], a[48:51], v[140:143], v[112:127]
  ds_read_b64_tr_b16 v[156:157], v165 offset:35840
  ds_read_b64_tr_b16 v[158:159], v165 offset:37632
  buffer_load_dwordx4 v26, s[8:11], s64 offen offset:2048 lds
  s_waitcnt lgkmcnt(4)
  v_mfma_f32_32x32x16_bf16 v[64:79], v[144:147], a[52:55], v[64:79]
  ds_read_b64_tr_b16 v[128:129], v163 offset:43008
  ds_read_b64_tr_b16 v[130:131], v163 offset:44800
  buffer_load_dwordx4 v27, s[8:11], s64 offen offset:3072 lds
  v_mfma_f32_32x32x16_bf16 v[80:95], v[148:151], a[52:55], v[80:95]
  ds_read_b64_tr_b16 v[132:133], v163 offset:43048
  ds_read_b64_tr_b16 v[134:135], v163 offset:44840
  s_waitcnt lgkmcnt(4)
  v_mfma_f32_32x32x16_bf16 v[96:111], a[52:55], v[152:155], v[96:111]
  ds_read_b64_tr_b16 v[136:137], v164 offset:43008
  ds_read_b64_tr_b16 v[138:139], v164 offset:44800
  s_add_u32 m0, s65, 32768
  v_mfma_f32_32x32x16_bf16 v[112:127], a[52:55], v[156:159], v[112:127]
  ds_read_b64_tr_b16 v[140:141], v165 offset:43008
  ds_read_b64_tr_b16 v[142:143], v165 offset:44800
  buffer_load_dwordx4 v28, s[8:11], s64 offen offset:0 lds
  s_waitcnt lgkmcnt(4)
  v_mfma_f32_32x32x16_bf16 v[64:79], v[128:131], a[56:59], v[64:79]
  ds_read_b64_tr_b16 v[144:145], v163 offset:50176
  ds_read_b64_tr_b16 v[146:147], v163 offset:51968
  buffer_load_dwordx4 v29, s[8:11], s64 offen offset:1024 lds
  v_mfma_f32_32x32x16_bf16 v[80:95], v[132:135], a[56:59], v[80:95]
  ds_read_b64_tr_b16 v[148:149], v163 offset:50216
  ds_read_b64_tr_b16 v[150:151], v163 offset:52008
  s_waitcnt lgkmcnt(4)
  v_mfma_f32_32x32x16_bf16 v[96:111], a[56:59], v[136:139], v[96:111]
  ds_read_b64_tr_b16 v[152:153], v164 offset:50176
  ds_read_b64_tr_b16 v[154:155], v164 offset:51968
  buffer_load_dwordx4 v30, s[8:11], s64 offen offset:2048 lds
  v_mfma_f32_32x32x16_bf16 v[112:127], a[56:59], v[140:143], v[112:127]
  ds_read_b64_tr_b16 v[156:157], v165 offset:50176
  ds_read_b64_tr_b16 v[158:159], v165 offset:51968
  s_waitcnt lgkmcnt(4)
  v_mfma_f32_32x32x16_bf16 v[64:79], v[144:147], a[60:63], v[64:79]
  s_waitcnt vmcnt(14)
  s_barrier
  ds_read_b64_tr_b16 v[128:129], v166 offset:0
  ds_read_b64_tr_b16 v[130:131], v166 offset:1792
  v_mfma_f32_32x32x16_bf16 v[80:95], v[148:151], a[60:63], v[80:95]
  ds_read_b64_tr_b16 v[132:133], v166 offset:40
  ds_read_b64_tr_b16 v[134:135], v166 offset:1832
  s_add_u32 s64, s64, 221184
  s_waitcnt lgkmcnt(4)
  v_mfma_f32_32x32x16_bf16 v[96:111], a[60:63], v[152:155], v[96:111]
  ds_read_b64_tr_b16 v[136:137], v167 offset:0
  ds_read_b64_tr_b16 v[138:139], v167 offset:1792
  v_mfma_f32_32x32x16_bf16 v[112:127], a[60:63], v[156:159], v[112:127]
  ds_read_b64_tr_b16 v[140:141], v168 offset:0
  ds_read_b64_tr_b16 v[142:143], v168 offset:1792
  s_add_u32 m0, s65, 57344
  s_waitcnt lgkmcnt(4)
  v_mfma_f32_32x32x16_bf16 v[64:79], v[128:131], a[64:67], v[64:79]
  ds_read_b64_tr_b16 v[144:145], v166 offset:7168
  ds_read_b64_tr_b16 v[146:147], v166 offset:8960
  buffer_load_dwordx4 v24, s[8:11], s64 offen offset:0 lds
  v_mfma_f32_32x32x16_bf16 v[80:95], v[132:135], a[64:67], v[80:95]
  ds_read_b64_tr_b16 v[148:149], v166 offset:7208
  ds_read_b64_tr_b16 v[150:151], v166 offset:9000
  buffer_load_dwordx4 v25, s[8:11], s64 offen offset:1024 lds
  s_waitcnt lgkmcnt(4)
  v_mfma_f32_32x32x16_bf16 v[96:111], a[64:67], v[136:139], v[96:111]
  ds_read_b64_tr_b16 v[152:153], v167 offset:7168
  ds_read_b64_tr_b16 v[154:155], v167 offset:8960
  v_mfma_f32_32x32x16_bf16 v[112:127], a[64:67], v[140:143], v[112:127]
  ds_read_b64_tr_b16 v[156:157], v168 offset:7168
  ds_read_b64_tr_b16 v[158:159], v168 offset:8960
  buffer_load_dwordx4 v26, s[8:11], s64 offen offset:2048 lds
  s_waitcnt lgkmcnt(4)
  v_mfma_f32_32x32x16_bf16 v[64:79], v[144:147], a[68:71], v[64:79]
  ds_read_b64_tr_b16 v[128:129], v166 offset:14336
  ds_read_b64_tr_b16 v[130:131], v166 offset:16128
  buffer_load_dwordx4 v27, s[8:11], s64 offen offset:3072 lds
  v_mfma_f32_32x32x16_bf16 v[80:95], v[148:151], a[68:71], v[80:95]
  ds_read_b64_tr_b16 v[132:133], v166 offset:14376
  ds_read_b64_tr_b16 v[134:135], v166 offset:16168
  s_waitcnt lgkmcnt(4)
  v_mfma_f32_32x32x16_bf16 v[96:111], a[68:71], v[152:155], v[96:111]
  ds_read_b64_tr_b16 v[136:137], v167 offset:14336
  ds_read_b64_tr_b16 v[138:139], v167 offset:16128
  s_add_u32 m0, s65, 61440
  v_mfma_f32_32x32x16_bf16 v[112:127], a[68:71], v[156:159], v[112:127]
  ds_read_b64_tr_b16 v[140:141], v168 offset:14336
  ds_read_b64_tr_b16 v[142:143], v168 offset:16128
  buffer_load_dwordx4 v28, s[8:11], s64 offen offset:0 lds
  s_waitcnt lgkmcnt(4)
  v_mfma_f32_32x32x16_bf16 v[64:79], v[128:131], a[72:75], v[64:79]
  ds_read_b64_tr_b16 v[144:145], v166 offset:21504
  ds_read_b64_tr_b16 v[146:147], v166 offset:23296
  buffer_load_dwordx4 v29, s[8:11], s64 offen offset:1024 lds
  v_mfma_f32_32x32x16_bf16 v[80:95], v[132:135], a[72:75], v[80:95]
  ds_read_b64_tr_b16 v[148:149], v166 offset:21544
  ds_read_b64_tr_b16 v[150:151], v166 offset:23336
  s_waitcnt lgkmcnt(4)
  v_mfma_f32_32x32x16_bf16 v[96:111], a[72:75], v[136:139], v[96:111]
  ds_read_b64_tr_b16 v[152:153], v167 offset:21504
  ds_read_b64_tr_b16 v[154:155], v167 offset:23296
  buffer_load_dwordx4 v30, s[8:11], s64 offen offset:2048 lds
  v_mfma_f32_32x32x16_bf16 v[112:127], a[72:75], v[140:143], v[112:127]
  ds_read_b64_tr_b16 v[156:157], v168 offset:21504
  ds_read_b64_tr_b16 v[158:159], v168 offset:23296
  s_waitcnt lgkmcnt(4)
  v_mfma_f32_32x32x16_bf16 v[64:79], v[144:147], a[76:79], v[64:79]
  s_waitcnt vmcnt(14)
  s_barrier
  ds_read_b64_tr_b16 v[128:129], v160 offset:0
  ds_read_b64_tr_b16 v[130:131], v160 offset:1792
  v_mfma_f32_32x32x16_bf16 v[80:95], v[148:151], a[76:79], v[80:95]
  ds_read_b64_tr_b16 v[132:133], v160 offset:40
  ds_read_b64_tr_b16 v[134:135], v160 offset:1832
  s_add_u32 s64, s64, 221184
  s_waitcnt lgkmcnt(4)
  v_mfma_f32_32x32x16_bf16 v[96:111], a[76:79], v[152:155], v[96:111]
  ds_read_b64_tr_b16 v[136:137], v161 offset:0
  ds_read_b64_tr_b16 v[138:139], v161 offset:1792
  v_mfma_f32_32x32x16_bf16 v[112:127], a[76:79], v[156:159], v[112:127]
  ds_read_b64_tr_b16 v[140:141], v162 offset:0
  ds_read_b64_tr_b16 v[142:143], v162 offset:1792
  s_add_u32 m0, s65, 86016
  s_waitcnt lgkmcnt(4)
  v_mfma_f32_32x32x16_bf16 v[64:79], v[128:131], a[80:83], v[64:79]
  ds_read_b64_tr_b16 v[144:145], v160 offset:7168
  ds_read_b64_tr_b16 v[146:147], v160 offset:8960
  buffer_load_dwordx4 v24, s[8:11], s64 offen offset:0 lds
  v_mfma_f32_32x32x16_bf16 v[80:95], v[132:135], a[80:83], v[80:95]
  ds_read_b64_tr_b16 v[148:149], v160 offset:7208
  ds_read_b64_tr_b16 v[150:151], v160 offset:9000
  buffer_load_dwordx4 v25, s[8:11], s64 offen offset:1024 lds
  s_waitcnt lgkmcnt(4)
  v_mfma_f32_32x32x16_bf16 v[96:111], a[80:83], v[136:139], v[96:111]
  ds_read_b64_tr_b16 v[152:153], v161 offset:7168
  ds_read_b64_tr_b16 v[154:155], v161 offset:8960
  v_mfma_f32_32x32x16_bf16 v[112:127], a[80:83], v[140:143], v[112:127]
  ds_read_b64_tr_b16 v[156:157], v162 offset:7168
  ds_read_b64_tr_b16 v[158:159], v162 offset:8960
  buffer_load_dwordx4 v26, s[8:11], s64 offen offset:2048 lds
  s_waitcnt lgkmcnt(4)
  v_mfma_f32_32x32x16_bf16 v[64:79], v[144:147], a[84:87], v[64:79]
  ds_read_b64_tr_b16 v[128:129], v160 offset:14336
  ds_read_b64_tr_b16 v[130:131], v160 offset:16128
  buffer_load_dwordx4 v27, s[8:11], s64 offen offset:3072 lds
  v_mfma_f32_32x32x16_bf16 v[80:95], v[148:151], a[84:87], v[80:95]
  ds_read_b64_tr_b16 v[132:133], v160 offset:14376
  ds_read_b64_tr_b16 v[134:135], v160 offset:16168
  s_waitcnt lgkmcnt(4)
  v_mfma_f32_32x32x16_bf16 v[96:111], a[84:87], v[152:155], v[96:111]
  ds_read_b64_tr_b16 v[136:137], v161 offset:14336
  ds_read_b64_tr_b16 v[138:139], v161 offset:16128
  s_add_u32 m0, s65, 90112
  v_mfma_f32_32x32x16_bf16 v[112:127], a[84:87], v[156:159], v[112:127]
  ds_read_b64_tr_b16 v[140:141], v162 offset:14336
  ds_read_b64_tr_b16 v[142:143], v162 offset:16128
  buffer_load_dwordx4 v28, s[8:11], s64 offen offset:0 lds
  s_waitcnt lgkmcnt(4)
  v_mfma_f32_32x32x16_bf16 v[64:79], v[128:131], a[88:91], v[64:79]
  ds_read_b64_tr_b16 v[144:145], v160 offset:21504
  ds_read_b64_tr_b16 v[146:147], v160 offset:23296
  buffer_load_dwordx4 v29, s[8:11], s64 offen offset:1024 lds
  v_mfma_f32_32x32x16_bf16 v[80:95], v[132:135], a[88:91], v[80:95]
  ds_read_b64_tr_b16 v[148:149], v160 offset:21544
  ds_read_b64_tr_b16 v[150:151], v160 offset:23336
  s_waitcnt lgkmcnt(4)
  v_mfma_f32_32x32x16_bf16 v[96:111], a[88:91], v[136:139], v[96:111]
  ds_read_b64_tr_b16 v[152:153], v161 offset:21504
  ds_read_b64_tr_b16 v[154:155], v161 offset:23296
  buffer_load_dwordx4 v30, s[8:11], s64 offen offset:2048 lds
  v_mfma_f32_32x32x16_bf16 v[112:127], a[88:91], v[140:143], v[112:127]
  ds_read_b64_tr_b16 v[156:157], v162 offset:21504
  ds_read_b64_tr_b16 v[158:159], v162 offset:23296
  s_waitcnt lgkmcnt(4)
  v_mfma_f32_32x32x16_bf16 v[64:79], v[144:147], a[92:95], v[64:79]
  s_waitcnt vmcnt(14)
  s_barrier
  ds_read_b64_tr_b16 v[128:129], v160 offset:28672
  ds_read_b64_tr_b16 v[130:131], v160 offset:30464
  v_mfma_f32_32x32x16_bf16 v[80:95], v[148:151], a[92:95], v[80:95]
  ds_read_b64_tr_b16 v[132:133], v160 offset:28712
  ds_read_b64_tr_b16 v[134:135], v160 offset:30504
  s_waitcnt lgkmcnt(4)
  v_mfma_f32_32x32x16_bf16 v[96:111], a[92:95], v[152:155], v[96:111]
  ds_read_b64_tr_b16 v[136:137], v161 offset:28672
  ds_read_b64_tr_b16 v[138:139], v161 offset:30464
  v_mfma_f32_32x32x16_bf16 v[112:127], a[92:95], v[156:159], v[112:127]
  ds_read_b64_tr_b16 v[140:141], v162 offset:28672
  ds_read_b64_tr_b16 v[142:143], v162 offset:30464
  s_waitcnt lgkmcnt(4)
  v_mfma_f32_32x32x16_bf16 v[64:79], v[128:131], a[96:99], v[64:79]
  ds_read_b64_tr_b16 v[144:145], v160 offset:35840
  ds_read_b64_tr_b16 v[146:147], v160 offset:37632
  v_mfma_f32_32x32x16_bf16 v[80:95], v[132:135], a[96:99], v[80:95]
  ds_read_b64_tr_b16 v[148:149], v160 offset:35880
  ds_read_b64_tr_b16 v[150:151], v160 offset:37672
  s_waitcnt lgkmcnt(4)
  v_mfma_f32_32x32x16_bf16 v[96:111], a[96:99], v[136:139], v[96:111]
  ds_read_b64_tr_b16 v[152:153], v161 offset:35840
  ds_read_b64_tr_b16 v[154:155], v161 offset:37632
  v_mfma_f32_32x32x16_bf16 v[112:127], a[96:99], v[140:143], v[112:127]
  ds_read_b64_tr_b16 v[156:157], v162 offset:35840
  ds_read_b64_tr_b16 v[158:159], v162 offset:37632
  s_waitcnt lgkmcnt(4)
  v_mfma_f32_32x32x16_bf16 v[64:79], v[144:147], a[100:103], v[64:79]
  ds_read_b64_tr_b16 v[128:129], v160 offset:43008
  ds_read_b64_tr_b16 v[130:131], v160 offset:44800
  v_mfma_f32_32x32x16_bf16 v[80:95], v[148:151], a[100:103], v[80:95]
  ds_read_b64_tr_b16 v[132:133], v160 offset:43048
  ds_read_b64_tr_b16 v[134:135], v160 offset:44840
  s_waitcnt lgkmcnt(4)
  v_mfma_f32_32x32x16_bf16 v[96:111], a[100:103], v[152:155], v[96:111]
  ds_read_b64_tr_b16 v[136:137], v161 offset:43008
  ds_read_b64_tr_b16 v[138:139], v161 offset:44800
  v_mfma_f32_32x32x16_bf16 v[112:127], a[100:103], v[156:159], v[112:127]
  ds_read_b64_tr_b16 v[140:141], v162 offset:43008
  ds_read_b64_tr_b16 v[142:143], v162 offset:44800
  s_waitcnt lgkmcnt(4)
  v_mfma_f32_32x32x16_bf16 v[64:79], v[128:131], a[104:107], v[64:79]
  ds_read_b64_tr_b16 v[144:145], v160 offset:50176
  ds_read_b64_tr_b16 v[146:147], v160 offset:51968
  v_mfma_f32_32x32x16_bf16 v[80:95], v[132:135], a[104:107], v[80:95]
  ds_read_b64_tr_b16 v[148:149], v160 offset:50216
  ds_read_b64_tr_b16 v[150:151], v160 offset:52008
  s_waitcnt lgkmcnt(4)
  v_mfma_f32_32x32x16_bf16 v[96:111], a[104:107], v[136:139], v[96:111]
  ds_read_b64_tr_b16 v[152:153], v161 offset:50176
  ds_read_b64_tr_b16 v[154:155], v161 offset:51968
  v_mfma_f32_32x32x16_bf16 v[112:127], a[104:107], v[140:143], v[112:127]
  ds_read_b64_tr_b16 v[156:157], v162 offset:50176
  ds_read_b64_tr_b16 v[158:159], v162 offset:51968
  s_waitcnt lgkmcnt(4)
  v_mfma_f32_32x32x16_bf16 v[64:79], v[144:147], a[108:111], v[64:79]
  s_waitcnt vmcnt(7)
  s_barrier
  ds_read_b64_tr_b16 v[128:129], v163 offset:0
  ds_read_b64_tr_b16 v[130:131], v163 offset:1792
  v_mfma_f32_32x32x16_bf16 v[80:95], v[148:151], a[108:111], v[80:95]
  ds_read_b64_tr_b16 v[132:133], v163 offset:40
  ds_read_b64_tr_b16 v[134:135], v163 offset:1832
  s_waitcnt lgkmcnt(4)
  v_mfma_f32_32x32x16_bf16 v[96:111], a[108:111], v[152:155], v[96:111]
  ds_read_b64_tr_b16 v[136:137], v164 offset:0
  ds_read_b64_tr_b16 v[138:139], v164 offset:1792
  s_lshl_b32 s54, s44, 2
  s_sub_u32 s54, s54, 16
  v_lshrrev_b32 v254, 2, v1
  v_add_u32 v254, s54, v254
  buffer_load_dword v255, v254, s[40:43], 0 offen sc1
  v_mfma_f32_32x32x16_bf16 v[112:127], a[108:111], v[156:159], v[112:127]
  ds_read_b64_tr_b16 v[140:141], v165 offset:0
  ds_read_b64_tr_b16 v[142:143], v165 offset:1792
  s_waitcnt lgkmcnt(4)
  v_mfma_f32_32x32x16_bf16 v[64:79], v[128:131], a[112:115], v[64:79]
  ds_read_b64_tr_b16 v[144:145], v163 offset:7168
  ds_read_b64_tr_b16 v[146:147], v163 offset:8960
  v_mfma_f32_32x32x16_bf16 v[80:95], v[132:135], a[112:115], v[80:95]
  ds_read_b64_tr_b16 v[148:149], v163 offset:7208
  ds_read_b64_tr_b16 v[150:151], v163 offset:9000
  s_waitcnt lgkmcnt(4)
  v_mfma_f32_32x32x16_bf16 v[96:111], a[112:115], v[136:139], v[96:111]
  ds_read_b64_tr_b16 v[152:153], v164 offset:7168
  ds_read_b64_tr_b16 v[154:155], v164 offset:8960
  v_mfma_f32_32x32x16_bf16 v[112:127], a[112:115], v[140:143], v[112:127]
  ds_read_b64_tr_b16 v[156:157], v165 offset:7168
  ds_read_b64_tr_b16 v[158:159], v165 offset:8960
  s_waitcnt lgkmcnt(4)
  v_mfma_f32_32x32x16_bf16 v[64:79], v[144:147], a[116:119], v[64:79]
  ds_read_b64_tr_b16 v[128:129], v163 offset:14336
  ds_read_b64_tr_b16 v[130:131], v163 offset:16128
  v_mfma_f32_32x32x16_bf16 v[80:95], v[148:151], a[116:119], v[80:95]
  ds_read_b64_tr_b16 v[132:133], v163 offset:14376
  ds_read_b64_tr_b16 v[134:135], v163 offset:16168
  s_waitcnt lgkmcnt(4)
  v_mfma_f32_32x32x16_bf16 v[96:111], a[116:119], v[152:155], v[96:111]
  ds_read_b64_tr_b16 v[136:137], v164 offset:14336
  ds_read_b64_tr_b16 v[138:139], v164 offset:16128
  v_mfma_f32_32x32x16_bf16 v[112:127], a[116:119], v[156:159], v[112:127]
  ds_read_b64_tr_b16 v[140:141], v165 offset:14336
  ds_read_b64_tr_b16 v[142:143], v165 offset:16128
  s_waitcnt lgkmcnt(4)
  v_mfma_f32_32x32x16_bf16 v[64:79], v[128:131], a[120:123], v[64:79]
  ds_read_b64_tr_b16 v[144:145], v163 offset:21504
  ds_read_b64_tr_b16 v[146:147], v163 offset:23296
  v_mfma_f32_32x32x16_bf16 v[80:95], v[132:135], a[120:123], v[80:95]
  ds_read_b64_tr_b16 v[148:149], v163 offset:21544
  ds_read_b64_tr_b16 v[150:151], v163 offset:23336
  s_waitcnt lgkmcnt(4)
  v_mfma_f32_32x32x16_bf16 v[96:111], a[120:123], v[136:139], v[96:111]
  ds_read_b64_tr_b16 v[152:153], v164 offset:21504
  ds_read_b64_tr_b16 v[154:155], v164 offset:23296
  v_mfma_f32_32x32x16_bf16 v[112:127], a[120:123], v[140:143], v[112:127]
  ds_read_b64_tr_b16 v[156:157], v165 offset:21504
  ds_read_b64_tr_b16 v[158:159], v165 offset:23296
  s_waitcnt lgkmcnt(4)
  v_mfma_f32_32x32x16_bf16 v[64:79], v[144:147], a[124:127], v[64:79]
  s_waitcnt vmcnt(1)
  s_barrier
  ds_read_b64_tr_b16 v[128:129], v163 offset:28672
  ds_read_b64_tr_b16 v[130:131], v163 offset:30464
  v_mfma_f32_32x32x16_bf16 v[80:95], v[148:151], a[124:127], v[80:95]
  ds_read_b64_tr_b16 v[132:133], v163 offset:28712
  ds_read_b64_tr_b16 v[134:135], v163 offset:30504
  s_waitcnt lgkmcnt(4)
  v_mfma_f32_32x32x16_bf16 v[96:111], a[124:127], v[152:155], v[96:111]
  ds_read_b64_tr_b16 v[136:137], v164 offset:28672
  ds_read_b64_tr_b16 v[138:139], v164 offset:30464
  v_mfma_f32_32x32x16_bf16 v[112:127], a[124:127], v[156:159], v[112:127]
  ds_read_b64_tr_b16 v[140:141], v165 offset:28672
  ds_read_b64_tr_b16 v[142:143], v165 offset:30464
  s_waitcnt lgkmcnt(4)
  v_mfma_f32_32x32x16_bf16 v[64:79], v[128:131], a[128:131], v[64:79]
  ds_read_b64_tr_b16 v[144:145], v163 offset:35840
  ds_read_b64_tr_b16 v[146:147], v163 offset:37632
  v_mfma_f32_32x32x16_bf16 v[80:95], v[132:135], a[128:131], v[80:95]
  ds_read_b64_tr_b16 v[148:149], v163 offset:35880
  ds_read_b64_tr_b16 v[150:151], v163 offset:37672
  s_waitcnt lgkmcnt(4)
  v_mfma_f32_32x32x16_bf16 v[96:111], a[128:131], v[136:139], v[96:111]
  ds_read_b64_tr_b16 v[152:153], v164 offset:35840
  ds_read_b64_tr_b16 v[154:155], v164 offset:37632
  v_mfma_f32_32x32x16_bf16 v[112:127], a[128:131], v[140:143], v[112:127]
  ds_read_b64_tr_b16 v[156:157], v165 offset:35840
  ds_read_b64_tr_b16 v[158:159], v165 offset:37632
  s_waitcnt lgkmcnt(4)
  v_mfma_f32_32x32x16_bf16 v[64:79], v[144:147], a[132:135], v[64:79]
  ds_read_b64_tr_b16 v[128:129], v163 offset:43008
  ds_read_b64_tr_b16 v[130:131], v163 offset:44800
  v_mfma_f32_32x32x16_bf16 v[80:95], v[148:151], a[132:135], v[80:95]
  ds_read_b64_tr_b16 v[132:133], v163 offset:43048
  ds_read_b64_tr_b16 v[134:135], v163 offset:44840
  s_waitcnt lgkmcnt(4)
  v_mfma_f32_32x32x16_bf16 v[96:111], a[132:135], v[152:155], v[96:111]
  ds_read_b64_tr_b16 v[136:137], v164 offset:43008
  ds_read_b64_tr_b16 v[138:139], v164 offset:44800
  v_mfma_f32_32x32x16_bf16 v[112:127], a[132:135], v[156:159], v[112:127]
  ds_read_b64_tr_b16 v[140:141], v165 offset:43008
  ds_read_b64_tr_b16 v[142:143], v165 offset:44800
  s_waitcnt lgkmcnt(4)
  v_mfma_f32_32x32x16_bf16 v[64:79], v[128:131], a[136:139], v[64:79]
  ds_read_b64_tr_b16 v[144:145], v163 offset:50176
  ds_read_b64_tr_b16 v[146:147], v163 offset:51968
  v_mfma_f32_32x32x16_bf16 v[80:95], v[132:135], a[136:139], v[80:95]
  ds_read_b64_tr_b16 v[148:149], v163 offset:50216
  ds_read_b64_tr_b16 v[150:151], v163 offset:52008
  s_waitcnt lgkmcnt(4)
  v_mfma_f32_32x32x16_bf16 v[96:111], a[136:139], v[136:139], v[96:111]
  ds_read_b64_tr_b16 v[152:153], v164 offset:50176
  ds_read_b64_tr_b16 v[154:155], v164 offset:51968
  v_mfma_f32_32x32x16_bf16 v[112:127], a[136:139], v[140:143], v[112:127]
  ds_read_b64_tr_b16 v[156:157], v165 offset:50176
  ds_read_b64_tr_b16 v[158:159], v165 offset:51968
  s_waitcnt lgkmcnt(4)
  v_mfma_f32_32x32x16_bf16 v[64:79], v[144:147], a[140:143], v[64:79]
  v_mfma_f32_32x32x16_bf16 v[80:95], v[148:151], a[140:143], v[80:95]
  s_waitcnt lgkmcnt(0)
  v_mfma_f32_32x32x16_bf16 v[96:111], a[140:143], v[152:155], v[96:111]
  v_mfma_f32_32x32x16_bf16 v[112:127], a[140:143], v[156:159], v[112:127]
Llayer:
  v_mov_b32 v56, 0x3eae1a93
  v_mov_b32 v57, 1.0
  v_and_b32 v58, 28, v2
  v_cmp_eq_u32 vcc, 20, v58
  s_nop 1
  v_cndmask_b32 v57, v57, v56, vcc
  s_lshl_b32 s54, s45, 2
  s_lshl_b32 s55, s48, 1
  s_add_u32 s54, s54, s55
  s_lshl_b32 s54, s54, 6
  s_lshl_b32 s55, s44, 1
  s_add_u32 s55, s55, s47
  s_add_u32 s54, s54, s55
  s_lshl_b32 s56, s54, 10
  s_add_u32 s56, s56, s50
  s_add_u32 s57, s56, 65536
  s_lshl_b32 s58, s54, 11
  s_add_u32 s58, s58, s50
  s_add_u32 s58, s58, 2621440
  s_add_u32 s59, s58, 131072
  s_lshl_b32 s60, s45, 1
  s_add_u32 s60, s60, s48
  s_lshl_b32 s60, s60, 6
  s_add_u32 s60, s60, s55
  s_lshl_b32 s60, s60, 8
  s_add_u32 s60, s60, s50
  s_add_u32 s60, s60, 2097152
  v_cvt_pk_bf16_f32 v128, v72, v73
  v_cvt_pk_bf16_f32 v129, v74, v75
  v_cvt_pk_bf16_f32 v130, v76, v77
  v_cvt_pk_bf16_f32 v131, v78, v79
  buffer_store_dwordx4 v[128:131], v1, s[32:35], s56 offen sc1
  v_cvt_pk_bf16_f32 v132, v88, v89
  v_cvt_pk_bf16_f32 v133, v90, v91
  v_cvt_pk_bf16_f32 v134, v92, v93
  v_cvt_pk_bf16_f32 v135, v94, v95
  buffer_store_dwordx4 v[132:135], v1, s[32:35], s57 offen sc1
  v_mul_f32 v96, v96, v57
  v_mul_f32 v97, v97, v57
  v_mul_f32 v98, v98, v57
  v_mul_f32 v99, v99, v57
  v_mul_f32 v100, v100, v57
  v_mul_f32 v101, v101, v57
  v_mul_f32 v102, v102, v57
  v_mul_f32 v103, v103, v57
  v_mul_f32 v104, v104, v57
  v_mul_f32 v105, v105, v57
  v_mul_f32 v106, v106, v57
  v_mul_f32 v107, v107, v57
  v_mul_f32 v108, v108, v57
  v_mul_f32 v109, v109, v57
  v_mul_f32 v110, v110, v57
  v_mul_f32 v111, v111, v57
  v_cvt_pk_bf16_f32 v136, v96, v97
  v_cvt_pk_bf16_f32 v137, v98, v99
  v_cvt_pk_bf16_f32 v138, v100, v101
  v_cvt_pk_bf16_f32 v139, v102, v103
  v_cvt_pk_bf16_f32 v140, v104, v105
  v_cvt_pk_bf16_f32 v141, v106, v107
  v_cvt_pk_bf16_f32 v142, v108, v109
  v_cvt_pk_bf16_f32 v143, v110, v111
  v_cvt_pk_bf16_f32 v144, v112, v113
  v_cvt_pk_bf16_f32 v145, v114, v115
  v_cvt_pk_bf16_f32 v146, v116, v117
  v_cvt_pk_bf16_f32 v147, v118, v119
  v_cvt_pk_bf16_f32 v148, v120, v121
  v_cvt_pk_bf16_f32 v149, v122, v123
  v_cvt_pk_bf16_f32 v150, v124, v125
  v_cvt_pk_bf16_f32 v151, v126, v127
  v_mfma_f32_32x32x16_bf16 v[96:111], v[136:139], a[168:171], 0
  v_mfma_f32_32x32x16_bf16 v[96:111], v[140:143], a[172:175], v[96:111]
  s_mov_b32 exec_lo, 16777215
  s_mov_b32 exec_hi, 16777215
  buffer_store_dwordx4 v[136:139], v1, s[32:35], s58 offen offset:0 sc1
  buffer_store_dwordx4 v[140:143], v1, s[32:35], s58 offen offset:1024 sc1
  buffer_store_dwordx4 v[144:147], v1, s[32:35], s59 offen offset:0 sc1
  buffer_store_dwordx4 v[148:151], v1, s[32:35], s59 offen offset:1024 sc1
  s_mov_b64 exec, -1
  v_lshlrev_b32 v59, 3, v2
  s_nop 3
  v_cvt_pk_bf16_f32 v162, v108, v109
  v_cvt_pk_bf16_f32 v163, v110, v111
  s_mov_b32 exec_lo, -1
  s_mov_b32 exec_hi, 0
  buffer_store_dwordx2 v[162:163], v59, s[32:35], s60 offen sc1
  s_mov_b64 exec, -1
  s_lshl_b32 s54, s48, 2
  s_add_u32 s54, s54, s47
  s_lshl_b32 s54, s54, 10
  v_add_u32 v58, s54, v1
  v_mul_f32 v64, v64, v56
  v_mul_f32 v65, v65, v56
  v_mul_f32 v66, v66, v56
  v_mul_f32 v67, v67, v56
  v_mul_f32 v68, v68, v56
  v_mul_f32 v69, v69, v56
  v_mul_f32 v70, v70, v56
  v_mul_f32 v71, v71, v56
  v_cvt_pk_bf16_f32 v152, v64, v65
  v_cvt_pk_bf16_f32 v153, v66, v67
  v_cvt_pk_bf16_f32 v154, v68, v69
  v_cvt_pk_bf16_f32 v155, v70, v71
  ds_write_b128 v58, v[152:155] offset:0
  v_mul_f32 v80, v80, v56
  v_mul_f32 v81, v81, v56
  v_mul_f32 v82, v82, v56
  v_mul_f32 v83, v83, v56
  v_mul_f32 v84, v84, v56
  v_mul_f32 v85, v85, v56
  v_mul_f32 v86, v86, v56
  v_mul_f32 v87, v87, v56
  v_cvt_pk_bf16_f32 v156, v80, v81
  v_cvt_pk_bf16_f32 v157, v82, v83
  v_cvt_pk_bf16_f32 v158, v84, v85
  v_cvt_pk_bf16_f32 v159, v86, v87
  ds_write_b128 v58, v[156:159] offset:2048
  s_lshl_b32 s54, s48, 1
  s_add_u32 s54, s54, s47
  s_lshl_b32 s54, s54, 8
  s_add_u32 s54, s54, 8192
  v_lshlrev_b32 v59, 3, v2
  v_add_u32 v58, s54, v59
  v_cvt_pk_bf16_f32 v160, v104, v105
  v_cvt_pk_bf16_f32 v161, v106, v107
  s_mov_b32 exec_lo, 0
  s_mov_b32 exec_hi, -1
  ds_write_b64 v58, v[160:161]
  s_mov_b64 exec, -1
  v_lshrrev_b32 v56, 4, v1
  v_mul_u32_u24 v57, 7282, v56
  v_lshrrev_b32 v57, 16, v57
  v_mul_u32_u24 v57, 1008, v57
  v_add_u32 v220, v57, v1
  v_add_u32 v221, 7056, v220
  v_add_u32 v222, 14112, v220
  v_add_u32 v223, 21168, v220
  s_waitcnt vmcnt(0) lgkmcnt(0)
  s_mul_i32 s68, s49, 196608
  s_lshl_b32 s69, s44, 10
  s_add_u32 s68, s68, s69
  s_add_u32 s68, s68, 0
  s_lshl_b32 s69, s45, 7
  s_add_u32 s68, s68, s69
  s_barrier
  s_cmp_lg_u32 s46, 0
  s_cbranch_scc1 Lsig1
  s_mov_b32 exec_lo, 1
  s_mov_b32 exec_hi, 0
  v_mov_b32 v62, 1
  buffer_store_dword v62, v19, s[32:35], s68 offen sc1
  s_mov_b64 exec, -1
Lsig1:
  s_lshl_b32 s54, s46, 11
  v_add_u32 v58, s54, v1
  s_lshl_b32 s54, s47, 9
  s_add_u32 s54, s54, 8192
  v_add_u32 v60, s54, v59
  ds_read_b128 v[32:35], v58 offset:0
  ds_read_b64 v[40:41], v60 offset:0
  ds_read_b128 v[36:39], v58 offset:1024
  ds_read_b64 v[44:45], v60 offset:256
  v_accvgpr_write_b32 a40, s52
  v_accvgpr_write_b32 a41, s52
  v_accvgpr_write_b32 a42, s52
  v_accvgpr_write_b32 a43, s52
  v_accvgpr_write_b32 a44, s52
  v_accvgpr_write_b32 a45, s52
  v_accvgpr_write_b32 a46, s52
  v_accvgpr_write_b32 a47, s52
  v_accvgpr_write_b32 a48, s52
  v_accvgpr_write_b32 a49, s52
  v_accvgpr_write_b32 a50, s52
  v_accvgpr_write_b32 a51, s52
  v_accvgpr_write_b32 a52, s52
  v_accvgpr_write_b32 a53, s52
  v_accvgpr_write_b32 a54, s52
  v_accvgpr_write_b32 a55, s52
  v_accvgpr_write_b32 a56, s52
  v_accvgpr_write_b32 a57, s52
  v_accvgpr_write_b32 a58, s52
  v_accvgpr_write_b32 a59, s52
  v_accvgpr_write_b32 a60, s52
  v_accvgpr_write_b32 a61, s52
  v_accvgpr_write_b32 a62, s52
  v_accvgpr_write_b32 a63, s52
  v_accvgpr_write_b32 a64, s52
  v_accvgpr_write_b32 a65, s52
  v_accvgpr_write_b32 a66, s52
  v_accvgpr_write_b32 a67, s52
  v_accvgpr_write_b32 a68, s52
  v_accvgpr_write_b32 a69, s52
  v_accvgpr_write_b32 a70, s52
  v_accvgpr_write_b32 a71, s52
  v_accvgpr_write_b32 a72, s52
  v_accvgpr_write_b32 a73, s52
  v_accvgpr_write_b32 a74, s52
  v_accvgpr_write_b32 a75, s52
  v_accvgpr_write_b32 a76, s52
  v_accvgpr_write_b32 a77, s52
  v_accvgpr_write_b32 a78, s52
  v_accvgpr_write_b32 a79, s52
  v_accvgpr_write_b32 a80, s52
  v_accvgpr_write_b32 a81, s52
  v_accvgpr_write_b32 a82, s52
  v_accvgpr_write_b32 a83, s52
  v_accvgpr_write_b32 a84, s52
  v_accvgpr_write_b32 a85, s52
  v_accvgpr_write_b32 a86, s52
  v_accvgpr_write_b32 a87, s52
  v_accvgpr_write_b32 a88, s52
  v_accvgpr_write_b32 a89, s52
  v_accvgpr_write_b32 a90, s52
  v_accvgpr_write_b32 a91, s52
  v_accvgpr_write_b32 a92, s52
  v_accvgpr_write_b32 a93, s52
  v_accvgpr_write_b32 a94, s52
  v_accvgpr_write_b32 a95, s52
  v_accvgpr_write_b32 a96, s52
  v_accvgpr_write_b32 a97, s52
  v_accvgpr_write_b32 a98, s52
  v_accvgpr_write_b32 a99, s52
  v_accvgpr_write_b32 a100, s52
  v_accvgpr_write_b32 a101, s52
  v_accvgpr_write_b32 a102, s52
  v_accvgpr_write_b32 a103, s52
  v_accvgpr_write_b32 a104, s52
  v_accvgpr_write_b32 a105, s52
  v_accvgpr_write_b32 a106, s52
  v_accvgpr_write_b32 a107, s52
  v_accvgpr_write_b32 a108, s52
  v_accvgpr_write_b32 a109, s52
  v_accvgpr_write_b32 a110, s52
  v_accvgpr_write_b32 a111, s52
  v_accvgpr_write_b32 a112, s52
  v_accvgpr_write_b32 a113, s52
  v_accvgpr_write_b32 a114, s52
  v_accvgpr_write_b32 a115, s52
  v_accvgpr_write_b32 a116, s52
  v_accvgpr_write_b32 a117, s52
  v_accvgpr_write_b32 a118, s52
  v_accvgpr_write_b32 a119, s52
  v_lshlrev_b32 v56, 2, v3
  v_sub_u32 v56, v2, v56
  v_mov_b32 v57, 4048155338
  v_cmp_le_i32 vcc, 0, v56
  s_nop 1
  v_cndmask_b32 v168, v57, 0, vcc
  v_cndmask_b32 v152, 0, v57, vcc
  v_cmp_le_i32 vcc, 1, v56
  s_nop 1
  v_cndmask_b32 v169, v57, 0, vcc
  v_cndmask_b32 v153, 0, v57, vcc
  v_cmp_le_i32 vcc, 2, v56
  s_nop 1
  v_cndmask_b32 v170, v57, 0, vcc
  v_cndmask_b32 v154, 0, v57, vcc
  v_cmp_le_i32 vcc, 3, v56
  s_nop 1
  v_cndmask_b32 v171, v57, 0, vcc
  v_cndmask_b32 v155, 0, v57, vcc
  v_cmp_le_i32 vcc, 8, v56
  s_nop 1
  v_cndmask_b32 v172, v57, 0, vcc
  v_cndmask_b32 v156, 0, v57, vcc
  v_cmp_le_i32 vcc, 9, v56
  s_nop 1
  v_cndmask_b32 v173, v57, 0, vcc
  v_cndmask_b32 v157, 0, v57, vcc
  v_cmp_le_i32 vcc, 10, v56
  s_nop 1
  v_cndmask_b32 v174, v57, 0, vcc
  v_cndmask_b32 v158, 0, v57, vcc
  v_cmp_le_i32 vcc, 11, v56
  s_nop 1
  v_cndmask_b32 v175, v57, 0, vcc
  v_cndmask_b32 v159, 0, v57, vcc
  v_cmp_le_i32 vcc, 16, v56
  s_nop 1
  v_cndmask_b32 v176, v57, 0, vcc
  v_cndmask_b32 v160, 0, v57, vcc
  v_cmp_le_i32 vcc, 17, v56
  s_nop 1
  v_cndmask_b32 v177, v57, 0, vcc
  v_cndmask_b32 v161, 0, v57, vcc
  v_cmp_le_i32 vcc, 18, v56
  s_nop 1
  v_cndmask_b32 v178, v57, 0, vcc
  v_cndmask_b32 v162, 0, v57, vcc
  v_cmp_le_i32 vcc, 19, v56
  s_nop 1
  v_cndmask_b32 v179, v57, 0, vcc
  v_cndmask_b32 v163, 0, v57, vcc
  v_cmp_le_i32 vcc, 24, v56
  s_nop 1
  v_cndmask_b32 v180, v57, 0, vcc
  v_cndmask_b32 v164, 0, v57, vcc
  v_cmp_le_i32 vcc, 25, v56
  s_nop 1
  v_cndmask_b32 v181, v57, 0, vcc
  v_cndmask_b32 v165, 0, v57, vcc
  v_cmp_le_i32 vcc, 26, v56
  s_nop 1
  v_cndmask_b32 v182, v57, 0, vcc
  v_cndmask_b32 v166, 0, v57, vcc
  v_cmp_le_i32 vcc, 27, v56
  s_nop 1
  v_cndmask_b32 v183, v57, 0, vcc
  v_cndmask_b32 v167, 0, v57, vcc
  s_lshl_b32 s55, s44, 1
  s_mov_b32 s56, 0x3f800000
  s_cmp_lt_u32 s55, 8
  s_cselect_b32 s54, s52, s56
  v_mov_b32 v232, s54
  v_mov_b32 v233, s52
  s_cmp_lt_u32 s55, 7
  s_cselect_b32 s54, s52, s56
  v_mov_b32 v234, s54
  v_mov_b32 v235, s52
  s_cmp_lt_u32 s55, 6
  s_cselect_b32 s54, s52, s56
  v_mov_b32 v236, s54
  v_mov_b32 v237, s52
  s_cmp_lt_u32 s55, 5
  s_cselect_b32 s54, s52, s56
  v_mov_b32 v238, s54
  v_mov_b32 v239, s52
  s_cmp_lt_u32 s55, 4
  s_cselect_b32 s54, s52, s56
  v_mov_b32 v240, s54
  v_mov_b32 v241, s52
  s_cmp_lt_u32 s55, 3
  s_cselect_b32 s54, s52, s56
  v_mov_b32 v242, s54
  v_mov_b32 v243, s52
  s_cmp_lt_u32 s55, 2
  s_cselect_b32 s54, s52, s56
  v_mov_b32 v244, s54
  v_mov_b32 v245, s52
  s_cmp_lt_u32 s55, 1
  s_cselect_b32 s54, s52, s56
  v_mov_b32 v246, s54
  v_mov_b32 v247, s52
  s_cmp_lt_u32 s55, 0
  s_cselect_b32 s54, s52, s56
  v_mov_b32 v248, s54
  v_mov_b32 v249, s52
  s_cmp_lt_u32 s55, 0
  s_cselect_b32 s54, s52, s56
  v_mov_b32 v250, s54
  v_mov_b32 v251, s52
  v_mov_b32 v252, 0
  v_mov_b32 v253, 0
  s_sub_u32 s54, s48, 1
  s_not_b32 s55, s54
  v_mov_b32 v57, 61769
  v_cmp_eq_u32 vcc, 0, v3
  s_waitcnt lgkmcnt(0)
  s_barrier
  v_and_b32 v40, s54, v40
  v_and_b32 v41, s55, v41
  v_cndmask_b32 v40, v57, v40, vcc
  v_cndmask_b32 v41, 0, v41, vcc
  v_mov_b32 v42, 0
  v_mov_b32 v43, 0
  v_and_b32 v44, s54, v44
  v_and_b32 v45, s55, v45
  v_cndmask_b32 v44, v57, v44, vcc
  v_cndmask_b32 v45, 0, v45, vcc
  v_mov_b32 v46, 0
  v_mov_b32 v47, 0
  s_min_u32 s66, s44, 4
  s_sub_u32 s66, 4, s66
  s_lshl_b32 s66, -1, s66
  s_and_b32 exec_lo, s66, 31
  s_mov_b32 exec_hi, 0
  v_cmp_ne_u32 vcc, 8, v255
  s_nop 1
  s_cbranch_vccz Lq2
Lp2:
  buffer_load_dword v62, v254, s[40:43], 0 offen sc1
  s_waitcnt vmcnt(0)
  v_cmp_ne_u32 vcc, 8, v62
  s_cmp_eq_u32 s51, 0
  s_cbranch_scc1 Lq2
  s_sub_u32 s51, s51, 1
  s_cbranch_vccnz Lp2
Lq2:
  s_mul_i32 s67, s49, 196608
  s_lshl_b32 s69, s44, 10
  s_add_u32 s67, s67, s69
  s_add_u32 s67, s67, 0
  s_lshl_b32 s69, s45, 7
  s_add_u32 s67, s67, s69
  s_sub_u32 s67, s67, 4096
  v_add_u32 v61, s67, v20
Lp3:
  buffer_load_dword v62, v61, s[32:35], 0 offen sc1
  s_waitcnt vmcnt(0)
  v_cmp_ne_u32 vcc, 1, v62
  s_cmp_eq_u32 s51, 0
  s_cbranch_scc1 Lq3
  s_sub_u32 s51, s51, 1
  s_cbranch_vccnz Lp3
Lq3:
  s_mov_b64 exec, -1
  s_lshl_b32 s54, s45, 2
  s_add_u32 s54, s54, s46
  s_lshl_b32 s54, s54, 6
  s_lshl_b32 s55, s44, 1
  s_add_u32 s54, s54, s55
  s_lshl_b32 s56, s54, 10
  s_add_u32 s56, s56, s50
  s_lshl_b32 s58, s54, 11
  s_add_u32 s58, s58, s50
  s_lshl_b32 s60, s45, 1
  s_add_u32 s60, s60, s47
  s_lshl_b32 s60, s60, 6
  s_add_u32 s60, s60, s55
  s_lshl_b32 s60, s60, 8
  s_add_u32 s60, s60, s50
  s_add_u32 s62, s56, 4294959104
  s_cmp_lt_u32 s55, 8
  s_cselect_b32 s62, 0x20000000, s62
  buffer_load_dwordx4 a[0:3], v1, s[32:35], s62 offen sc1
  s_add_u32 s62, s60, 2095104
  s_cmp_lt_u32 s55, 8
  s_cselect_b32 s62, 0x20000000, s62
  s_mov_b32 exec_lo, -1
  s_mov_b32 exec_hi, 0
  buffer_load_dwordx2 v[232:233], v59, s[32:35], s62 offen sc1
  s_mov_b64 exec, -1
  s_add_u32 s62, s56, 4294960128
  s_cmp_lt_u32 s55, 7
  s_cselect_b32 s62, 0x20000000, s62
  buffer_load_dwordx4 a[4:7], v1, s[32:35], s62 offen sc1
  s_add_u32 s62, s60, 2095360
  s_cmp_lt_u32 s55, 7
  s_cselect_b32 s62, 0x20000000, s62
  s_mov_b32 exec_lo, -1
  s_mov_b32 exec_hi, 0
  buffer_load_dwordx2 v[234:235], v59, s[32:35], s62 offen sc1
  s_mov_b64 exec, -1
  s_add_u32 s62, s56, 4294961152
  s_cmp_lt_u32 s55, 6
  s_cselect_b32 s62, 0x20000000, s62
  buffer_load_dwordx4 a[8:11], v1, s[32:35], s62 offen sc1
  s_add_u32 s62, s60, 2095616
  s_cmp_lt_u32 s55, 6
  s_cselect_b32 s62, 0x20000000, s62
  s_mov_b32 exec_lo, -1
  s_mov_b32 exec_hi, 0
  buffer_load_dwordx2 v[236:237], v59, s[32:35], s62 offen sc1
  s_mov_b64 exec, -1
  s_add_u32 s62, s56, 4294962176
  s_cmp_lt_u32 s55, 5
  s_cselect_b32 s62, 0x20000000, s62
  buffer_load_dwordx4 a[12:15], v1, s[32:35], s62 offen sc1
  s_add_u32 s62, s60, 2095872
  s_cmp_lt_u32 s55, 5
  s_cselect_b32 s62, 0x20000000, s62
  s_mov_b32 exec_lo, -1
  s_mov_b32 exec_hi, 0
  buffer_load_dwordx2 v[238:239], v59, s[32:35], s62 offen sc1
  s_mov_b64 exec, -1
  s_add_u32 s62, s56, 4294963200
  s_cmp_lt_u32 s55, 4
  s_cselect_b32 s62, 0x20000000, s62
  buffer_load_dwordx4 a[16:19], v1, s[32:35], s62 offen sc1
  s_add_u32 s62, s60, 2096128
  s_cmp_lt_u32 s55, 4
  s_cselect_b32 s62, 0x20000000, s62
  s_mov_b32 exec_lo, -1
  s_mov_b32 exec_hi, 0
  buffer_load_dwordx2 v[240:241], v59, s[32:35], s62 offen sc1
  s_mov_b64 exec, -1
  s_add_u32 s62, s56, 4294964224
  s_cmp_lt_u32 s55, 3
  s_cselect_b32 s62, 0x20000000, s62
  buffer_load_dwordx4 a[20:23], v1, s[32:35], s62 offen sc1
  s_add_u32 s62, s60, 2096384
  s_cmp_lt_u32 s55, 3
  s_cselect_b32 s62, 0x20000000, s62
  s_mov_b32 exec_lo, -1
  s_mov_b32 exec_hi, 0
  buffer_load_dwordx2 v[242:243], v59, s[32:35], s62 offen sc1
  s_mov_b64 exec, -1
  s_add_u32 s62, s56, 4294965248
  s_cmp_lt_u32 s55, 2
  s_cselect_b32 s62, 0x20000000, s62
  buffer_load_dwordx4 a[24:27], v1, s[32:35], s62 offen sc1
  s_add_u32 s62, s60, 2096640
  s_cmp_lt_u32 s55, 2
  s_cselect_b32 s62, 0x20000000, s62
  s_mov_b32 exec_lo, -1
  s_mov_b32 exec_hi, 0
  buffer_load_dwordx2 v[244:245], v59, s[32:35], s62 offen sc1
  s_mov_b64 exec, -1
  s_add_u32 s62, s56, 4294966272
  s_cmp_lt_u32 s55, 1
  s_cselect_b32 s62, 0x20000000, s62
  buffer_load_dwordx4 a[28:31], v1, s[32:35], s62 offen sc1
  s_add_u32 s62, s60, 2096896
  s_cmp_lt_u32 s55, 1
  s_cselect_b32 s62, 0x20000000, s62
  s_mov_b32 exec_lo, -1
  s_mov_b32 exec_hi, 0
  buffer_load_dwordx2 v[246:247], v59, s[32:35], s62 offen sc1
  s_mov_b64 exec, -1
  s_add_u32 s62, s56, 0
  s_cmp_lt_u32 s55, 0
  s_cselect_b32 s62, 0x20000000, s62
  buffer_load_dwordx4 a[32:35], v1, s[32:35], s62 offen sc1
  s_add_u32 s62, s60, 2097152
  s_cmp_lt_u32 s55, 0
  s_cselect_b32 s62, 0x20000000, s62
  s_mov_b32 exec_lo, -1
  s_mov_b32 exec_hi, 0
  buffer_load_dwordx2 v[248:249], v59, s[32:35], s62 offen sc1
  s_mov_b64 exec, -1
  s_add_u32 s62, s56, 1024
  s_cmp_lt_u32 s55, 0
  s_cselect_b32 s62, 0x20000000, s62
  buffer_load_dwordx4 a[36:39], v1, s[32:35], s62 offen sc1
  s_add_u32 s62, s60, 2097408
  s_cmp_lt_u32 s55, 0
  s_cselect_b32 s62, 0x20000000, s62
  s_mov_b32 exec_lo, -1
  s_mov_b32 exec_hi, 0
  buffer_load_dwordx2 v[250:251], v59, s[32:35], s62 offen sc1
  s_mov_b64 exec, -1
  s_add_u32 s62, s58, 2605056
  s_cmp_lt_u32 s55, 8
  s_cselect_b32 s62, 0x20000000, s62
  s_mov_b64 exec, s[98:99]
  buffer_load_dwordx4 a[40:43], v1, s[32:35], s62 offen offset:0 sc1
  buffer_load_dwordx4 a[44:47], v1, s[32:35], s62 offen offset:1024 sc1
  s_mov_b64 exec, -1
  s_mov_b32 s53, 0x07060302
  s_waitcnt vmcnt(18)
  v_mfma_f32_32x32x16_bf16 v[184:199], a[0:3], v[32:35], v[152:167]
  s_add_u32 s62, s58, 2607104
  s_cmp_lt_u32 s55, 7
  s_cselect_b32 s62, 0x20000000, s62
  s_mov_b64 exec, s[98:99]
  buffer_load_dwordx4 a[48:51], v1, s[32:35], s62 offen offset:0 sc1
  buffer_load_dwordx4 a[52:55], v1, s[32:35], s62 offen offset:1024 sc1
  s_mov_b64 exec, -1
  v_mfma_f32_32x32x16_bf16 v[184:199], v[232:235], v[40:43], v[184:199]
  s_waitcnt vmcnt(18)
  v_mfma_f32_32x32x16_bf16 v[200:215], a[4:7], v[32:35], 0
  s_add_u32 s62, s58, 2609152
  s_cmp_lt_u32 s55, 6
  s_cselect_b32 s62, 0x20000000, s62
  s_mov_b64 exec, s[98:99]
  buffer_load_dwordx4 a[56:59], v1, s[32:35], s62 offen offset:0 sc1
  buffer_load_dwordx4 a[60:63], v1, s[32:35], s62 offen offset:1024 sc1
  s_mov_b64 exec, -1
  v_mfma_f32_32x32x16_bf16 v[200:215], v[234:237], v[40:43], v[200:215]
  s_nop 1
  v_max_f32 v216, v184, v185
  v_max3_f32 v216, v186, v187, v216
  v_max3_f32 v216, v188, v189, v216
  v_max3_f32 v216, v190, v191, v216
  v_max3_f32 v216, v192, v193, v216
  v_max3_f32 v216, v194, v195, v216
  v_max3_f32 v216, v196, v197, v216
  v_max3_f32 v216, v198, v199, v216
  s_waitcnt vmcnt(18)
  v_mfma_f32_32x32x16_bf16 v[184:199], a[8:11], v[32:35], 0
  s_add_u32 s62, s58, 2611200
  s_cmp_lt_u32 s55, 5
  s_cselect_b32 s62, 0x20000000, s62
  s_mov_b64 exec, s[98:99]
  buffer_load_dwordx4 a[64:67], v1, s[32:35], s62 offen offset:0 sc1
  buffer_load_dwordx4 a[68:71], v1, s[32:35], s62 offen offset:1024 sc1
  s_mov_b64 exec, -1
  v_mfma_f32_32x32x16_bf16 v[184:199], v[236:239], v[40:43], v[184:199]
  v_max3_f32 v216, v200, v201, v216
  v_max3_f32 v216, v202, v203, v216
  v_max3_f32 v216, v204, v205, v216
  v_max3_f32 v216, v206, v207, v216
  v_max3_f32 v216, v208, v209, v216
  v_max3_f32 v216, v210, v211, v216
  v_max3_f32 v216, v212, v213, v216
  v_max3_f32 v216, v214, v215, v216
  s_waitcnt vmcnt(18)
  v_mfma_f32_32x32x16_bf16 v[200:215], a[12:15], v[32:35], 0
  s_add_u32 s62, s58, 2613248
  s_cmp_lt_u32 s55, 4
  s_cselect_b32 s62, 0x20000000, s62
  s_mov_b64 exec, s[98:99]
  buffer_load_dwordx4 a[72:75], v1, s[32:35], s62 offen offset:0 sc1
  buffer_load_dwordx4 a[76:79], v1, s[32:35], s62 offen offset:1024 sc1
  s_mov_b64 exec, -1
  v_mfma_f32_32x32x16_bf16 v[200:215], v[238:241], v[40:43], v[200:215]
  v_max3_f32 v216, v184, v185, v216
  v_max3_f32 v216, v186, v187, v216
  v_max3_f32 v216, v188, v189, v216
  v_max3_f32 v216, v190, v191, v216
  v_max3_f32 v216, v192, v193, v216
  v_max3_f32 v216, v194, v195, v216
  v_max3_f32 v216, v196, v197, v216
  v_max3_f32 v216, v198, v199, v216
  s_waitcnt vmcnt(18)
  v_mfma_f32_32x32x16_bf16 v[184:199], a[16:19], v[32:35], 0
  s_add_u32 s62, s58, 2615296
  s_cmp_lt_u32 s55, 3
  s_cselect_b32 s62, 0x20000000, s62
  s_mov_b64 exec, s[98:99]
  buffer_load_dwordx4 a[80:83], v1, s[32:35], s62 offen offset:0 sc1
  buffer_load_dwordx4 a[84:87], v1, s[32:35], s62 offen offset:1024 sc1
  s_mov_b64 exec, -1
  v_mfma_f32_32x32x16_bf16 v[184:199], v[240:243], v[40:43], v[184:199]
  v_max3_f32 v216, v200, v201, v216
  v_max3_f32 v216, v202, v203, v216
  v_max3_f32 v216, v204, v205, v216
  v_max3_f32 v216, v206, v207, v216
  v_max3_f32 v216, v208, v209, v216
  v_max3_f32 v216, v210, v211, v216
  v_max3_f32 v216, v212, v213, v216
  v_max3_f32 v216, v214, v215, v216
  s_waitcnt vmcnt(18)
  v_mfma_f32_32x32x16_bf16 v[200:215], a[20:23], v[32:35], 0
  s_add_u32 s62, s58, 2617344
  s_cmp_lt_u32 s55, 2
  s_cselect_b32 s62, 0x20000000, s62
  s_mov_b64 exec, s[98:99]
  buffer_load_dwordx4 a[88:91], v1, s[32:35], s62 offen offset:0 sc1
  buffer_load_dwordx4 a[92:95], v1, s[32:35], s62 offen offset:1024 sc1
  s_mov_b64 exec, -1
  v_mfma_f32_32x32x16_bf16 v[200:215], v[242:245], v[40:43], v[200:215]
  v_max3_f32 v216, v184, v185, v216
  v_max3_f32 v216, v186, v187, v216
  v_max3_f32 v216, v188, v189, v216
  v_max3_f32 v216, v190, v191, v216
  v_max3_f32 v216, v192, v193, v216
  v_max3_f32 v216, v194, v195, v216
  v_max3_f32 v216, v196, v197, v216
  v_max3_f32 v216, v198, v199, v216
  s_waitcnt vmcnt(18)
  v_mfma_f32_32x32x16_bf16 v[184:199], a[24:27], v[32:35], 0
  s_add_u32 s62, s58, 2619392
  s_cmp_lt_u32 s55, 1
  s_cselect_b32 s62, 0x20000000, s62
  s_mov_b64 exec, s[98:99]
  buffer_load_dwordx4 a[96:99], v1, s[32:35], s62 offen offset:0 sc1
  buffer_load_dwordx4 a[100:103], v1, s[32:35], s62 offen offset:1024 sc1
  s_mov_b64 exec, -1
  v_mfma_f32_32x32x16_bf16 v[184:199], v[244:247], v[40:43], v[184:199]
  v_max3_f32 v216, v200, v201, v216
  v_max3_f32 v216, v202, v203, v216
  v_max3_f32 v216, v204, v205, v216
  v_max3_f32 v216, v206, v207, v216
  v_max3_f32 v216, v208, v209, v216
  v_max3_f32 v216, v210, v211, v216
  v_max3_f32 v216, v212, v213, v216
  v_max3_f32 v216, v214, v215, v216
  s_waitcnt vmcnt(18)
  v_mfma_f32_32x32x16_bf16 v[200:215], a[28:31], v[32:35], 0
  s_add_u32 s62, s58, 2621440
  s_cmp_lt_u32 s55, 0
  s_cselect_b32 s62, 0x20000000, s62
  s_mov_b64 exec, s[98:99]
  buffer_load_dwordx4 a[104:107], v1, s[32:35], s62 offen offset:0 sc1
  buffer_load_dwordx4 a[108:111], v1, s[32:35], s62 offen offset:1024 sc1
  s_mov_b64 exec, -1
  v_mfma_f32_32x32x16_bf16 v[200:215], v[246:249], v[40:43], v[200:215]
  v_max3_f32 v216, v184, v185, v216
  v_max3_f32 v216, v186, v187, v216
  v_max3_f32 v216, v188, v189, v216
  v_max3_f32 v216, v190, v191, v216
  v_max3_f32 v216, v192, v193, v216
  v_max3_f32 v216, v194, v195, v216
  v_max3_f32 v216, v196, v197, v216
  v_max3_f32 v216, v198, v199, v216
  s_waitcnt vmcnt(18)
  v_mfma_f32_32x32x16_bf16 v[184:199], a[32:35], v[32:35], v[168:183]
  s_add_u32 s62, s58, 2623488
  s_cmp_lt_u32 s55, 0
  s_cselect_b32 s62, 0x20000000, s62
  s_mov_b64 exec, s[98:99]
  buffer_load_dwordx4 a[112:115], v1, s[32:35], s62 offen offset:0 sc1
  buffer_load_dwordx4 a[116:119], v1, s[32:35], s62 offen offset:1024 sc1
  s_mov_b64 exec, -1
  v_mfma_f32_32x32x16_bf16 v[184:199], v[248:251], v[40:43], v[184:199]
  v_max3_f32 v216, v200, v201, v216
  v_max3_f32 v216, v202, v203, v216
  v_max3_f32 v216, v204, v205, v216
  v_max3_f32 v216, v206, v207, v216
  v_max3_f32 v216, v208, v209, v216
  v_max3_f32 v216, v210, v211, v216
  v_max3_f32 v216, v212, v213, v216
  v_max3_f32 v216, v214, v215, v216
  s_nop 3
  v_max3_f32 v216, v184, v185, v216
  v_max3_f32 v216, v186, v187, v216
  v_max3_f32 v216, v188, v189, v216
  v_max3_f32 v216, v190, v191, v216
  v_max3_f32 v216, v192, v193, v216
  v_max3_f32 v216, v194, v195, v216
  v_max3_f32 v216, v196, v197, v216
  v_max3_f32 v216, v198, v199, v216
  v_mov_b32 v217, v216
  s_nop 1
  v_permlane32_swap_b32 v216, v217
  v_max_f32 v216, v216, v217
  v_sub_f32 v216, 0, v216
  v_and_b32 v217, 0xffff0000, v216
  v_sub_f32 v216, v216, v217
  v_and_b32 v56, 0xffff0000, v216
  v_sub_f32 v216, v216, v56
  s_mov_b32 exec_lo, 0
  v_or_b32 v40, 61769, v217
  v_perm_b32 v41, v216, v56, s53
  s_mov_b32 exec_lo, -1
  v_mfma_f32_32x32x16_bf16 v[72:87], a[0:3], v[32:35], v[152:167]
  v_mfma_f32_32x32x16_bf16 v[72:87], v[232:235], v[40:43], v[72:87]
  v_mfma_f32_32x32x16_bf16 v[88:103], a[4:7], v[32:35], 0
  s_nop 10
  v_exp_f32 v72, v72
  v_exp_f32 v73, v73
  v_exp_f32 v74, v74
  v_exp_f32 v75, v75
  v_cvt_pk_bf16_f32 v104, v72, v73
  v_exp_f32 v76, v76
  v_mfma_f32_32x32x16_bf16 v[88:103], v[234:237], v[40:43], v[88:103]
  v_exp_f32 v77, v77
  v_cvt_pk_bf16_f32 v105, v74, v75
  v_exp_f32 v78, v78
  v_exp_f32 v79, v79
  v_cvt_pk_bf16_f32 v106, v76, v77
  v_exp_f32 v80, v80
  v_mfma_f32_32x32x16_bf16 v[184:199], a[4:7], v[36:39], v[152:167]
  v_exp_f32 v81, v81
  v_cvt_pk_bf16_f32 v107, v78, v79
  v_exp_f32 v82, v82
  v_exp_f32 v83, v83
  v_cvt_pk_bf16_f32 v108, v80, v81
  v_exp_f32 v84, v84
  v_exp_f32 v85, v85
  v_mfma_f32_32x32x16_bf16 v[184:199], v[234:237], v[44:47], v[184:199]
  v_cvt_pk_bf16_f32 v109, v82, v83
  v_exp_f32 v86, v86
  v_exp_f32 v87, v87
  v_cvt_pk_bf16_f32 v110, v84, v85
  v_cvt_pk_bf16_f32 v111, v86, v87
  s_mul_i32 s59, s46, 169344
  s_mul_i32 s58, s45, 144
  s_add_u32 s59, s59, s58
  s_mul_i32 s58, s46, 21168
  s_add_u32 m0, s58, 73728
  s_nop 0
  buffer_load_dwordx4 v220, s[12:15], s59 offen offset:0 lds
  v_mfma_f32_32x32x16_bf16 v[72:87], a[8:11], v[32:35], 0
  v_max_f32 v218, v184, v185
  v_max3_f32 v218, v186, v187, v218
  v_max3_f32 v218, v188, v189, v218
  v_max3_f32 v218, v190, v191, v218
  v_max3_f32 v218, v192, v193, v218
  v_max3_f32 v218, v194, v195, v218
  v_max3_f32 v218, v196, v197, v218
  v_max3_f32 v218, v198, v199, v218
  v_mfma_f32_32x32x16_bf16 v[72:87], v[236:239], v[40:43], v[72:87]
  v_exp_f32 v88, v88
  v_exp_f32 v89, v89
  v_exp_f32 v90, v90
  v_exp_f32 v91, v91
  v_cvt_pk_bf16_f32 v112, v88, v89
  v_mfma_f32_32x32x16_bf16 v[200:215], a[8:11], v[36:39], 0
  v_exp_f32 v92, v92
  v_exp_f32 v93, v93
  v_cvt_pk_bf16_f32 v113, v90, v91
  v_exp_f32 v94, v94
  v_exp_f32 v95, v95
  v_mfma_f32_32x32x16_bf16 v[200:215], v[236:239], v[44:47], v[200:215]
  v_cvt_pk_bf16_f32 v114, v92, v93
  v_exp_f32 v96, v96
  v_exp_f32 v97, v97
  v_cvt_pk_bf16_f32 v115, v94, v95
  v_exp_f32 v98, v98
  s_waitcnt vmcnt(19)
  v_mfma_f32_32x32x16_bf16 v[120:135], a[40:43], v[104:107], 0
  v_exp_f32 v99, v99
  v_cvt_pk_bf16_f32 v116, v96, v97
  v_exp_f32 v100, v100
  v_exp_f32 v101, v101
  v_cvt_pk_bf16_f32 v117, v98, v99
  v_exp_f32 v102, v102
  v_mfma_f32_32x32x16_bf16 v[120:135], a[44:47], v[108:111], v[120:135]
  v_exp_f32 v103, v103
  v_cvt_pk_bf16_f32 v118, v100, v101
  v_cvt_pk_bf16_f32 v119, v102, v103
  buffer_load_dwordx4 v221, s[12:15], s59 offen offset:1008 lds
  buffer_load_dwordx4 v222, s[12:15], s59 offen offset:2016 lds
  buffer_load_dwordx4 v223, s[12:15], s59 offen offset:3024 lds
  s_add_u32 m0, s58, 77760
  s_add_u32 s59, s59, 32256
  v_mfma_f32_32x32x16_bf16 v[88:103], a[12:15], v[32:35], 0
  v_max3_f32 v218, v200, v201, v218
  v_max3_f32 v218, v202, v203, v218
  v_max3_f32 v218, v204, v205, v218
  v_max3_f32 v218, v206, v207, v218
  v_max3_f32 v218, v208, v209, v218
  v_max3_f32 v218, v210, v211, v218
  v_max3_f32 v218, v212, v213, v218
  v_max3_f32 v218, v214, v215, v218
  v_mfma_f32_32x32x16_bf16 v[88:103], v[238:241], v[40:43], v[88:103]
  v_exp_f32 v72, v72
  v_exp_f32 v73, v73
  v_exp_f32 v74, v74
  v_exp_f32 v75, v75
  v_cvt_pk_bf16_f32 v104, v72, v73
  v_mfma_f32_32x32x16_bf16 v[184:199], a[12:15], v[36:39], 0
  v_exp_f32 v76, v76
  v_exp_f32 v77, v77
  v_cvt_pk_bf16_f32 v105, v74, v75
  v_exp_f32 v78, v78
  v_exp_f32 v79, v79
  v_mfma_f32_32x32x16_bf16 v[184:199], v[238:241], v[44:47], v[184:199]
  v_cvt_pk_bf16_f32 v106, v76, v77
  v_exp_f32 v80, v80
  v_exp_f32 v81, v81
  v_cvt_pk_bf16_f32 v107, v78, v79
  v_exp_f32 v82, v82
  s_waitcnt vmcnt(20)
  v_mfma_f32_32x32x16_bf16 v[120:135], a[48:51], v[112:115], v[120:135]
  v_exp_f32 v83, v83
  v_cvt_pk_bf16_f32 v108, v80, v81
  v_exp_f32 v84, v84
  v_exp_f32 v85, v85
  v_cvt_pk_bf16_f32 v109, v82, v83
  v_mfma_f32_32x32x16_bf16 v[120:135], a[52:55], v[116:119], v[120:135]
  v_exp_f32 v86, v86
  v_exp_f32 v87, v87
  v_cvt_pk_bf16_f32 v110, v84, v85
  v_cvt_pk_bf16_f32 v111, v86, v87
  buffer_load_dwordx4 v220, s[12:15], s59 offen offset:0 lds
  buffer_load_dwordx4 v221, s[12:15], s59 offen offset:1008 lds
  buffer_load_dwordx4 v222, s[12:15], s59 offen offset:2016 lds
  v_mfma_f32_32x32x16_bf16 v[72:87], a[16:19], v[32:35], 0
  v_max3_f32 v218, v184, v185, v218
  v_max3_f32 v218, v186, v187, v218
  v_max3_f32 v218, v188, v189, v218
  v_max3_f32 v218, v190, v191, v218
  v_max3_f32 v218, v192, v193, v218
  v_max3_f32 v218, v194, v195, v218
  v_max3_f32 v218, v196, v197, v218
  v_max3_f32 v218, v198, v199, v218
  v_mfma_f32_32x32x16_bf16 v[72:87], v[240:243], v[40:43], v[72:87]
  v_exp_f32 v88, v88
  v_exp_f32 v89, v89
  v_exp_f32 v90, v90
  v_exp_f32 v91, v91
  v_cvt_pk_bf16_f32 v112, v88, v89
  v_mfma_f32_32x32x16_bf16 v[200:215], a[16:19], v[36:39], 0
  v_exp_f32 v92, v92
  v_exp_f32 v93, v93
  v_cvt_pk_bf16_f32 v113, v90, v91
  v_exp_f32 v94, v94
  v_exp_f32 v95, v95
  v_mfma_f32_32x32x16_bf16 v[200:215], v[240:243], v[44:47], v[200:215]
  v_cvt_pk_bf16_f32 v114, v92, v93
  v_exp_f32 v96, v96
  v_exp_f32 v97, v97
  v_cvt_pk_bf16_f32 v115, v94, v95
  v_exp_f32 v98, v98
  s_waitcnt vmcnt(21)
  v_mfma_f32_32x32x16_bf16 v[120:135], a[56:59], v[104:107], v[120:135]
  v_exp_f32 v99, v99
  v_cvt_pk_bf16_f32 v116, v96, v97
  v_exp_f32 v100, v100
  v_exp_f32 v101, v101
  v_cvt_pk_bf16_f32 v117, v98, v99
  v_exp_f32 v102, v102
  v_mfma_f32_32x32x16_bf16 v[120:135], a[60:63], v[108:111], v[120:135]
  v_exp_f32 v103, v103
  v_cvt_pk_bf16_f32 v118, v100, v101
  v_cvt_pk_bf16_f32 v119, v102, v103
  buffer_load_dwordx4 v223, s[12:15], s59 offen offset:3024 lds
  s_add_u32 m0, s58, 81792
  s_add_u32 s59, s59, 32256
  buffer_load_dwordx4 v220, s[12:15], s59 offen offset:0 lds
  buffer_load_dwordx4 v221, s[12:15], s59 offen offset:1008 lds
  v_mfma_f32_32x32x16_bf16 v[88:103], a[20:23], v[32:35], 0
  v_max3_f32 v218, v200, v201, v218
  v_max3_f32 v218, v202, v203, v218
  v_max3_f32 v218, v204, v205, v218
  v_max3_f32 v218, v206, v207, v218
  v_max3_f32 v218, v208, v209, v218
  v_max3_f32 v218, v210, v211, v218
  v_max3_f32 v218, v212, v213, v218
  v_max3_f32 v218, v214, v215, v218
  v_mfma_f32_32x32x16_bf16 v[88:103], v[242:245], v[40:43], v[88:103]
  v_exp_f32 v72, v72
  v_exp_f32 v73, v73
  v_exp_f32 v74, v74
  v_exp_f32 v75, v75
  v_cvt_pk_bf16_f32 v104, v72, v73
  v_mfma_f32_32x32x16_bf16 v[184:199], a[20:23], v[36:39], 0
  v_exp_f32 v76, v76
  v_exp_f32 v77, v77
  v_cvt_pk_bf16_f32 v105, v74, v75
  v_exp_f32 v78, v78
  v_exp_f32 v79, v79
  v_mfma_f32_32x32x16_bf16 v[184:199], v[242:245], v[44:47], v[184:199]
  v_cvt_pk_bf16_f32 v106, v76, v77
  v_exp_f32 v80, v80
  v_exp_f32 v81, v81
  v_cvt_pk_bf16_f32 v107, v78, v79
  v_exp_f32 v82, v82
  s_waitcnt vmcnt(22)
  v_mfma_f32_32x32x16_bf16 v[120:135], a[64:67], v[112:115], v[120:135]
  v_exp_f32 v83, v83
  v_cvt_pk_bf16_f32 v108, v80, v81
  v_exp_f32 v84, v84
  v_exp_f32 v85, v85
  v_cvt_pk_bf16_f32 v109, v82, v83
  v_mfma_f32_32x32x16_bf16 v[120:135], a[68:71], v[116:119], v[120:135]
  v_exp_f32 v86, v86
  v_exp_f32 v87, v87
  v_cvt_pk_bf16_f32 v110, v84, v85
  v_cvt_pk_bf16_f32 v111, v86, v87
  buffer_load_dwordx4 v222, s[12:15], s59 offen offset:2016 lds
  buffer_load_dwordx4 v223, s[12:15], s59 offen offset:3024 lds
  s_add_u32 m0, s58, 85824
  s_add_u32 s59, s59, 32256
  v_mfma_f32_32x32x16_bf16 v[72:87], a[24:27], v[32:35], 0
  v_max3_f32 v218, v184, v185, v218
  v_max3_f32 v218, v186, v187, v218
  v_max3_f32 v218, v188, v189, v218
  v_max3_f32 v218, v190, v191, v218
  v_max3_f32 v218, v192, v193, v218
  v_max3_f32 v218, v194, v195, v218
  v_max3_f32 v218, v196, v197, v218
  v_max3_f32 v218, v198, v199, v218
  v_mfma_f32_32x32x16_bf16 v[72:87], v[244:247], v[40:43], v[72:87]
  v_exp_f32 v88, v88
  v_exp_f32 v89, v89
  v_exp_f32 v90, v90
  v_exp_f32 v91, v91
  v_cvt_pk_bf16_f32 v112, v88, v89
  v_mfma_f32_32x32x16_bf16 v[200:215], a[24:27], v[36:39], 0
  v_exp_f32 v92, v92
  v_exp_f32 v93, v93
  v_cvt_pk_bf16_f32 v113, v90, v91
  v_exp_f32 v94, v94
  v_exp_f32 v95, v95
  v_mfma_f32_32x32x16_bf16 v[200:215], v[244:247], v[44:47], v[200:215]
  v_cvt_pk_bf16_f32 v114, v92, v93
  v_exp_f32 v96, v96
  v_exp_f32 v97, v97
  v_cvt_pk_bf16_f32 v115, v94, v95
  v_exp_f32 v98, v98
  s_waitcnt vmcnt(22)
  v_mfma_f32_32x32x16_bf16 v[120:135], a[72:75], v[104:107], v[120:135]
  v_exp_f32 v99, v99
  v_cvt_pk_bf16_f32 v116, v96, v97
  v_exp_f32 v100, v100
  v_exp_f32 v101, v101
  v_cvt_pk_bf16_f32 v117, v98, v99
  v_exp_f32 v102, v102
  v_mfma_f32_32x32x16_bf16 v[120:135], a[76:79], v[108:111], v[120:135]
  v_exp_f32 v103, v103
  v_cvt_pk_bf16_f32 v118, v100, v101
  v_cvt_pk_bf16_f32 v119, v102, v103
  buffer_load_dwordx4 v220, s[12:15], s59 offen offset:0 lds
  buffer_load_dwordx4 v221, s[12:15], s59 offen offset:1008 lds
  buffer_load_dwordx4 v222, s[12:15], s59 offen offset:2016 lds
  buffer_load_dwordx4 v223, s[12:15], s59 offen offset:3024 lds
  v_mfma_f32_32x32x16_bf16 v[88:103], a[28:31], v[32:35], 0
  v_max3_f32 v218, v200, v201, v218
  v_max3_f32 v218, v202, v203, v218
  v_max3_f32 v218, v204, v205, v218
  v_max3_f32 v218, v206, v207, v218
  v_max3_f32 v218, v208, v209, v218
  v_max3_f32 v218, v210, v211, v218
  v_max3_f32 v218, v212, v213, v218
  v_max3_f32 v218, v214, v215, v218
  v_mfma_f32_32x32x16_bf16 v[88:103], v[246:249], v[40:43], v[88:103]
  v_exp_f32 v72, v72
  v_exp_f32 v73, v73
  v_exp_f32 v74, v74
  v_exp_f32 v75, v75
  v_cvt_pk_bf16_f32 v104, v72, v73
  v_mfma_f32_32x32x16_bf16 v[184:199], a[28:31], v[36:39], 0
  v_exp_f32 v76, v76
  v_exp_f32 v77, v77
  v_cvt_pk_bf16_f32 v105, v74, v75
  v_exp_f32 v78, v78
  v_exp_f32 v79, v79
  v_mfma_f32_32x32x16_bf16 v[184:199], v[246:249], v[44:47], v[184:199]
  v_cvt_pk_bf16_f32 v106, v76, v77
  v_exp_f32 v80, v80
  v_exp_f32 v81, v81
  v_cvt_pk_bf16_f32 v107, v78, v79
  v_exp_f32 v82, v82
  s_waitcnt vmcnt(24)
  v_mfma_f32_32x32x16_bf16 v[120:135], a[80:83], v[112:115], v[120:135]
  v_exp_f32 v83, v83
  v_cvt_pk_bf16_f32 v108, v80, v81
  v_exp_f32 v84, v84
  v_exp_f32 v85, v85
  v_cvt_pk_bf16_f32 v109, v82, v83
  v_mfma_f32_32x32x16_bf16 v[120:135], a[84:87], v[116:119], v[120:135]
  v_exp_f32 v86, v86
  v_exp_f32 v87, v87
  v_cvt_pk_bf16_f32 v110, v84, v85
  v_cvt_pk_bf16_f32 v111, v86, v87
  s_add_u32 m0, s58, 89856
  s_add_u32 s59, s59, 32256
  buffer_load_dwordx4 v220, s[12:15], s59 offen offset:0 lds
  buffer_load_dwordx4 v221, s[12:15], s59 offen offset:1008 lds
  v_mfma_f32_32x32x16_bf16 v[72:87], a[32:35], v[32:35], v[168:183]
  v_max3_f32 v218, v184, v185, v218
  v_max3_f32 v218, v186, v187, v218
  v_max3_f32 v218, v188, v189, v218
  v_max3_f32 v218, v190, v191, v218
  v_max3_f32 v218, v192, v193, v218
  v_max3_f32 v218, v194, v195, v218
  v_max3_f32 v218, v196, v197, v218
  v_max3_f32 v218, v198, v199, v218
  v_mfma_f32_32x32x16_bf16 v[72:87], v[248:251], v[40:43], v[72:87]
  v_exp_f32 v88, v88
  v_exp_f32 v89, v89
  v_exp_f32 v90, v90
  v_exp_f32 v91, v91
  v_cvt_pk_bf16_f32 v112, v88, v89
  v_mfma_f32_32x32x16_bf16 v[200:215], a[32:35], v[36:39], 0
  v_exp_f32 v92, v92
  v_exp_f32 v93, v93
  v_cvt_pk_bf16_f32 v113, v90, v91
  v_exp_f32 v94, v94
  v_exp_f32 v95, v95
  v_mfma_f32_32x32x16_bf16 v[200:215], v[248:251], v[44:47], v[200:215]
  v_cvt_pk_bf16_f32 v114, v92, v93
  v_exp_f32 v96, v96
  v_exp_f32 v97, v97
  v_cvt_pk_bf16_f32 v115, v94, v95
  v_exp_f32 v98, v98
  s_waitcnt vmcnt(24)
  v_mfma_f32_32x32x16_bf16 v[120:135], a[88:91], v[104:107], v[120:135]
  v_exp_f32 v99, v99
  v_cvt_pk_bf16_f32 v116, v96, v97
  v_exp_f32 v100, v100
  v_exp_f32 v101, v101
  v_cvt_pk_bf16_f32 v117, v98, v99
  v_exp_f32 v102, v102
  v_mfma_f32_32x32x16_bf16 v[120:135], a[92:95], v[108:111], v[120:135]
  v_exp_f32 v103, v103
  v_cvt_pk_bf16_f32 v118, v100, v101
  v_cvt_pk_bf16_f32 v119, v102, v103
  buffer_load_dwordx4 v222, s[12:15], s59 offen offset:2016 lds
  buffer_load_dwordx4 v223, s[12:15], s59 offen offset:3024 lds
  s_add_u32 m0, s58, 93888
  s_add_u32 s59, s59, 32256
  buffer_load_dwordx4 v220, s[12:15], s59 offen offset:0 lds
  v_mfma_f32_32x32x16_bf16 v[184:199], a[36:39], v[36:39], v[168:183]
  v_max3_f32 v218, v200, v201, v218
  v_max3_f32 v218, v202, v203, v218
  v_max3_f32 v218, v204, v205, v218
  v_max3_f32 v218, v206, v207, v218
  v_max3_f32 v218, v208, v209, v218
  v_max3_f32 v218, v210, v211, v218
  v_max3_f32 v218, v212, v213, v218
  v_max3_f32 v218, v214, v215, v218
  v_exp_f32 v72, v72
  v_exp_f32 v73, v73
  v_exp_f32 v74, v74
  v_mfma_f32_32x32x16_bf16 v[184:199], v[250:253], v[44:47], v[184:199]
  v_exp_f32 v75, v75
  v_cvt_pk_bf16_f32 v104, v72, v73
  v_exp_f32 v76, v76
  v_exp_f32 v77, v77
  v_cvt_pk_bf16_f32 v105, v74, v75
  v_exp_f32 v78, v78
  v_exp_f32 v79, v79
  v_cvt_pk_bf16_f32 v106, v76, v77
  v_exp_f32 v80, v80
  s_waitcnt vmcnt(25)
  v_mfma_f32_32x32x16_bf16 v[120:135], a[96:99], v[112:115], v[120:135]
  v_exp_f32 v81, v81
  v_cvt_pk_bf16_f32 v107, v78, v79
  v_exp_f32 v82, v82
  v_exp_f32 v83, v83
  v_cvt_pk_bf16_f32 v108, v80, v81
  v_exp_f32 v84, v84
  v_exp_f32 v85, v85
  v_cvt_pk_bf16_f32 v109, v82, v83
  v_exp_f32 v86, v86
  v_mfma_f32_32x32x16_bf16 v[120:135], a[100:103], v[116:119], v[120:135]
  v_exp_f32 v87, v87
  v_cvt_pk_bf16_f32 v110, v84, v85
  v_cvt_pk_bf16_f32 v111, v86, v87
  v_mov_b32 v224, -1
  v_mov_b32 v225, -1
  v_mov_b32 v226, -1
  v_mov_b32 v227, -1
  s_lshl_b32 s54, s44, 1
  s_add_u32 s60, s54, s47
  s_add_u32 s54, s54, 1
  s_mul_i32 s54, s54, 36864
  s_add_u32 s54, s54, 6815744
  s_add_u32 s54, s54, s50
  s_lshl_b32 s55, s45, 2
  s_add_u32 s55, s55, s46
  s_lshl_b32 s55, s55, 10
  s_add_u32 s55, s55, s54
  s_lshl_b32 s61, s45, 9
  s_lshl_b32 s57, s46, 2
  s_add_u32 s61, s61, s57
  s_add_u32 s61, s61, s54
  s_add_u32 s61, s61, 32768
  s_mul_i32 s57, s44, 72
  s_mul_i32 s58, s45, 9
  s_add_u32 s57, s57, s58
  s_lshl_b32 s57, s57, 10
  s_add_u32 s57, s57, 9175040
  s_add_u32 s57, s57, s50
  s_add_u32 s58, s57, 8192
  s_lshl_b32 s59, s46, 11
  s_add_u32 s57, s57, s59
  s_lshl_b32 s59, s46, 8
  s_add_u32 s58, s58, s59
  s_lshl_b32 s60, s60, 5
  s_add_u32 s60, s60, s45
  s_mul_i32 s60, s60, 9216
  s_lshl_b32 s59, s48, 9
  s_add_u32 s60, s60, s59
  s_add_u32 s60, s60, 13901824
  s_add_u32 s60, s60, s50
  buffer_store_dwordx4 v[224:227], v1, s[32:35], s55 offen offset:0 sc1
  s_mov_b32 exec_hi, 0
  buffer_store_dword v224, v1, s[32:35], s61 offen offset:0 sc1
  s_mov_b32 exec_hi, -1
  buffer_store_dwordx4 v[224:227], v1, s[32:35], s57 offen offset:0 sc1
  buffer_store_dwordx4 v[224:227], v1, s[32:35], s57 offen offset:1024 sc1
  s_mov_b64 exec, 0xffff
  buffer_store_dwordx4 v[224:227], v1, s[32:35], s58 offen offset:0 sc1
  s_mov_b64 exec, -1
  s_waitcnt vmcnt(28)
  v_mfma_f32_32x32x16_bf16 v[120:135], a[104:107], v[104:107], v[120:135]
  v_max3_f32 v218, v184, v185, v218
  v_max3_f32 v218, v186, v187, v218
  v_max3_f32 v218, v188, v189, v218
  v_max3_f32 v218, v190, v191, v218
  v_max3_f32 v218, v192, v193, v218
  v_max3_f32 v218, v194, v195, v218
  v_max3_f32 v218, v196, v197, v218
  v_max3_f32 v218, v198, v199, v218
  v_mfma_f32_32x32x16_bf16 v[120:135], a[108:111], v[108:111], v[120:135]
  v_mov_b32 v219, v218
  s_nop 1
  v_permlane32_swap_b32 v218, v219
  v_max_f32 v218, v218, v219
  v_sub_f32 v218, 0, v218
  v_and_b32 v219, 0xffff0000, v218
  v_sub_f32 v218, v218, v219
  v_and_b32 v56, 0xffff0000, v218
  v_sub_f32 v218, v218, v56
  s_mov_b32 exec_lo, 0
  v_or_b32 v44, 61769, v219
  v_perm_b32 v45, v218, v56, s53
  s_mov_b32 exec_lo, -1
  v_mfma_f32_32x32x16_bf16 v[72:87], a[4:7], v[36:39], v[152:167]
  s_lshl_b32 s54, s44, 1
  s_add_u32 s54, s54, 0
  s_mul_i32 s54, s54, 36864
  s_add_u32 s54, s54, s50
  s_add_u32 s54, s54, 6815744
  s_lshl_b32 s55, s45, 2
  s_add_u32 s55, s55, s46
  s_lshl_b32 s55, s55, 10
  s_add_u32 s55, s55, s54
  s_lshl_b32 s56, s45, 9
  s_lshl_b32 s57, s46, 2
  s_add_u32 s56, s56, s57
  s_add_u32 s56, s56, s54
  s_add_u32 s56, s56, 32768
  s_cmp_eq_u32 s48, 0
  s_cselect_b64 vcc, -1, 0
  v_mfma_f32_32x32x16_bf16 v[72:87], v[234:237], v[44:47], v[72:87]
  v_mfma_f32_32x32x16_bf16 v[88:103], a[8:11], v[36:39], 0
  v_mfma_f32_32x32x16_bf16 v[88:103], v[236:239], v[44:47], v[88:103]
  s_nop 9
  v_exp_f32 v72, v72
  v_exp_f32 v73, v73
  v_exp_f32 v74, v74
  v_exp_f32 v75, v75
  v_cvt_pk_bf16_f32 v104, v72, v73
  v_exp_f32 v76, v76
  v_exp_f32 v77, v77
  v_cvt_pk_bf16_f32 v105, v74, v75
  v_exp_f32 v78, v78
  v_exp_f32 v79, v79
  v_cvt_pk_bf16_f32 v106, v76, v77
  v_exp_f32 v80, v80
  v_exp_f32 v81, v81
  v_cvt_pk_bf16_f32 v107, v78, v79
  v_exp_f32 v82, v82
  v_exp_f32 v83, v83
  v_cvt_pk_bf16_f32 v108, v80, v81
  v_exp_f32 v84, v84
  v_exp_f32 v85, v85
  v_cvt_pk_bf16_f32 v109, v82, v83
  v_exp_f32 v86, v86
  v_exp_f32 v87, v87
  v_cvt_pk_bf16_f32 v110, v84, v85
  v_cvt_pk_bf16_f32 v111, v86, v87
  v_rcp_f32 v57, v132
  v_cndmask_b32 v128, v130, v128, vcc
  v_cndmask_b32 v129, v131, v129, vcc
  v_mul_f32 v120, v120, v57
  v_mul_f32 v121, v121, v57
  v_mul_f32 v122, v122, v57
  v_mul_f32 v123, v123, v57
  v_mul_f32 v124, v124, v57
  v_mul_f32 v125, v125, v57
  v_mfma_f32_32x32x16_bf16 v[72:87], a[12:15], v[36:39], 0
  v_exp_f32 v88, v88
  v_exp_f32 v89, v89
  v_exp_f32 v90, v90
  v_exp_f32 v91, v91
  v_cvt_pk_bf16_f32 v112, v88, v89
  v_exp_f32 v92, v92
  v_exp_f32 v93, v93
  v_mfma_f32_32x32x16_bf16 v[72:87], v[238:241], v[44:47], v[72:87]
  v_cvt_pk_bf16_f32 v113, v90, v91
  v_exp_f32 v94, v94
  v_exp_f32 v95, v95
  v_cvt_pk_bf16_f32 v114, v92, v93
  v_exp_f32 v96, v96
  v_exp_f32 v97, v97
  v_cvt_pk_bf16_f32 v115, v94, v95
  v_exp_f32 v98, v98
  v_mfma_f32_32x32x16_bf16 v[136:151], a[48:51], v[104:107], 0
  v_exp_f32 v99, v99
  v_cvt_pk_bf16_f32 v116, v96, v97
  v_exp_f32 v100, v100
  v_exp_f32 v101, v101
  v_cvt_pk_bf16_f32 v117, v98, v99
  v_exp_f32 v102, v102
  v_exp_f32 v103, v103
  v_mfma_f32_32x32x16_bf16 v[136:151], a[52:55], v[108:111], v[136:151]
  v_cvt_pk_bf16_f32 v118, v100, v101
  v_cvt_pk_bf16_f32 v119, v102, v103
  v_mul_f32 v126, v126, v57
  v_mul_f32 v127, v127, v57
  v_mul_f32 v128, v128, v57
  v_mul_f32 v129, v129, v57
  v_cvt_pk_bf16_f32 v224, v120, v121
  v_cvt_pk_bf16_f32 v225, v122, v123
  v_cvt_pk_bf16_f32 v226, v124, v125
  v_cvt_pk_bf16_f32 v227, v126, v127
  v_cvt_pk_bf16_f32 v228, v128, v129
  buffer_store_dwordx4 v[224:227], v1, s[32:35], s55 offen sc1
  s_mov_b32 exec_hi, 0
  buffer_store_dword v228, v1, s[32:35], s56 offen sc1
  s_mov_b32 exec_hi, -1
  v_mfma_f32_32x32x16_bf16 v[88:103], a[16:19], v[36:39], 0
  v_exp_f32 v72, v72
  v_exp_f32 v73, v73
  v_exp_f32 v74, v74
  v_exp_f32 v75, v75
  v_cvt_pk_bf16_f32 v104, v72, v73
  v_mfma_f32_32x32x16_bf16 v[88:103], v[240:243], v[44:47], v[88:103]
  v_exp_f32 v76, v76
  v_exp_f32 v77, v77
  v_cvt_pk_bf16_f32 v105, v74, v75
  v_exp_f32 v78, v78
  v_exp_f32 v79, v79
  v_cvt_pk_bf16_f32 v106, v76, v77
  v_mfma_f32_32x32x16_bf16 v[136:151], a[56:59], v[112:115], v[136:151]
  v_exp_f32 v80, v80
  v_exp_f32 v81, v81
  v_cvt_pk_bf16_f32 v107, v78, v79
  v_exp_f32 v82, v82
  v_exp_f32 v83, v83
  v_cvt_pk_bf16_f32 v108, v80, v81
  v_mfma_f32_32x32x16_bf16 v[136:151], a[60:63], v[116:119], v[136:151]
  v_exp_f32 v84, v84
  v_exp_f32 v85, v85
  v_cvt_pk_bf16_f32 v109, v82, v83
  v_exp_f32 v86, v86
  v_exp_f32 v87, v87
  v_cvt_pk_bf16_f32 v110, v84, v85
  v_cvt_pk_bf16_f32 v111, v86, v87
  v_mfma_f32_32x32x16_bf16 v[72:87], a[20:23], v[36:39], 0
  v_exp_f32 v88, v88
  v_exp_f32 v89, v89
  v_exp_f32 v90, v90
  v_exp_f32 v91, v91
  v_cvt_pk_bf16_f32 v112, v88, v89
  v_mfma_f32_32x32x16_bf16 v[72:87], v[242:245], v[44:47], v[72:87]
  v_exp_f32 v92, v92
  v_exp_f32 v93, v93
  v_cvt_pk_bf16_f32 v113, v90, v91
  v_exp_f32 v94, v94
  v_exp_f32 v95, v95
  v_cvt_pk_bf16_f32 v114, v92, v93
  v_mfma_f32_32x32x16_bf16 v[136:151], a[64:67], v[104:107], v[136:151]
  v_exp_f32 v96, v96
  v_exp_f32 v97, v97
  v_cvt_pk_bf16_f32 v115, v94, v95
  v_exp_f32 v98, v98
  v_exp_f32 v99, v99
  v_cvt_pk_bf16_f32 v116, v96, v97
  v_mfma_f32_32x32x16_bf16 v[136:151], a[68:71], v[108:111], v[136:151]
  v_exp_f32 v100, v100
  v_exp_f32 v101, v101
  v_cvt_pk_bf16_f32 v117, v98, v99
  v_exp_f32 v102, v102
  v_exp_f32 v103, v103
  v_cvt_pk_bf16_f32 v118, v100, v101
  v_cvt_pk_bf16_f32 v119, v102, v103
  v_mfma_f32_32x32x16_bf16 v[88:103], a[24:27], v[36:39], 0
  v_exp_f32 v72, v72
  v_exp_f32 v73, v73
  v_exp_f32 v74, v74
  v_exp_f32 v75, v75
  v_cvt_pk_bf16_f32 v104, v72, v73
  v_mfma_f32_32x32x16_bf16 v[88:103], v[244:247], v[44:47], v[88:103]
  v_exp_f32 v76, v76
  v_exp_f32 v77, v77
  v_cvt_pk_bf16_f32 v105, v74, v75
  v_exp_f32 v78, v78
  v_exp_f32 v79, v79
  v_cvt_pk_bf16_f32 v106, v76, v77
  v_mfma_f32_32x32x16_bf16 v[136:151], a[72:75], v[112:115], v[136:151]
  v_exp_f32 v80, v80
  v_exp_f32 v81, v81
  v_cvt_pk_bf16_f32 v107, v78, v79
  v_exp_f32 v82, v82
  v_exp_f32 v83, v83
  v_cvt_pk_bf16_f32 v108, v80, v81
  v_mfma_f32_32x32x16_bf16 v[136:151], a[76:79], v[116:119], v[136:151]
  v_exp_f32 v84, v84
  v_exp_f32 v85, v85
  v_cvt_pk_bf16_f32 v109, v82, v83
  v_exp_f32 v86, v86
  v_exp_f32 v87, v87
  v_cvt_pk_bf16_f32 v110, v84, v85
  v_cvt_pk_bf16_f32 v111, v86, v87
  v_mfma_f32_32x32x16_bf16 v[72:87], a[28:31], v[36:39], 0
  v_exp_f32 v88, v88
  v_exp_f32 v89, v89
  v_exp_f32 v90, v90
  v_exp_f32 v91, v91
  v_cvt_pk_bf16_f32 v112, v88, v89
  v_mfma_f32_32x32x16_bf16 v[72:87], v[246:249], v[44:47], v[72:87]
  v_exp_f32 v92, v92
  v_exp_f32 v93, v93
  v_cvt_pk_bf16_f32 v113, v90, v91
  v_exp_f32 v94, v94
  v_exp_f32 v95, v95
  v_cvt_pk_bf16_f32 v114, v92, v93
  v_mfma_f32_32x32x16_bf16 v[136:151], a[80:83], v[104:107], v[136:151]
  v_exp_f32 v96, v96
  v_exp_f32 v97, v97
  v_cvt_pk_bf16_f32 v115, v94, v95
  v_exp_f32 v98, v98
  v_exp_f32 v99, v99
  v_cvt_pk_bf16_f32 v116, v96, v97
  v_mfma_f32_32x32x16_bf16 v[136:151], a[84:87], v[108:111], v[136:151]
  v_exp_f32 v100, v100
  v_exp_f32 v101, v101
  v_cvt_pk_bf16_f32 v117, v98, v99
  v_exp_f32 v102, v102
  v_exp_f32 v103, v103
  v_cvt_pk_bf16_f32 v118, v100, v101
  v_cvt_pk_bf16_f32 v119, v102, v103
  v_mfma_f32_32x32x16_bf16 v[88:103], a[32:35], v[36:39], 0
  v_exp_f32 v72, v72
  v_exp_f32 v73, v73
  v_exp_f32 v74, v74
  v_exp_f32 v75, v75
  v_cvt_pk_bf16_f32 v104, v72, v73
  v_mfma_f32_32x32x16_bf16 v[88:103], v[248:251], v[44:47], v[88:103]
  v_exp_f32 v76, v76
  v_exp_f32 v77, v77
  v_cvt_pk_bf16_f32 v105, v74, v75
  v_exp_f32 v78, v78
  v_exp_f32 v79, v79
  v_cvt_pk_bf16_f32 v106, v76, v77
  v_mfma_f32_32x32x16_bf16 v[136:151], a[88:91], v[112:115], v[136:151]
  v_exp_f32 v80, v80
  v_exp_f32 v81, v81
  v_cvt_pk_bf16_f32 v107, v78, v79
  v_exp_f32 v82, v82
  v_exp_f32 v83, v83
  v_cvt_pk_bf16_f32 v108, v80, v81
  v_mfma_f32_32x32x16_bf16 v[136:151], a[92:95], v[116:119], v[136:151]
  v_exp_f32 v84, v84
  v_exp_f32 v85, v85
  v_cvt_pk_bf16_f32 v109, v82, v83
  v_exp_f32 v86, v86
  v_exp_f32 v87, v87
  v_cvt_pk_bf16_f32 v110, v84, v85
  v_cvt_pk_bf16_f32 v111, v86, v87
  v_mfma_f32_32x32x16_bf16 v[72:87], a[36:39], v[36:39], v[168:183]
  v_exp_f32 v88, v88
  v_exp_f32 v89, v89
  v_exp_f32 v90, v90
  v_exp_f32 v91, v91
  v_cvt_pk_bf16_f32 v112, v88, v89
  v_mfma_f32_32x32x16_bf16 v[72:87], v[250:253], v[44:47], v[72:87]
  v_exp_f32 v92, v92
  v_exp_f32 v93, v93
  v_cvt_pk_bf16_f32 v113, v90, v91
  v_exp_f32 v94, v94
  v_exp_f32 v95, v95
  v_cvt_pk_bf16_f32 v114, v92, v93
  v_mfma_f32_32x32x16_bf16 v[136:151], a[96:99], v[104:107], v[136:151]
  v_exp_f32 v96, v96
  v_exp_f32 v97, v97
  v_cvt_pk_bf16_f32 v115, v94, v95
  v_exp_f32 v98, v98
  v_exp_f32 v99, v99
  v_cvt_pk_bf16_f32 v116, v96, v97
  v_mfma_f32_32x32x16_bf16 v[136:151], a[100:103], v[108:111], v[136:151]
  v_exp_f32 v100, v100
  v_exp_f32 v101, v101
  v_cvt_pk_bf16_f32 v117, v98, v99
  v_exp_f32 v102, v102
  v_exp_f32 v103, v103
  v_cvt_pk_bf16_f32 v118, v100, v101
  v_cvt_pk_bf16_f32 v119, v102, v103
  v_mfma_f32_32x32x16_bf16 v[136:151], a[104:107], v[112:115], v[136:151]
  v_exp_f32 v72, v72
  v_exp_f32 v73, v73
  v_exp_f32 v74, v74
  v_exp_f32 v75, v75
  v_cvt_pk_bf16_f32 v104, v72, v73
  v_exp_f32 v76, v76
  v_exp_f32 v77, v77
  v_cvt_pk_bf16_f32 v105, v74, v75
  v_exp_f32 v78, v78
  v_exp_f32 v79, v79
  v_cvt_pk_bf16_f32 v106, v76, v77
  v_mfma_f32_32x32x16_bf16 v[136:151], a[108:111], v[116:119], v[136:151]
  v_exp_f32 v80, v80
  v_exp_f32 v81, v81
  v_cvt_pk_bf16_f32 v107, v78, v79
  v_exp_f32 v82, v82
  v_exp_f32 v83, v83
  v_cvt_pk_bf16_f32 v108, v80, v81
  v_exp_f32 v84, v84
  v_exp_f32 v85, v85
  v_cvt_pk_bf16_f32 v109, v82, v83
  v_exp_f32 v86, v86
  v_exp_f32 v87, v87
  v_cvt_pk_bf16_f32 v110, v84, v85
  v_cvt_pk_bf16_f32 v111, v86, v87
  s_waitcnt vmcnt(28)
  v_mfma_f32_32x32x16_bf16 v[136:151], a[112:115], v[104:107], v[136:151]
  s_lshl_b32 s54, s44, 1
  s_add_u32 s54, s54, 1
  s_mul_i32 s54, s54, 36864
  s_add_u32 s54, s54, s50
  s_add_u32 s54, s54, 6815744
  s_lshl_b32 s55, s45, 2
  s_add_u32 s55, s55, s46
  s_lshl_b32 s55, s55, 10
  s_add_u32 s55, s55, s54
  s_lshl_b32 s56, s45, 9
  s_lshl_b32 s57, s46, 2
  s_add_u32 s56, s56, s57
  s_add_u32 s56, s56, s54
  s_add_u32 s56, s56, 32768
  s_cmp_eq_u32 s48, 0
  s_cselect_b64 vcc, -1, 0
  v_mfma_f32_32x32x16_bf16 v[136:151], a[116:119], v[108:111], v[136:151]
  s_nop 11
  v_rcp_f32 v57, v148
  v_cndmask_b32 v144, v146, v144, vcc
  v_cndmask_b32 v145, v147, v145, vcc
  v_mul_f32 v136, v136, v57
  v_mul_f32 v137, v137, v57
  v_mul_f32 v138, v138, v57
  v_mul_f32 v139, v139, v57
  v_mul_f32 v140, v140, v57
  v_mul_f32 v141, v141, v57
  v_mul_f32 v142, v142, v57
  v_mul_f32 v143, v143, v57
  v_mul_f32 v144, v144, v57
  v_mul_f32 v145, v145, v57
  v_cvt_pk_bf16_f32 v224, v136, v137
  v_cvt_pk_bf16_f32 v225, v138, v139
  v_cvt_pk_bf16_f32 v226, v140, v141
  v_cvt_pk_bf16_f32 v227, v142, v143
  v_cvt_pk_bf16_f32 v228, v144, v145
  s_waitcnt vmcnt(2)
  buffer_store_dwordx4 v[224:227], v1, s[32:35], s55 offen sc1
  s_mov_b32 exec_hi, 0
  buffer_store_dword v228, v1, s[32:35], s56 offen sc1
  s_mov_b32 exec_hi, -1
  s_waitcnt vmcnt(2)
  s_mul_i32 s68, s49, 196608
  s_lshl_b32 s69, s44, 10
  s_add_u32 s68, s68, s69
  s_add_u32 s68, s68, 32768
  s_lshl_b32 s69, s45, 7
  s_add_u32 s68, s68, s69
  s_barrier
  s_cmp_lg_u32 s46, 0
  s_cbranch_scc1 Lsig4
  s_mov_b32 exec_lo, 1
  s_mov_b32 exec_hi, 0
  v_mov_b32 v62, 1
  buffer_store_dword v62, v19, s[32:35], s68 offen sc1
  s_mov_b64 exec, -1
Lsig4:
  v_lshrrev_b32 v56, 4, v1
  v_bfe_u32 v57, v56, 2, 2
  v_bfe_u32 v58, v56, 4, 1
  v_and_b32 v59, 1, v56
  v_lshlrev_b32 v59, 4, v59
  v_bfe_u32 v60, v56, 1, 1
  v_lshl_add_u32 v59, v60, 3, v59
  v_lshl_add_u32 v59, v58, 5, v59
  s_mul_i32 s54, s48, 41472
  s_add_u32 s54, s54, 73728
  v_add_u32 v59, s54, v59
  v_lshl_add_u32 v60, v3, 3, v57
  v_mul_u32_u24 v60, 144, v60
  v_add_u32 v60, v60, v59
  v_mul_u32_u24 v61, 72, v3
  v_add3_u32 v61, v61, v57, 16
  v_mul_u32_u24 v61, 144, v61
  v_add_u32 v61, v61, v59
  s_lshl_b32 s54, s48, 6
  s_sub_u32 s55, 64, s54
  v_add_u32 v112, s54, v60
  v_add_u32 v115, s54, v61
  v_add_u32 v113, s55, v60
  v_add_u32 v116, s55, v61
  v_add_u32 v114, 128, v60
  v_add_u32 v117, 128, v61
  v_mul_u32_u24 v59, 1152, v2
  v_lshl_add_u32 v59, v3, 4, v59
  s_lshl_b32 s55, s44, 1
  s_add_u32 s55, s55, s47
  s_mul_i32 s56, s55, 36864
  s_mul_i32 s59, s45, 144
  s_add_u32 s59, s59, s56
  s_add_u32 s60, s59, s54
  s_add_u32 s56, s56, s50
  s_add_u32 s56, s56, 6815744
  s_lshl_b32 s54, s48, 14
  s_add_u32 s57, s56, s54
  s_lshl_b32 s54, s48, 11
  s_add_u32 s58, s56, s54
  s_add_u32 s58, s58, 32768
  ds_read_b64_tr_b16 v[32:33], v112 offset:0
  ds_read_b64_tr_b16 v[34:35], v112 offset:576
  ds_read_b64_tr_b16 v[36:37], v113 offset:0
  ds_read_b64_tr_b16 v[38:39], v113 offset:576
  ds_read_b64_tr_b16 v[40:41], v114 offset:0
  ds_read_b64_tr_b16 v[42:43], v114 offset:576
  ds_read_b64_tr_b16 v[44:45], v112 offset:2880
  ds_read_b64_tr_b16 v[46:47], v112 offset:3456
  ds_read_b64_tr_b16 v[48:49], v113 offset:2880
  ds_read_b64_tr_b16 v[50:51], v113 offset:3456
  buffer_load_dwordx4 v[120:123], v59, s[4:7], s60 offen sc1
  buffer_load_dwordx4 v[124:127], v59, s[4:7], s60 offen offset:32 sc1
  buffer_load_dwordx4 v[128:131], v59, s[4:7], s59 offen offset:128 sc1
  s_mul_i32 s67, s49, 196608
  s_lshl_b32 s69, s44, 10
  s_add_u32 s67, s67, s69
  s_add_u32 s67, s67, 32768
  s_mov_b32 exec_lo, 255
  s_mov_b32 exec_hi, 0
Lp5:
  buffer_load_dword v62, v19, s[32:35], s67 offen sc1
  s_waitcnt vmcnt(0)
  v_cmp_ne_u32 vcc, 1, v62
  s_cmp_eq_u32 s51, 0
  s_cbranch_scc1 Lq5
  s_sub_u32 s51, s51, 1
  s_cbranch_vccnz Lp5
Lq5:
  s_mov_b64 exec, -1
LrA:
  buffer_load_dwordx4 a[0:3], v1, s[32:35], s57 offen offset:0 sc1
  buffer_load_dwordx4 a[4:7], v1, s[32:35], s57 offen offset:1024 sc1
  buffer_load_dwordx4 a[8:11], v1, s[32:35], s57 offen offset:2048 sc1
  buffer_load_dwordx4 a[12:15], v1, s[32:35], s57 offen offset:3072 sc1
  s_add_u32 s57, s57, 4096
  buffer_load_dwordx4 a[16:19], v1, s[32:35], s57 offen offset:0 sc1
  buffer_load_dwordx4 a[20:23], v1, s[32:35], s57 offen offset:1024 sc1
  buffer_load_dwordx4 a[24:27], v1, s[32:35], s57 offen offset:2048 sc1
  buffer_load_dwordx4 a[28:31], v1, s[32:35], s57 offen offset:3072 sc1
  s_add_u32 s57, s57, 4096
  buffer_load_dwordx4 a[32:35], v1, s[32:35], s57 offen offset:0 sc1
  buffer_load_dwordx4 a[36:39], v1, s[32:35], s57 offen offset:1024 sc1
  buffer_load_dwordx4 a[40:43], v1, s[32:35], s57 offen offset:2048 sc1
  buffer_load_dwordx4 a[44:47], v1, s[32:35], s57 offen offset:3072 sc1
  s_add_u32 s57, s57, 4096
  buffer_load_dwordx4 a[48:51], v1, s[32:35], s57 offen offset:0 sc1
  buffer_load_dwordx4 a[52:55], v1, s[32:35], s57 offen offset:1024 sc1
  buffer_load_dwordx4 a[56:59], v1, s[32:35], s57 offen offset:2048 sc1
  buffer_load_dwordx4 a[60:63], v1, s[32:35], s57 offen offset:3072 sc1
  buffer_load_dwordx4 a[64:67], v1, s[32:35], s58 offen offset:0 sc1
  buffer_load_dwordx4 a[68:71], v1, s[32:35], s58 offen offset:1024 sc1
  s_sub_u32 s54, s48, 1
  s_and_b32 s55, s54, 0xffff0000
  v_lshlrev_b32 v64, 16, v120
  v_and_b32 v65, 0xffff0000, v120
  v_lshlrev_b32 v66, 16, v121
  v_and_b32 v67, 0xffff0000, v121
  v_lshlrev_b32 v68, 16, v122
  v_and_b32 v69, 0xffff0000, v122
  v_lshlrev_b32 v70, 16, v123
  v_and_b32 v71, 0xffff0000, v123
  v_lshlrev_b32 v72, 16, v124
  v_and_b32 v73, 0xffff0000, v124
  v_lshlrev_b32 v74, 16, v125
  v_and_b32 v75, 0xffff0000, v125
  v_lshlrev_b32 v76, 16, v126
  v_and_b32 v77, 0xffff0000, v126
  v_lshlrev_b32 v78, 16, v127
  v_and_b32 v79, 0xffff0000, v127
  v_lshlrev_b32 v96, 16, v128
  v_and_b32 v96, s54, v96
  v_and_b32 v97, s55, v128
  v_mov_b32 v104, 0
  v_mov_b32 v105, 0
  v_lshlrev_b32 v98, 16, v129
  v_and_b32 v98, s54, v98
  v_and_b32 v99, s55, v129
  v_mov_b32 v106, 0
  v_mov_b32 v107, 0
  v_lshlrev_b32 v100, 16, v130
  v_and_b32 v100, s54, v100
  v_and_b32 v101, s55, v130
  v_mov_b32 v108, 0
  v_mov_b32 v109, 0
  v_lshlrev_b32 v102, 16, v131
  v_and_b32 v102, s54, v102
  v_and_b32 v103, s55, v131
  v_mov_b32 v110, 0
  v_mov_b32 v111, 0
  s_mul_i32 s54, s46, 6144
  s_add_u32 s54, s54, 73728
  v_add_u32 v56, s54, v1
  s_xor_b32 s54, s46, 1
  s_mul_i32 s54, s54, 6144
  s_add_u32 s54, s54, 73728
  v_add_u32 v57, s54, v1
  s_mul_i32 s54, s44, 72
  s_mul_i32 s55, s45, 9
  s_add_u32 s54, s54, s55
  s_lshl_b32 s54, s54, 10
  s_lshl_b32 s55, s47, 9
  s_add_u32 s54, s54, s55
  s_add_u32 s54, s54, s50
  s_add_u32 s54, s54, 9175040
  s_lshl_b32 s55, s48, 12
  s_add_u32 s55, s55, s54
  s_add_u32 s54, s54, 8192
  v_lshlrev_b32 v58, 4, v2
  v_lshl_add_u32 v58, v3, 10, v58
  s_waitcnt vmcnt(17) lgkmcnt(8)
  v_mfma_f32_32x32x16_bf16 v[64:79], v[32:35], a[0:3], v[64:79]
  ds_read_b64_tr_b16 v[52:53], v114 offset:2880
  ds_read_b64_tr_b16 v[54:55], v114 offset:3456
  s_waitcnt lgkmcnt(8)
  v_mfma_f32_32x32x16_bf16 v[80:95], v[36:39], a[0:3], 0
  ds_read_b64_tr_b16 v[32:33], v112 offset:5184
  ds_read_b64_tr_b16 v[34:35], v112 offset:5760
  s_waitcnt lgkmcnt(8)
  v_mfma_f32_32x32x16_bf16 v[96:111], v[40:43], a[0:3], v[96:111]
  ds_read_b64_tr_b16 v[36:37], v113 offset:5184
  ds_read_b64_tr_b16 v[38:39], v113 offset:5760
  s_waitcnt vmcnt(16) lgkmcnt(8)
  v_mfma_f32_32x32x16_bf16 v[64:79], v[44:47], a[4:7], v[64:79]
  ds_read_b64_tr_b16 v[40:41], v114 offset:5184
  ds_read_b64_tr_b16 v[42:43], v114 offset:5760
  s_waitcnt lgkmcnt(8)
  v_mfma_f32_32x32x16_bf16 v[80:95], v[48:51], a[4:7], v[80:95]
  ds_read_b64_tr_b16 v[44:45], v112 offset:8064
  ds_read_b64_tr_b16 v[46:47], v112 offset:8640
  s_waitcnt lgkmcnt(8)
  v_mfma_f32_32x32x16_bf16 v[96:111], v[52:55], a[4:7], v[96:111]
  ds_read_b64_tr_b16 v[48:49], v113 offset:8064
  ds_read_b64_tr_b16 v[50:51], v113 offset:8640
  s_waitcnt vmcnt(15) lgkmcnt(8)
  v_mfma_f32_32x32x16_bf16 v[64:79], v[32:35], a[8:11], v[64:79]
  ds_read_b64_tr_b16 v[52:53], v114 offset:8064
  ds_read_b64_tr_b16 v[54:55], v114 offset:8640
  s_mul_i32 s63, s45, 1152
  s_mul_i32 s62, s46, 442368
  s_add_u32 s63, s63, s62
  s_mul_i32 s61, s46, 6144
  s_waitcnt lgkmcnt(8)
  v_mfma_f32_32x32x16_bf16 v[80:95], v[36:39], a[8:11], v[80:95]
  ds_read_b64_tr_b16 v[32:33], v112 offset:10368
  ds_read_b64_tr_b16 v[34:35], v112 offset:10944
  s_waitcnt lgkmcnt(8)
  v_mfma_f32_32x32x16_bf16 v[96:111], v[40:43], a[8:11], v[96:111]
  ds_read_b64_tr_b16 v[36:37], v113 offset:10368
  ds_read_b64_tr_b16 v[38:39], v113 offset:10944
  s_add_u32 s62, s63, 0
  s_waitcnt vmcnt(14) lgkmcnt(8)
  v_mfma_f32_32x32x16_bf16 v[64:79], v[44:47], a[12:15], v[64:79]
  ds_read_b64_tr_b16 v[40:41], v114 offset:10368
  ds_read_b64_tr_b16 v[42:43], v114 offset:10944
  s_add_u32 m0, s61, 0
  s_waitcnt lgkmcnt(8)
  v_mfma_f32_32x32x16_bf16 v[80:95], v[48:51], a[12:15], v[80:95]
  ds_read_b64_tr_b16 v[44:45], v112 offset:13248
  ds_read_b64_tr_b16 v[46:47], v112 offset:13824
  buffer_load_dwordx4 v10, s[16:19], s62 offen offset:0 lds
  s_waitcnt lgkmcnt(8)
  v_mfma_f32_32x32x16_bf16 v[96:111], v[52:55], a[12:15], v[96:111]
  ds_read_b64_tr_b16 v[48:49], v113 offset:13248
  ds_read_b64_tr_b16 v[50:51], v113 offset:13824
  s_waitcnt vmcnt(14) lgkmcnt(8)
  v_mfma_f32_32x32x16_bf16 v[64:79], v[32:35], a[16:19], v[64:79]
  ds_read_b64_tr_b16 v[52:53], v114 offset:13248
  ds_read_b64_tr_b16 v[54:55], v114 offset:13824
  buffer_load_dwordx4 v11, s[16:19], s62 offen offset:1024 lds
  s_waitcnt lgkmcnt(8)
  v_mfma_f32_32x32x16_bf16 v[80:95], v[36:39], a[16:19], v[80:95]
  ds_read_b64_tr_b16 v[32:33], v112 offset:15552
  ds_read_b64_tr_b16 v[34:35], v112 offset:16128
  buffer_load_dwordx4 v12, s[16:19], s62 offen offset:2048 lds
  s_waitcnt lgkmcnt(8)
  v_mfma_f32_32x32x16_bf16 v[96:111], v[40:43], a[16:19], v[96:111]
  ds_read_b64_tr_b16 v[36:37], v113 offset:15552
  ds_read_b64_tr_b16 v[38:39], v113 offset:16128
  s_waitcnt vmcnt(15) lgkmcnt(8)
  v_mfma_f32_32x32x16_bf16 v[64:79], v[44:47], a[20:23], v[64:79]
  ds_read_b64_tr_b16 v[40:41], v114 offset:15552
  ds_read_b64_tr_b16 v[42:43], v114 offset:16128
  s_add_u32 s62, s63, 221184
  s_waitcnt lgkmcnt(8)
  v_mfma_f32_32x32x16_bf16 v[80:95], v[48:51], a[20:23], v[80:95]
  ds_read_b64_tr_b16 v[44:45], v112 offset:18432
  ds_read_b64_tr_b16 v[46:47], v112 offset:19008
  s_add_u32 m0, s61, 3072
  s_waitcnt lgkmcnt(8)
  v_mfma_f32_32x32x16_bf16 v[96:111], v[52:55], a[20:23], v[96:111]
  ds_read_b64_tr_b16 v[48:49], v113 offset:18432
  ds_read_b64_tr_b16 v[50:51], v113 offset:19008
  buffer_load_dwordx4 v10, s[16:19], s62 offen offset:0 lds
  s_waitcnt vmcnt(15) lgkmcnt(8)
  v_mfma_f32_32x32x16_bf16 v[64:79], v[32:35], a[24:27], v[64:79]
  ds_read_b64_tr_b16 v[52:53], v114 offset:18432
  ds_read_b64_tr_b16 v[54:55], v114 offset:19008
  s_waitcnt lgkmcnt(8)
  v_mfma_f32_32x32x16_bf16 v[80:95], v[36:39], a[24:27], v[80:95]
  ds_read_b64_tr_b16 v[32:33], v112 offset:20736
  ds_read_b64_tr_b16 v[34:35], v112 offset:21312
  buffer_load_dwordx4 v11, s[16:19], s62 offen offset:1024 lds
  s_waitcnt lgkmcnt(8)
  v_mfma_f32_32x32x16_bf16 v[96:111], v[40:43], a[24:27], v[96:111]
  ds_read_b64_tr_b16 v[36:37], v113 offset:20736
  ds_read_b64_tr_b16 v[38:39], v113 offset:21312
  buffer_load_dwordx4 v12, s[16:19], s62 offen offset:2048 lds
  s_waitcnt vmcnt(16) lgkmcnt(8)
  v_mfma_f32_32x32x16_bf16 v[64:79], v[44:47], a[28:31], v[64:79]
  ds_read_b64_tr_b16 v[40:41], v114 offset:20736
  ds_read_b64_tr_b16 v[42:43], v114 offset:21312
  s_add_u32 s62, s63, 1769472
  s_waitcnt lgkmcnt(8)
  v_mfma_f32_32x32x16_bf16 v[80:95], v[48:51], a[28:31], v[80:95]
  ds_read_b64_tr_b16 v[44:45], v112 offset:23616
  ds_read_b64_tr_b16 v[46:47], v112 offset:24192
  s_waitcnt lgkmcnt(8)
  v_mfma_f32_32x32x16_bf16 v[96:111], v[52:55], a[28:31], v[96:111]
  ds_read_b64_tr_b16 v[48:49], v113 offset:23616
  ds_read_b64_tr_b16 v[50:51], v113 offset:24192
  s_add_u32 m0, s61, 24576
  s_waitcnt vmcnt(15) lgkmcnt(8)
  v_mfma_f32_32x32x16_bf16 v[64:79], v[32:35], a[32:35], v[64:79]
  ds_read_b64_tr_b16 v[52:53], v114 offset:23616
  ds_read_b64_tr_b16 v[54:55], v114 offset:24192
  buffer_load_dwordx4 v10, s[16:19], s62 offen offset:0 lds
  s_waitcnt lgkmcnt(8)
  v_mfma_f32_32x32x16_bf16 v[80:95], v[36:39], a[32:35], v[80:95]
  ds_read_b64_tr_b16 v[32:33], v112 offset:25920
  ds_read_b64_tr_b16 v[34:35], v112 offset:26496
  s_waitcnt lgkmcnt(8)
  v_mfma_f32_32x32x16_bf16 v[96:111], v[40:43], a[32:35], v[96:111]
  ds_read_b64_tr_b16 v[36:37], v113 offset:25920
  ds_read_b64_tr_b16 v[38:39], v113 offset:26496
  buffer_load_dwordx4 v11, s[16:19], s62 offen offset:1024 lds
  s_waitcnt vmcnt(16) lgkmcnt(8)
  v_mfma_f32_32x32x16_bf16 v[64:79], v[44:47], a[36:39], v[64:79]
  ds_read_b64_tr_b16 v[40:41], v114 offset:25920
  ds_read_b64_tr_b16 v[42:43], v114 offset:26496
  buffer_load_dwordx4 v12, s[16:19], s62 offen offset:2048 lds
  s_waitcnt lgkmcnt(8)
  v_mfma_f32_32x32x16_bf16 v[80:95], v[48:51], a[36:39], v[80:95]
  ds_read_b64_tr_b16 v[44:45], v112 offset:28800
  ds_read_b64_tr_b16 v[46:47], v112 offset:29376
  s_add_u32 s62, s63, 1990656
  s_waitcnt lgkmcnt(8)
  v_mfma_f32_32x32x16_bf16 v[96:111], v[52:55], a[36:39], v[96:111]
  ds_read_b64_tr_b16 v[48:49], v113 offset:28800
  ds_read_b64_tr_b16 v[50:51], v113 offset:29376
  s_waitcnt vmcnt(16) lgkmcnt(8)
  v_mfma_f32_32x32x16_bf16 v[64:79], v[32:35], a[40:43], v[64:79]
  ds_read_b64_tr_b16 v[52:53], v114 offset:28800
  ds_read_b64_tr_b16 v[54:55], v114 offset:29376
  s_add_u32 m0, s61, 27648
  s_waitcnt lgkmcnt(8)
  v_mfma_f32_32x32x16_bf16 v[80:95], v[36:39], a[40:43], v[80:95]
  ds_read_b64_tr_b16 v[32:33], v112 offset:31104
  ds_read_b64_tr_b16 v[34:35], v112 offset:31680
  buffer_load_dwordx4 v10, s[16:19], s62 offen offset:0 lds
  s_waitcnt lgkmcnt(8)
  v_mfma_f32_32x32x16_bf16 v[96:111], v[40:43], a[40:43], v[96:111]
  ds_read_b64_tr_b16 v[36:37], v113 offset:31104
  ds_read_b64_tr_b16 v[38:39], v113 offset:31680
  s_waitcnt vmcnt(16) lgkmcnt(8)
  v_mfma_f32_32x32x16_bf16 v[64:79], v[44:47], a[44:47], v[64:79]
  ds_read_b64_tr_b16 v[40:41], v114 offset:31104
  ds_read_b64_tr_b16 v[42:43], v114 offset:31680
  buffer_load_dwordx4 v11, s[16:19], s62 offen offset:1024 lds
  s_waitcnt lgkmcnt(8)
  v_mfma_f32_32x32x16_bf16 v[80:95], v[48:51], a[44:47], v[80:95]
  ds_read_b64_tr_b16 v[44:45], v112 offset:33984
  ds_read_b64_tr_b16 v[46:47], v112 offset:34560
  buffer_load_dwordx4 v12, s[16:19], s62 offen offset:2048 lds
  s_waitcnt lgkmcnt(8)
  v_mfma_f32_32x32x16_bf16 v[96:111], v[52:55], a[44:47], v[96:111]
  ds_read_b64_tr_b16 v[48:49], v113 offset:33984
  ds_read_b64_tr_b16 v[50:51], v113 offset:34560
  s_add_u32 s62, s63, 3538944
  s_waitcnt vmcnt(17) lgkmcnt(8)
  v_mfma_f32_32x32x16_bf16 v[64:79], v[32:35], a[48:51], v[64:79]
  ds_read_b64_tr_b16 v[52:53], v114 offset:33984
  ds_read_b64_tr_b16 v[54:55], v114 offset:34560
  s_waitcnt lgkmcnt(8)
  v_mfma_f32_32x32x16_bf16 v[80:95], v[36:39], a[48:51], v[80:95]
  ds_read_b64_tr_b16 v[32:33], v112 offset:36288
  ds_read_b64_tr_b16 v[34:35], v112 offset:36864
  s_add_u32 m0, s61, 49152
  s_waitcnt lgkmcnt(8)
  v_mfma_f32_32x32x16_bf16 v[96:111], v[40:43], a[48:51], v[96:111]
  ds_read_b64_tr_b16 v[36:37], v113 offset:36288
  ds_read_b64_tr_b16 v[38:39], v113 offset:36864
  buffer_load_dwordx4 v10, s[16:19], s62 offen offset:0 lds
  s_waitcnt vmcnt(17) lgkmcnt(8)
  v_mfma_f32_32x32x16_bf16 v[64:79], v[44:47], a[52:55], v[64:79]
  ds_read_b64_tr_b16 v[40:41], v114 offset:36288
  ds_read_b64_tr_b16 v[42:43], v114 offset:36864
  buffer_load_dwordx4 v11, s[16:19], s62 offen offset:1024 lds
  s_waitcnt lgkmcnt(8)
  v_mfma_f32_32x32x16_bf16 v[80:95], v[48:51], a[52:55], v[80:95]
  ds_read_b64_tr_b16 v[44:45], v112 offset:39168
  ds_read_b64_tr_b16 v[46:47], v112 offset:39744
  s_waitcnt lgkmcnt(8)
  v_mfma_f32_32x32x16_bf16 v[96:111], v[52:55], a[52:55], v[96:111]
  ds_read_b64_tr_b16 v[48:49], v113 offset:39168
  ds_read_b64_tr_b16 v[50:51], v113 offset:39744
  buffer_load_dwordx4 v12, s[16:19], s62 offen offset:2048 lds
  s_waitcnt vmcnt(18) lgkmcnt(8)
  v_mfma_f32_32x32x16_bf16 v[64:79], v[32:35], a[56:59], v[64:79]
  ds_read_b64_tr_b16 v[52:53], v114 offset:39168
  ds_read_b64_tr_b16 v[54:55], v114 offset:39744
  s_add_u32 s62, s63, 3760128
  s_waitcnt lgkmcnt(8)
  v_mfma_f32_32x32x16_bf16 v[80:95], v[36:39], a[56:59], v[80:95]
  ds_read_b64_tr_b16 v[32:33], v115 offset:0
  ds_read_b64_tr_b16 v[34:35], v115 offset:5184
  s_waitcnt lgkmcnt(8)
  v_mfma_f32_32x32x16_bf16 v[96:111], v[40:43], a[56:59], v[96:111]
  ds_read_b64_tr_b16 v[36:37], v116 offset:0
  ds_read_b64_tr_b16 v[38:39], v116 offset:5184
  s_add_u32 m0, s61, 52224
  s_waitcnt vmcnt(17) lgkmcnt(8)
  v_mfma_f32_32x32x16_bf16 v[64:79], v[44:47], a[60:63], v[64:79]
  ds_read_b64_tr_b16 v[40:41], v117 offset:0
  ds_read_b64_tr_b16 v[42:43], v117 offset:5184
  buffer_load_dwordx4 v10, s[16:19], s62 offen offset:0 lds
  s_waitcnt lgkmcnt(8)
  v_mfma_f32_32x32x16_bf16 v[80:95], v[48:51], a[60:63], v[80:95]
  ds_read_b64_tr_b16 v[44:45], v115 offset:20736
  ds_read_b64_tr_b16 v[46:47], v115 offset:25920
  buffer_load_dwordx4 v11, s[16:19], s62 offen offset:1024 lds
  s_waitcnt lgkmcnt(8)
  v_mfma_f32_32x32x16_bf16 v[96:111], v[52:55], a[60:63], v[96:111]
  ds_read_b64_tr_b16 v[48:49], v116 offset:20736
  ds_read_b64_tr_b16 v[50:51], v116 offset:25920
  s_waitcnt vmcnt(18) lgkmcnt(8)
  v_mfma_f32_32x32x16_bf16 v[64:79], v[32:35], a[64:67], v[64:79]
  ds_read_b64_tr_b16 v[52:53], v117 offset:20736
  ds_read_b64_tr_b16 v[54:55], v117 offset:25920
  buffer_load_dwordx4 v12, s[16:19], s62 offen offset:2048 lds
  s_waitcnt lgkmcnt(8)
  v_mfma_f32_32x32x16_bf16 v[80:95], v[36:39], a[64:67], v[80:95]
  s_waitcnt lgkmcnt(6)
  v_mfma_f32_32x32x16_bf16 v[96:111], v[40:43], a[64:67], v[96:111]
  s_waitcnt vmcnt(18) lgkmcnt(4)
  v_mfma_f32_32x32x16_bf16 v[64:79], v[44:47], a[68:71], v[64:79]
  s_waitcnt lgkmcnt(2)
  v_mfma_f32_32x32x16_bf16 v[80:95], v[48:51], a[68:71], v[80:95]
  s_waitcnt lgkmcnt(0)
  v_mfma_f32_32x32x16_bf16 v[96:111], v[52:55], a[68:71], v[96:111]
  s_nop 7
  v_cmp_u_f32 vcc, v64, v64
  s_nop 1
  s_cbranch_vccz LokA
  s_cmp_eq_u32 s100, 0
  s_cbranch_scc1 LokA
  s_sub_u32 s100, s100, 1
  s_waitcnt vmcnt(0)
  s_lshl_b32 s57, s48, 14
  s_add_u32 s57, s57, s56
  ds_read_b64_tr_b16 v[32:33], v112 offset:0
  ds_read_b64_tr_b16 v[34:35], v112 offset:576
  ds_read_b64_tr_b16 v[36:37], v113 offset:0
  ds_read_b64_tr_b16 v[38:39], v113 offset:576
  ds_read_b64_tr_b16 v[40:41], v114 offset:0
  ds_read_b64_tr_b16 v[42:43], v114 offset:576
  ds_read_b64_tr_b16 v[44:45], v112 offset:2880
  ds_read_b64_tr_b16 v[46:47], v112 offset:3456
  ds_read_b64_tr_b16 v[48:49], v113 offset:2880
  ds_read_b64_tr_b16 v[50:51], v113 offset:3456
  s_waitcnt lgkmcnt(0)
  s_branch LrA
LokA:
  s_barrier
  ds_write_b128 v56, v[80:83] offset:0
  ds_write_b128 v56, v[84:87] offset:1024
  ds_write_b128 v56, v[88:91] offset:2048
  ds_write_b128 v56, v[92:95] offset:3072
  ds_write_b128 v56, v[96:99] offset:4096
  ds_write_b128 v56, v[100:103] offset:5120
  s_waitcnt lgkmcnt(0)
  s_barrier
  ds_read_b128 v[132:135], v57 offset:0
  ds_read_b128 v[136:139], v57 offset:1024
  ds_read_b128 v[140:143], v57 offset:2048
  ds_read_b128 v[144:147], v57 offset:3072
  ds_read_b128 v[148:151], v57 offset:4096
  ds_read_b128 v[152:155], v57 offset:5120
  s_waitcnt lgkmcnt(0)
  v_add_f32 v96, v96, v148
  v_add_f32 v97, v97, v149
  v_add_f32 v98, v98, v150
  v_add_f32 v99, v99, v151
  v_add_f32 v100, v100, v152
  v_add_f32 v101, v101, v153
  v_add_f32 v102, v102, v154
  v_add_f32 v103, v103, v155
  v_cvt_pk_bf16_f32 v128, v96, v97
  v_cvt_pk_bf16_f32 v129, v98, v99
  v_cvt_pk_bf16_f32 v130, v100, v101
  v_cvt_pk_bf16_f32 v131, v102, v103
  s_mov_b32 exec_lo, -1
  s_mov_b32 exec_hi, 0
  buffer_store_dwordx4 v[128:131], v58, s[32:35], s54 offen sc1
  s_mov_b64 exec, -1
  v_add_f32 v64, v64, v132
  v_add_f32 v65, v65, v133
  v_add_f32 v66, v66, v134
  v_add_f32 v67, v67, v135
  v_add_f32 v68, v68, v136
  v_add_f32 v69, v69, v137
  v_add_f32 v70, v70, v138
  v_add_f32 v71, v71, v139
  v_cvt_pk_bf16_f32 v120, v64, v65
  v_cvt_pk_bf16_f32 v121, v66, v67
  v_cvt_pk_bf16_f32 v122, v68, v69
  v_cvt_pk_bf16_f32 v123, v70, v71
  buffer_store_dwordx4 v[120:123], v58, s[32:35], s55 offen offset:0 sc1
  v_add_f32 v72, v72, v140
  v_add_f32 v73, v73, v141
  v_add_f32 v74, v74, v142
  v_add_f32 v75, v75, v143
  v_add_f32 v76, v76, v144
  v_add_f32 v77, v77, v145
  v_add_f32 v78, v78, v146
  v_add_f32 v79, v79, v147
  v_cvt_pk_bf16_f32 v124, v72, v73
  v_cvt_pk_bf16_f32 v125, v74, v75
  v_cvt_pk_bf16_f32 v126, v76, v77
  v_cvt_pk_bf16_f32 v127, v78, v79
  buffer_store_dwordx4 v[124:127], v58, s[32:35], s55 offen offset:2048 sc1
  s_mul_i32 s68, s49, 196608
  s_lshl_b32 s69, s44, 10
  s_add_u32 s68, s68, s69
  s_add_u32 s68, s68, 65536
  s_lshl_b32 s69, s45, 7
  s_add_u32 s68, s68, s69
  s_barrier
  s_cmp_lg_u32 s46, 0
  s_cbranch_scc1 Lsig6
  s_mov_b32 exec_lo, 1
  s_mov_b32 exec_hi, 0
  v_mov_b32 v62, 1
  buffer_store_dword v62, v19, s[32:35], s68 offen sc1
  s_mov_b64 exec, -1
Lsig6:
  s_mul_i32 s54, s44, 73728
  s_lshl_b32 s55, s46, 8
  s_add_u32 s54, s54, s55
  s_add_u32 s54, s54, s50
  s_add_u32 s54, s54, 9175040
  v_add_u32 v104, 0, v16
  v_add_u32 v105, 49152, v16
  v_add_u32 v106, 98304, v16
  s_lshl_b32 s55, s46, 11
  s_add_u32 s55, s55, 147456
  v_add_u32 v110, s55, v1
  v_xor_b32 v111, 2048, v110
  s_lshl_b32 s60, s44, 1
  s_add_u32 s60, s60, s47
  s_lshl_b32 s60, s60, 5
  s_add_u32 s60, s60, s45
  s_mul_i32 s60, s60, 9216
  s_lshl_b32 s55, s48, 9
  s_add_u32 s60, s60, s55
  s_add_u32 s60, s60, s50
  s_add_u32 s60, s60, 13893632
  s_lshl_b32 s58, s48, 12
  s_sub_u32 s59, 4096, s58
  s_mul_i32 s67, s49, 196608
  s_lshl_b32 s69, s44, 10
  s_add_u32 s67, s67, s69
  s_add_u32 s67, s67, 65536
  s_mov_b32 exec_lo, 255
  s_mov_b32 exec_hi, 0
Lp7:
  buffer_load_dword v62, v19, s[32:35], s67 offen sc1
  s_waitcnt vmcnt(0)
  v_cmp_ne_u32 vcc, 1, v62
  s_cmp_eq_u32 s51, 0
  s_cbranch_scc1 Lq7
  s_sub_u32 s51, s51, 1
  s_cbranch_vccnz Lp7
Lq7:
  s_mov_b64 exec, -1
LrB:
  buffer_load_dwordx4 v[112:115], v9, s[32:35], s54 offen sc1
  s_add_u32 s54, s54, 4096
  buffer_load_dwordx4 v[116:119], v9, s[32:35], s54 offen sc1
  s_add_u32 s54, s54, 4096
  buffer_load_dwordx4 v[120:123], v9, s[32:35], s54 offen sc1
  s_add_u32 s54, s54, 4096
  buffer_load_dwordx4 v[124:127], v9, s[32:35], s54 offen sc1
  s_add_u32 s54, s54, 4096
  buffer_load_dwordx4 v[128:131], v9, s[32:35], s54 offen sc1
  s_add_u32 s54, s54, 4096
  buffer_load_dwordx4 v[132:135], v9, s[32:35], s54 offen sc1
  s_add_u32 s54, s54, 4096
  buffer_load_dwordx4 v[136:139], v9, s[32:35], s54 offen sc1
  s_add_u32 s54, s54, 4096
  buffer_load_dwordx4 v[140:143], v9, s[32:35], s54 offen sc1
  s_add_u32 s54, s54, 4096
  buffer_load_dwordx4 v[144:147], v9, s[32:35], s54 offen sc1
  s_add_u32 s54, s54, 4096
  buffer_load_dwordx4 v[148:151], v9, s[32:35], s54 offen sc1
  s_add_u32 s54, s54, 4096
  buffer_load_dwordx4 v[152:155], v9, s[32:35], s54 offen sc1
  s_add_u32 s54, s54, 4096
  buffer_load_dwordx4 v[156:159], v9, s[32:35], s54 offen sc1
  s_add_u32 s54, s54, 4096
  buffer_load_dwordx4 v[160:163], v9, s[32:35], s54 offen sc1
  s_add_u32 s54, s54, 4096
  buffer_load_dwordx4 v[164:167], v9, s[32:35], s54 offen sc1
  s_add_u32 s54, s54, 4096
  buffer_load_dwordx4 v[168:171], v9, s[32:35], s54 offen sc1
  s_add_u32 s54, s54, 4096
  buffer_load_dwordx4 v[172:175], v9, s[32:35], s54 offen sc1
  s_add_u32 s54, s54, 4096
  buffer_load_dwordx4 v[176:179], v9, s[32:35], s54 offen sc1
  s_add_u32 s54, s54, 4096
  buffer_load_dwordx4 v[180:183], v9, s[32:35], s54 offen sc1
  s_add_u32 s54, s54, 4096
  v_mov_b32 v56, 0
  v_mov_b32 v57, 0
  v_mov_b32 v58, 0
  v_mov_b32 v59, 0
  s_waitcnt vmcnt(15)
  v_dot2_f32_bf16 v56, v112, s52, v56
  v_dot2_f32_bf16 v58, v112, v112, v58
  v_dot2_f32_bf16 v57, v113, s52, v57
  v_dot2_f32_bf16 v59, v113, v113, v59
  v_dot2_f32_bf16 v56, v114, s52, v56
  v_dot2_f32_bf16 v58, v114, v114, v58
  v_dot2_f32_bf16 v57, v115, s52, v57
  v_dot2_f32_bf16 v59, v115, v115, v59
  v_dot2_f32_bf16 v56, v116, s52, v56
  v_dot2_f32_bf16 v58, v116, v116, v58
  v_dot2_f32_bf16 v57, v117, s52, v57
  v_dot2_f32_bf16 v59, v117, v117, v59
  v_dot2_f32_bf16 v56, v118, s52, v56
  v_dot2_f32_bf16 v58, v118, v118, v58
  v_dot2_f32_bf16 v57, v119, s52, v57
  v_dot2_f32_bf16 v59, v119, v119, v59
  v_dot2_f32_bf16 v56, v120, s52, v56
  v_dot2_f32_bf16 v58, v120, v120, v58
  v_dot2_f32_bf16 v57, v121, s52, v57
  v_dot2_f32_bf16 v59, v121, v121, v59
  v_dot2_f32_bf16 v56, v122, s52, v56
  v_dot2_f32_bf16 v58, v122, v122, v58
  v_dot2_f32_bf16 v57, v123, s52, v57
  v_dot2_f32_bf16 v59, v123, v123, v59
  s_waitcnt vmcnt(12)
  v_dot2_f32_bf16 v56, v124, s52, v56
  v_dot2_f32_bf16 v58, v124, v124, v58
  v_dot2_f32_bf16 v57, v125, s52, v57
  v_dot2_f32_bf16 v59, v125, v125, v59
  v_dot2_f32_bf16 v56, v126, s52, v56
  v_dot2_f32_bf16 v58, v126, v126, v58
  v_dot2_f32_bf16 v57, v127, s52, v57
  v_dot2_f32_bf16 v59, v127, v127, v59
  v_dot2_f32_bf16 v56, v128, s52, v56
  v_dot2_f32_bf16 v58, v128, v128, v58
  v_dot2_f32_bf16 v57, v129, s52, v57
  v_dot2_f32_bf16 v59, v129, v129, v59
  v_dot2_f32_bf16 v56, v130, s52, v56
  v_dot2_f32_bf16 v58, v130, v130, v58
  v_dot2_f32_bf16 v57, v131, s52, v57
  v_dot2_f32_bf16 v59, v131, v131, v59
  v_dot2_f32_bf16 v56, v132, s52, v56
  v_dot2_f32_bf16 v58, v132, v132, v58
  v_dot2_f32_bf16 v57, v133, s52, v57
  v_dot2_f32_bf16 v59, v133, v133, v59
  v_dot2_f32_bf16 v56, v134, s52, v56
  v_dot2_f32_bf16 v58, v134, v134, v58
  v_dot2_f32_bf16 v57, v135, s52, v57
  v_dot2_f32_bf16 v59, v135, v135, v59
  s_waitcnt vmcnt(9)
  v_dot2_f32_bf16 v56, v136, s52, v56
  v_dot2_f32_bf16 v58, v136, v136, v58
  v_dot2_f32_bf16 v57, v137, s52, v57
  v_dot2_f32_bf16 v59, v137, v137, v59
  v_dot2_f32_bf16 v56, v138, s52, v56
  v_dot2_f32_bf16 v58, v138, v138, v58
  v_dot2_f32_bf16 v57, v139, s52, v57
  v_dot2_f32_bf16 v59, v139, v139, v59
  v_dot2_f32_bf16 v56, v140, s52, v56
  v_dot2_f32_bf16 v58, v140, v140, v58
  v_dot2_f32_bf16 v57, v141, s52, v57
  v_dot2_f32_bf16 v59, v141, v141, v59
  v_dot2_f32_bf16 v56, v142, s52, v56
  v_dot2_f32_bf16 v58, v142, v142, v58
  v_dot2_f32_bf16 v57, v143, s52, v57
  v_dot2_f32_bf16 v59, v143, v143, v59
  v_dot2_f32_bf16 v56, v144, s52, v56
  v_dot2_f32_bf16 v58, v144, v144, v58
  v_dot2_f32_bf16 v57, v145, s52, v57
  v_dot2_f32_bf16 v59, v145, v145, v59
  v_dot2_f32_bf16 v56, v146, s52, v56
  v_dot2_f32_bf16 v58, v146, v146, v58
  v_dot2_f32_bf16 v57, v147, s52, v57
  v_dot2_f32_bf16 v59, v147, v147, v59
  s_waitcnt vmcnt(6)
  v_dot2_f32_bf16 v56, v148, s52, v56
  v_dot2_f32_bf16 v58, v148, v148, v58
  v_dot2_f32_bf16 v57, v149, s52, v57
  v_dot2_f32_bf16 v59, v149, v149, v59
  v_dot2_f32_bf16 v56, v150, s52, v56
  v_dot2_f32_bf16 v58, v150, v150, v58
  v_dot2_f32_bf16 v57, v151, s52, v57
  v_dot2_f32_bf16 v59, v151, v151, v59
  v_dot2_f32_bf16 v56, v152, s52, v56
  v_dot2_f32_bf16 v58, v152, v152, v58
  v_dot2_f32_bf16 v57, v153, s52, v57
  v_dot2_f32_bf16 v59, v153, v153, v59
  v_dot2_f32_bf16 v56, v154, s52, v56
  v_dot2_f32_bf16 v58, v154, v154, v58
  v_dot2_f32_bf16 v57, v155, s52, v57
  v_dot2_f32_bf16 v59, v155, v155, v59
  v_dot2_f32_bf16 v56, v156, s52, v56
  v_dot2_f32_bf16 v58, v156, v156, v58
  v_dot2_f32_bf16 v57, v157, s52, v57
  v_dot2_f32_bf16 v59, v157, v157, v59
  v_dot2_f32_bf16 v56, v158, s52, v56
  v_dot2_f32_bf16 v58, v158, v158, v58
  v_dot2_f32_bf16 v57, v159, s52, v57
  v_dot2_f32_bf16 v59, v159, v159, v59
  s_waitcnt vmcnt(3)
  v_dot2_f32_bf16 v56, v160, s52, v56
  v_dot2_f32_bf16 v58, v160, v160, v58
  v_dot2_f32_bf16 v57, v161, s52, v57
  v_dot2_f32_bf16 v59, v161, v161, v59
  v_dot2_f32_bf16 v56, v162, s52, v56
  v_dot2_f32_bf16 v58, v162, v162, v58
  v_dot2_f32_bf16 v57, v163, s52, v57
  v_dot2_f32_bf16 v59, v163, v163, v59
  v_dot2_f32_bf16 v56, v164, s52, v56
  v_dot2_f32_bf16 v58, v164, v164, v58
  v_dot2_f32_bf16 v57, v165, s52, v57
  v_dot2_f32_bf16 v59, v165, v165, v59
  v_dot2_f32_bf16 v56, v166, s52, v56
  v_dot2_f32_bf16 v58, v166, v166, v58
  v_dot2_f32_bf16 v57, v167, s52, v57
  v_dot2_f32_bf16 v59, v167, v167, v59
  v_dot2_f32_bf16 v56, v168, s52, v56
  v_dot2_f32_bf16 v58, v168, v168, v58
  v_dot2_f32_bf16 v57, v169, s52, v57
  v_dot2_f32_bf16 v59, v169, v169, v59
  v_dot2_f32_bf16 v56, v170, s52, v56
  v_dot2_f32_bf16 v58, v170, v170, v58
  v_dot2_f32_bf16 v57, v171, s52, v57
  v_dot2_f32_bf16 v59, v171, v171, v59
  s_waitcnt vmcnt(0)
  v_dot2_f32_bf16 v56, v172, s52, v56
  v_dot2_f32_bf16 v58, v172, v172, v58
  v_dot2_f32_bf16 v57, v173, s52, v57
  v_dot2_f32_bf16 v59, v173, v173, v59
  v_dot2_f32_bf16 v56, v174, s52, v56
  v_dot2_f32_bf16 v58, v174, v174, v58
  v_dot2_f32_bf16 v57, v175, s52, v57
  v_dot2_f32_bf16 v59, v175, v175, v59
  v_dot2_f32_bf16 v56, v176, s52, v56
  v_dot2_f32_bf16 v58, v176, v176, v58
  v_dot2_f32_bf16 v57, v177, s52, v57
  v_dot2_f32_bf16 v59, v177, v177, v59
  v_dot2_f32_bf16 v56, v178, s52, v56
  v_dot2_f32_bf16 v58, v178, v178, v58
  v_dot2_f32_bf16 v57, v179, s52, v57
  v_dot2_f32_bf16 v59, v179, v179, v59
  v_dot2_f32_bf16 v56, v180, s52, v56
  v_dot2_f32_bf16 v58, v180, v180, v58
  v_dot2_f32_bf16 v57, v181, s52, v57
  v_dot2_f32_bf16 v59, v181, v181, v59
  v_dot2_f32_bf16 v56, v182, s52, v56
  v_dot2_f32_bf16 v58, v182, v182, v58
  v_dot2_f32_bf16 v57, v183, s52, v57
  v_dot2_f32_bf16 v59, v183, v183, v59
  s_nop 1
  v_add_f32 v56, v56, v57
  v_add_f32 v58, v58, v59
  v_mov_b32 v57, v56
  v_mov_b32 v59, v58
  s_nop 0
  v_permlane16_swap_b32 v56, v57
  v_permlane16_swap_b32 v58, v59
  v_add_f32 v56, v56, v57
  v_add_f32 v58, v58, v59
  v_mov_b32 v57, v56
  v_mov_b32 v59, v58
  s_nop 0
  v_permlane32_swap_b32 v56, v57
  v_permlane32_swap_b32 v58, v59
  v_add_f32 v56, v56, v57
  v_add_f32 v58, v58, v59
  v_cmp_u_f32 vcc, v56, v56
  s_nop 1
  s_cbranch_vccz LokB
  s_cmp_eq_u32 s100, 0
  s_cbranch_scc1 LokB
  s_sub_u32 s100, s100, 1
  s_sub_u32 s54, s54, 73728
  s_branch LrB
LokB:
  v_mul_f32 v56, 0x3ae38e39, v56
  v_mul_f32 v58, 0x3ae38e39, v58
  v_fma_f32 v58, -v56, v56, v58
  v_max_f32 v58, 0, v58
  v_add_f32 v57, 0x3727c5ac, v58
  v_rsq_f32 v60, v57
  s_nop 0
  v_mul_f32 v58, v58, v60
  v_fmaak_f32 v58, v58, v60, 0x3727c5ac
  v_rsq_f32 v58, v58
  s_nop 0
  v_mul_f32 v60, v60, v58
  v_mul_f32 v58, v56, v60
  v_sub_f32 v58, 0, v58
  v_lshlrev_b32 v64, 16, v112
  v_and_b32 v65, 0xffff0000, v112
  v_lshlrev_b32 v66, 16, v113
  v_and_b32 v67, 0xffff0000, v113
  v_lshlrev_b32 v68, 16, v114
  v_and_b32 v69, 0xffff0000, v114
  v_lshlrev_b32 v70, 16, v115
  v_and_b32 v71, 0xffff0000, v115
  v_pk_fma_f32 v[64:65], v[64:65], v[60:61], v[58:59] op_sel_hi:[1,0,0]
  v_pk_fma_f32 v[66:67], v[66:67], v[60:61], v[58:59] op_sel_hi:[1,0,0]
  v_pk_fma_f32 v[68:69], v[68:69], v[60:61], v[58:59] op_sel_hi:[1,0,0]
  v_pk_fma_f32 v[70:71], v[70:71], v[60:61], v[58:59] op_sel_hi:[1,0,0]
  v_cvt_pk_bf16_f32 v112, v64, v65
  v_cvt_pk_bf16_f32 v113, v66, v67
  v_cvt_pk_bf16_f32 v114, v68, v69
  v_cvt_pk_bf16_f32 v115, v70, v71
  ds_write_b128 v7, v[112:115] offset:0
  v_lshlrev_b32 v64, 16, v116
  v_and_b32 v65, 0xffff0000, v116
  v_lshlrev_b32 v66, 16, v117
  v_and_b32 v67, 0xffff0000, v117
  v_lshlrev_b32 v68, 16, v118
  v_and_b32 v69, 0xffff0000, v118
  v_lshlrev_b32 v70, 16, v119
  v_and_b32 v71, 0xffff0000, v119
  v_pk_fma_f32 v[64:65], v[64:65], v[60:61], v[58:59] op_sel_hi:[1,0,0]
  v_pk_fma_f32 v[66:67], v[66:67], v[60:61], v[58:59] op_sel_hi:[1,0,0]
  v_pk_fma_f32 v[68:69], v[68:69], v[60:61], v[58:59] op_sel_hi:[1,0,0]
  v_pk_fma_f32 v[70:71], v[70:71], v[60:61], v[58:59] op_sel_hi:[1,0,0]
  v_cvt_pk_bf16_f32 v116, v64, v65
  v_cvt_pk_bf16_f32 v117, v66, v67
  v_cvt_pk_bf16_f32 v118, v68, v69
  v_cvt_pk_bf16_f32 v119, v70, v71
  ds_write_b128 v7, v[116:119] offset:2048
  v_lshlrev_b32 v64, 16, v120
  v_and_b32 v65, 0xffff0000, v120
  v_lshlrev_b32 v66, 16, v121
  v_and_b32 v67, 0xffff0000, v121
  v_lshlrev_b32 v68, 16, v122
  v_and_b32 v69, 0xffff0000, v122
  v_lshlrev_b32 v70, 16, v123
  v_and_b32 v71, 0xffff0000, v123
  v_pk_fma_f32 v[64:65], v[64:65], v[60:61], v[58:59] op_sel_hi:[1,0,0]
  v_pk_fma_f32 v[66:67], v[66:67], v[60:61], v[58:59] op_sel_hi:[1,0,0]
  v_pk_fma_f32 v[68:69], v[68:69], v[60:61], v[58:59] op_sel_hi:[1,0,0]
  v_pk_fma_f32 v[70:71], v[70:71], v[60:61], v[58:59] op_sel_hi:[1,0,0]
  v_cvt_pk_bf16_f32 v120, v64, v65
  v_cvt_pk_bf16_f32 v121, v66, v67
  v_cvt_pk_bf16_f32 v122, v68, v69
  v_cvt_pk_bf16_f32 v123, v70, v71
  ds_write_b128 v7, v[120:123] offset:4096
  v_lshlrev_b32 v64, 16, v124
  v_and_b32 v65, 0xffff0000, v124
  v_lshlrev_b32 v66, 16, v125
  v_and_b32 v67, 0xffff0000, v125
  v_lshlrev_b32 v68, 16, v126
  v_and_b32 v69, 0xffff0000, v126
  v_lshlrev_b32 v70, 16, v127
  v_and_b32 v71, 0xffff0000, v127
  v_pk_fma_f32 v[64:65], v[64:65], v[60:61], v[58:59] op_sel_hi:[1,0,0]
  v_pk_fma_f32 v[66:67], v[66:67], v[60:61], v[58:59] op_sel_hi:[1,0,0]
  v_pk_fma_f32 v[68:69], v[68:69], v[60:61], v[58:59] op_sel_hi:[1,0,0]
  v_pk_fma_f32 v[70:71], v[70:71], v[60:61], v[58:59] op_sel_hi:[1,0,0]
  v_cvt_pk_bf16_f32 v124, v64, v65
  v_cvt_pk_bf16_f32 v125, v66, v67
  v_cvt_pk_bf16_f32 v126, v68, v69
  v_cvt_pk_bf16_f32 v127, v70, v71
  ds_write_b128 v7, v[124:127] offset:6144
  v_lshlrev_b32 v64, 16, v128
  v_and_b32 v65, 0xffff0000, v128
  v_lshlrev_b32 v66, 16, v129
  v_and_b32 v67, 0xffff0000, v129
  v_lshlrev_b32 v68, 16, v130
  v_and_b32 v69, 0xffff0000, v130
  v_lshlrev_b32 v70, 16, v131
  v_and_b32 v71, 0xffff0000, v131
  v_pk_fma_f32 v[64:65], v[64:65], v[60:61], v[58:59] op_sel_hi:[1,0,0]
  v_pk_fma_f32 v[66:67], v[66:67], v[60:61], v[58:59] op_sel_hi:[1,0,0]
  v_pk_fma_f32 v[68:69], v[68:69], v[60:61], v[58:59] op_sel_hi:[1,0,0]
  v_pk_fma_f32 v[70:71], v[70:71], v[60:61], v[58:59] op_sel_hi:[1,0,0]
  v_cvt_pk_bf16_f32 v128, v64, v65
  v_cvt_pk_bf16_f32 v129, v66, v67
  v_cvt_pk_bf16_f32 v130, v68, v69
  v_cvt_pk_bf16_f32 v131, v70, v71
  ds_write_b128 v7, v[128:131] offset:8192
  v_lshlrev_b32 v64, 16, v132
  v_and_b32 v65, 0xffff0000, v132
  v_lshlrev_b32 v66, 16, v133
  v_and_b32 v67, 0xffff0000, v133
  v_lshlrev_b32 v68, 16, v134
  v_and_b32 v69, 0xffff0000, v134
  v_lshlrev_b32 v70, 16, v135
  v_and_b32 v71, 0xffff0000, v135
  v_pk_fma_f32 v[64:65], v[64:65], v[60:61], v[58:59] op_sel_hi:[1,0,0]
  v_pk_fma_f32 v[66:67], v[66:67], v[60:61], v[58:59] op_sel_hi:[1,0,0]
  v_pk_fma_f32 v[68:69], v[68:69], v[60:61], v[58:59] op_sel_hi:[1,0,0]
  v_pk_fma_f32 v[70:71], v[70:71], v[60:61], v[58:59] op_sel_hi:[1,0,0]
  v_cvt_pk_bf16_f32 v132, v64, v65
  v_cvt_pk_bf16_f32 v133, v66, v67
  v_cvt_pk_bf16_f32 v134, v68, v69
  v_cvt_pk_bf16_f32 v135, v70, v71
  ds_write_b128 v7, v[132:135] offset:10240
  v_lshlrev_b32 v64, 16, v136
  v_and_b32 v65, 0xffff0000, v136
  v_lshlrev_b32 v66, 16, v137
  v_and_b32 v67, 0xffff0000, v137
  v_lshlrev_b32 v68, 16, v138
  v_and_b32 v69, 0xffff0000, v138
  v_lshlrev_b32 v70, 16, v139
  v_and_b32 v71, 0xffff0000, v139
  v_pk_fma_f32 v[64:65], v[64:65], v[60:61], v[58:59] op_sel_hi:[1,0,0]
  v_pk_fma_f32 v[66:67], v[66:67], v[60:61], v[58:59] op_sel_hi:[1,0,0]
  v_pk_fma_f32 v[68:69], v[68:69], v[60:61], v[58:59] op_sel_hi:[1,0,0]
  v_pk_fma_f32 v[70:71], v[70:71], v[60:61], v[58:59] op_sel_hi:[1,0,0]
  v_cvt_pk_bf16_f32 v136, v64, v65
  v_cvt_pk_bf16_f32 v137, v66, v67
  v_cvt_pk_bf16_f32 v138, v68, v69
  v_cvt_pk_bf16_f32 v139, v70, v71
  ds_write_b128 v7, v[136:139] offset:12288
  v_lshlrev_b32 v64, 16, v140
  v_and_b32 v65, 0xffff0000, v140
  v_lshlrev_b32 v66, 16, v141
  v_and_b32 v67, 0xffff0000, v141
  v_lshlrev_b32 v68, 16, v142
  v_and_b32 v69, 0xffff0000, v142
  v_lshlrev_b32 v70, 16, v143
  v_and_b32 v71, 0xffff0000, v143
  v_pk_fma_f32 v[64:65], v[64:65], v[60:61], v[58:59] op_sel_hi:[1,0,0]
  v_pk_fma_f32 v[66:67], v[66:67], v[60:61], v[58:59] op_sel_hi:[1,0,0]
  v_pk_fma_f32 v[68:69], v[68:69], v[60:61], v[58:59] op_sel_hi:[1,0,0]
  v_pk_fma_f32 v[70:71], v[70:71], v[60:61], v[58:59] op_sel_hi:[1,0,0]
  v_cvt_pk_bf16_f32 v140, v64, v65
  v_cvt_pk_bf16_f32 v141, v66, v67
  v_cvt_pk_bf16_f32 v142, v68, v69
  v_cvt_pk_bf16_f32 v143, v70, v71
  ds_write_b128 v7, v[140:143] offset:14336
  v_lshlrev_b32 v64, 16, v144
  v_and_b32 v65, 0xffff0000, v144
  v_lshlrev_b32 v66, 16, v145
  v_and_b32 v67, 0xffff0000, v145
  v_lshlrev_b32 v68, 16, v146
  v_and_b32 v69, 0xffff0000, v146
  v_lshlrev_b32 v70, 16, v147
  v_and_b32 v71, 0xffff0000, v147
  v_pk_fma_f32 v[64:65], v[64:65], v[60:61], v[58:59] op_sel_hi:[1,0,0]
  v_pk_fma_f32 v[66:67], v[66:67], v[60:61], v[58:59] op_sel_hi:[1,0,0]
  v_pk_fma_f32 v[68:69], v[68:69], v[60:61], v[58:59] op_sel_hi:[1,0,0]
  v_pk_fma_f32 v[70:71], v[70:71], v[60:61], v[58:59] op_sel_hi:[1,0,0]
  v_cvt_pk_bf16_f32 v144, v64, v65
  v_cvt_pk_bf16_f32 v145, v66, v67
  v_cvt_pk_bf16_f32 v146, v68, v69
  v_cvt_pk_bf16_f32 v147, v70, v71
  ds_write_b128 v7, v[144:147] offset:16384
  v_lshlrev_b32 v64, 16, v148
  v_and_b32 v65, 0xffff0000, v148
  v_lshlrev_b32 v66, 16, v149
  v_and_b32 v67, 0xffff0000, v149
  v_lshlrev_b32 v68, 16, v150
  v_and_b32 v69, 0xffff0000, v150
  v_lshlrev_b32 v70, 16, v151
  v_and_b32 v71, 0xffff0000, v151
  v_pk_fma_f32 v[64:65], v[64:65], v[60:61], v[58:59] op_sel_hi:[1,0,0]
  v_pk_fma_f32 v[66:67], v[66:67], v[60:61], v[58:59] op_sel_hi:[1,0,0]
  v_pk_fma_f32 v[68:69], v[68:69], v[60:61], v[58:59] op_sel_hi:[1,0,0]
  v_pk_fma_f32 v[70:71], v[70:71], v[60:61], v[58:59] op_sel_hi:[1,0,0]
  v_cvt_pk_bf16_f32 v148, v64, v65
  v_cvt_pk_bf16_f32 v149, v66, v67
  v_cvt_pk_bf16_f32 v150, v68, v69
  v_cvt_pk_bf16_f32 v151, v70, v71
  ds_write_b128 v7, v[148:151] offset:18432
  v_lshlrev_b32 v64, 16, v152
  v_and_b32 v65, 0xffff0000, v152
  v_lshlrev_b32 v66, 16, v153
  v_and_b32 v67, 0xffff0000, v153
  v_lshlrev_b32 v68, 16, v154
  v_and_b32 v69, 0xffff0000, v154
  v_lshlrev_b32 v70, 16, v155
  v_and_b32 v71, 0xffff0000, v155
  v_pk_fma_f32 v[64:65], v[64:65], v[60:61], v[58:59] op_sel_hi:[1,0,0]
  v_pk_fma_f32 v[66:67], v[66:67], v[60:61], v[58:59] op_sel_hi:[1,0,0]
  v_pk_fma_f32 v[68:69], v[68:69], v[60:61], v[58:59] op_sel_hi:[1,0,0]
  v_pk_fma_f32 v[70:71], v[70:71], v[60:61], v[58:59] op_sel_hi:[1,0,0]
  v_cvt_pk_bf16_f32 v152, v64, v65
  v_cvt_pk_bf16_f32 v153, v66, v67
  v_cvt_pk_bf16_f32 v154, v68, v69
  v_cvt_pk_bf16_f32 v155, v70, v71
  ds_write_b128 v7, v[152:155] offset:20480
  v_lshlrev_b32 v64, 16, v156
  v_and_b32 v65, 0xffff0000, v156
  v_lshlrev_b32 v66, 16, v157
  v_and_b32 v67, 0xffff0000, v157
  v_lshlrev_b32 v68, 16, v158
  v_and_b32 v69, 0xffff0000, v158
  v_lshlrev_b32 v70, 16, v159
  v_and_b32 v71, 0xffff0000, v159
  v_pk_fma_f32 v[64:65], v[64:65], v[60:61], v[58:59] op_sel_hi:[1,0,0]
  v_pk_fma_f32 v[66:67], v[66:67], v[60:61], v[58:59] op_sel_hi:[1,0,0]
  v_pk_fma_f32 v[68:69], v[68:69], v[60:61], v[58:59] op_sel_hi:[1,0,0]
  v_pk_fma_f32 v[70:71], v[70:71], v[60:61], v[58:59] op_sel_hi:[1,0,0]
  v_cvt_pk_bf16_f32 v156, v64, v65
  v_cvt_pk_bf16_f32 v157, v66, v67
  v_cvt_pk_bf16_f32 v158, v68, v69
  v_cvt_pk_bf16_f32 v159, v70, v71
  ds_write_b128 v7, v[156:159] offset:22528
  v_lshlrev_b32 v64, 16, v160
  v_and_b32 v65, 0xffff0000, v160
  v_lshlrev_b32 v66, 16, v161
  v_and_b32 v67, 0xffff0000, v161
  v_lshlrev_b32 v68, 16, v162
  v_and_b32 v69, 0xffff0000, v162
  v_lshlrev_b32 v70, 16, v163
  v_and_b32 v71, 0xffff0000, v163
  v_pk_fma_f32 v[64:65], v[64:65], v[60:61], v[58:59] op_sel_hi:[1,0,0]
  v_pk_fma_f32 v[66:67], v[66:67], v[60:61], v[58:59] op_sel_hi:[1,0,0]
  v_pk_fma_f32 v[68:69], v[68:69], v[60:61], v[58:59] op_sel_hi:[1,0,0]
  v_pk_fma_f32 v[70:71], v[70:71], v[60:61], v[58:59] op_sel_hi:[1,0,0]
  v_cvt_pk_bf16_f32 v160, v64, v65
  v_cvt_pk_bf16_f32 v161, v66, v67
  v_cvt_pk_bf16_f32 v162, v68, v69
  v_cvt_pk_bf16_f32 v163, v70, v71
  ds_write_b128 v7, v[160:163] offset:24576
  v_lshlrev_b32 v64, 16, v164
  v_and_b32 v65, 0xffff0000, v164
  v_lshlrev_b32 v66, 16, v165
  v_and_b32 v67, 0xffff0000, v165
  v_lshlrev_b32 v68, 16, v166
  v_and_b32 v69, 0xffff0000, v166
  v_lshlrev_b32 v70, 16, v167
  v_and_b32 v71, 0xffff0000, v167
  v_pk_fma_f32 v[64:65], v[64:65], v[60:61], v[58:59] op_sel_hi:[1,0,0]
  v_pk_fma_f32 v[66:67], v[66:67], v[60:61], v[58:59] op_sel_hi:[1,0,0]
  v_pk_fma_f32 v[68:69], v[68:69], v[60:61], v[58:59] op_sel_hi:[1,0,0]
  v_pk_fma_f32 v[70:71], v[70:71], v[60:61], v[58:59] op_sel_hi:[1,0,0]
  v_cvt_pk_bf16_f32 v164, v64, v65
  v_cvt_pk_bf16_f32 v165, v66, v67
  v_cvt_pk_bf16_f32 v166, v68, v69
  v_cvt_pk_bf16_f32 v167, v70, v71
  ds_write_b128 v7, v[164:167] offset:26624
  v_lshlrev_b32 v64, 16, v168
  v_and_b32 v65, 0xffff0000, v168
  v_lshlrev_b32 v66, 16, v169
  v_and_b32 v67, 0xffff0000, v169
  v_lshlrev_b32 v68, 16, v170
  v_and_b32 v69, 0xffff0000, v170
  v_lshlrev_b32 v70, 16, v171
  v_and_b32 v71, 0xffff0000, v171
  v_pk_fma_f32 v[64:65], v[64:65], v[60:61], v[58:59] op_sel_hi:[1,0,0]
  v_pk_fma_f32 v[66:67], v[66:67], v[60:61], v[58:59] op_sel_hi:[1,0,0]
  v_pk_fma_f32 v[68:69], v[68:69], v[60:61], v[58:59] op_sel_hi:[1,0,0]
  v_pk_fma_f32 v[70:71], v[70:71], v[60:61], v[58:59] op_sel_hi:[1,0,0]
  v_cvt_pk_bf16_f32 v168, v64, v65
  v_cvt_pk_bf16_f32 v169, v66, v67
  v_cvt_pk_bf16_f32 v170, v68, v69
  v_cvt_pk_bf16_f32 v171, v70, v71
  ds_write_b128 v7, v[168:171] offset:28672
  v_lshlrev_b32 v64, 16, v172
  v_and_b32 v65, 0xffff0000, v172
  v_lshlrev_b32 v66, 16, v173
  v_and_b32 v67, 0xffff0000, v173
  v_lshlrev_b32 v68, 16, v174
  v_and_b32 v69, 0xffff0000, v174
  v_lshlrev_b32 v70, 16, v175
  v_and_b32 v71, 0xffff0000, v175
  v_pk_fma_f32 v[64:65], v[64:65], v[60:61], v[58:59] op_sel_hi:[1,0,0]
  v_pk_fma_f32 v[66:67], v[66:67], v[60:61], v[58:59] op_sel_hi:[1,0,0]
  v_pk_fma_f32 v[68:69], v[68:69], v[60:61], v[58:59] op_sel_hi:[1,0,0]
  v_pk_fma_f32 v[70:71], v[70:71], v[60:61], v[58:59] op_sel_hi:[1,0,0]
  v_cvt_pk_bf16_f32 v172, v64, v65
  v_cvt_pk_bf16_f32 v173, v66, v67
  v_cvt_pk_bf16_f32 v174, v68, v69
  v_cvt_pk_bf16_f32 v175, v70, v71
  ds_write_b128 v7, v[172:175] offset:30720
  v_lshlrev_b32 v64, 16, v176
  v_and_b32 v65, 0xffff0000, v176
  v_lshlrev_b32 v66, 16, v177
  v_and_b32 v67, 0xffff0000, v177
  v_lshlrev_b32 v68, 16, v178
  v_and_b32 v69, 0xffff0000, v178
  v_lshlrev_b32 v70, 16, v179
  v_and_b32 v71, 0xffff0000, v179
  v_pk_fma_f32 v[64:65], v[64:65], v[60:61], v[58:59] op_sel_hi:[1,0,0]
  v_pk_fma_f32 v[66:67], v[66:67], v[60:61], v[58:59] op_sel_hi:[1,0,0]
  v_pk_fma_f32 v[68:69], v[68:69], v[60:61], v[58:59] op_sel_hi:[1,0,0]
  v_pk_fma_f32 v[70:71], v[70:71], v[60:61], v[58:59] op_sel_hi:[1,0,0]
  v_cvt_pk_bf16_f32 v176, v64, v65
  v_cvt_pk_bf16_f32 v177, v66, v67
  v_cvt_pk_bf16_f32 v178, v68, v69
  v_cvt_pk_bf16_f32 v179, v70, v71
  ds_write_b128 v7, v[176:179] offset:32768
  v_lshlrev_b32 v64, 16, v180
  v_and_b32 v65, 0xffff0000, v180
  v_lshlrev_b32 v66, 16, v181
  v_and_b32 v67, 0xffff0000, v181
  v_lshlrev_b32 v68, 16, v182
  v_and_b32 v69, 0xffff0000, v182
  v_lshlrev_b32 v70, 16, v183
  v_and_b32 v71, 0xffff0000, v183
  v_pk_fma_f32 v[64:65], v[64:65], v[60:61], v[58:59] op_sel_hi:[1,0,0]
  v_pk_fma_f32 v[66:67], v[66:67], v[60:61], v[58:59] op_sel_hi:[1,0,0]
  v_pk_fma_f32 v[68:69], v[68:69], v[60:61], v[58:59] op_sel_hi:[1,0,0]
  v_pk_fma_f32 v[70:71], v[70:71], v[60:61], v[58:59] op_sel_hi:[1,0,0]
  v_cvt_pk_bf16_f32 v180, v64, v65
  v_cvt_pk_bf16_f32 v181, v66, v67
  v_cvt_pk_bf16_f32 v182, v68, v69
  v_cvt_pk_bf16_f32 v183, v70, v71
  ds_write_b128 v7, v[180:183] offset:34816
  s_waitcnt lgkmcnt(0)
  s_barrier
  ds_read_b128 a[0:3], v4 offset:0
  ds_read_b128 a[4:7], v5 offset:1024
  ds_read_b128 a[8:11], v4 offset:2048
  ds_read_b128 a[12:15], v5 offset:3072
  ds_read_b128 a[16:19], v4 offset:4096
  ds_read_b128 a[20:23], v5 offset:5120
  ds_read_b128 a[24:27], v4 offset:6144
  ds_read_b128 a[28:31], v5 offset:7168
  ds_read_b128 a[32:35], v4 offset:8192
  ds_read_b128 a[36:39], v5 offset:9216
  ds_read_b128 a[40:43], v4 offset:10240
  ds_read_b128 a[44:47], v5 offset:11264
  ds_read_b128 a[48:51], v4 offset:12288
  ds_read_b128 a[52:55], v5 offset:13312
  ds_read_b128 a[56:59], v4 offset:14336
  ds_read_b128 a[60:63], v5 offset:15360
  ds_read_b128 a[64:67], v4 offset:16384
  ds_read_b128 a[68:71], v5 offset:17408
  ds_read_b128 a[72:75], v4 offset:18432
  ds_read_b128 a[76:79], v5 offset:19456
  ds_read_b128 a[80:83], v4 offset:20480
  ds_read_b128 a[84:87], v5 offset:21504
  ds_read_b128 a[88:91], v4 offset:22528
  ds_read_b128 a[92:95], v5 offset:23552
  ds_read_b128 a[96:99], v4 offset:24576
  ds_read_b128 a[100:103], v5 offset:25600
  ds_read_b128 a[104:107], v4 offset:26624
  ds_read_b128 a[108:111], v5 offset:27648
  ds_read_b128 a[112:115], v4 offset:28672
  ds_read_b128 a[116:119], v5 offset:29696
  ds_read_b128 a[120:123], v4 offset:30720
  ds_read_b128 a[124:127], v5 offset:31744
  ds_read_b128 a[128:131], v4 offset:32768
  ds_read_b128 a[132:135], v5 offset:33792
  ds_read_b128 a[136:139], v4 offset:34816
  ds_read_b128 a[140:143], v5 offset:35840
  s_mul_i32 s68, s49, 196608
  s_lshl_b32 s69, s44, 10
  s_add_u32 s68, s68, s69
  s_add_u32 s68, s68, 163840
  s_lshl_b32 s69, s45, 7
  s_add_u32 s68, s68, s69
  v_mov_b32 v96, 1
  s_lshl_b32 s53, s45, 7
  s_waitcnt lgkmcnt(0)
  s_barrier
  ds_read_b64_tr_b16 a[176:177], v104 offset:0
  ds_read_b64_tr_b16 a[178:179], v104 offset:512
  ds_read_b64_tr_b16 a[180:181], v104 offset:2048
  ds_read_b64_tr_b16 a[182:183], v104 offset:2560
  ds_read_b64_tr_b16 a[184:185], v104 offset:4096
  ds_read_b64_tr_b16 a[186:187], v104 offset:4608
  ds_read_b64_tr_b16 a[188:189], v104 offset:6144
  ds_read_b64_tr_b16 a[190:191], v104 offset:6656
  ds_read_b64_tr_b16 a[192:193], v104 offset:8192
  ds_read_b64_tr_b16 a[194:195], v104 offset:8704
  ds_read_b64_tr_b16 a[196:197], v104 offset:10240
  ds_read_b64_tr_b16 a[198:199], v104 offset:10752
  v_mfma_f32_32x32x16_bf16 v[64:79], a[144:147], a[164:167], 0
  s_add_u32 s62, s63, 128
  s_add_u32 m0, s61, 73728
  s_waitcnt lgkmcnt(4)
  v_mfma_f32_32x32x16_bf16 v[64:79], a[176:179], a[0:3], v[64:79]
  ds_read_b64_tr_b16 a[200:201], v104 offset:12288
  ds_read_b64_tr_b16 a[202:203], v104 offset:12800
  buffer_load_dwordx4 v10, s[16:19], s62 offen offset:0 lds
  buffer_load_dwordx4 v11, s[16:19], s62 offen offset:1024 lds
  buffer_load_dwordx4 v12, s[16:19], s62 offen offset:2048 lds
  v_mfma_f32_32x32x16_bf16 v[64:79], a[180:183], a[4:7], v[64:79]
  ds_read_b64_tr_b16 a[204:205], v104 offset:14336
  ds_read_b64_tr_b16 a[206:207], v104 offset:14848
  s_add_u32 s62, s63, 221312
  s_add_u32 m0, s61, 76800
  v_mfma_f32_32x32x16_bf16 v[64:79], a[184:187], a[8:11], v[64:79]
  ds_read_b64_tr_b16 a[176:177], v104 offset:16384
  ds_read_b64_tr_b16 a[178:179], v104 offset:16896
  buffer_load_dwordx4 v10, s[16:19], s62 offen offset:0 lds
  buffer_load_dwordx4 v11, s[16:19], s62 offen offset:1024 lds
  buffer_load_dwordx4 v12, s[16:19], s62 offen offset:2048 lds
  v_mfma_f32_32x32x16_bf16 v[64:79], a[188:191], a[12:15], v[64:79]
  ds_read_b64_tr_b16 a[180:181], v104 offset:18432
  ds_read_b64_tr_b16 a[182:183], v104 offset:18944
  s_add_u32 s62, s63, 1769600
  s_add_u32 m0, s61, 98304
  s_waitcnt lgkmcnt(4)
  v_mfma_f32_32x32x16_bf16 v[64:79], a[192:195], a[16:19], v[64:79]
  ds_read_b64_tr_b16 a[184:185], v104 offset:20480
  ds_read_b64_tr_b16 a[186:187], v104 offset:20992
  buffer_load_dwordx4 v10, s[16:19], s62 offen offset:0 lds
  buffer_load_dwordx4 v11, s[16:19], s62 offen offset:1024 lds
  buffer_load_dwordx4 v12, s[16:19], s62 offen offset:2048 lds
  v_mfma_f32_32x32x16_bf16 v[64:79], a[196:199], a[20:23], v[64:79]
  ds_read_b64_tr_b16 a[188:189], v104 offset:22528
  ds_read_b64_tr_b16 a[190:191], v104 offset:23040
  s_add_u32 s62, s63, 1990784
  s_add_u32 m0, s61, 101376
  v_mfma_f32_32x32x16_bf16 v[64:79], a[200:203], a[24:27], v[64:79]
  s_barrier
  ds_read_b64_tr_b16 a[192:193], v104 offset:24576
  ds_read_b64_tr_b16 a[194:195], v104 offset:25088
  buffer_load_dwordx4 v10, s[16:19], s62 offen offset:0 lds
  buffer_load_dwordx4 v11, s[16:19], s62 offen offset:1024 lds
  buffer_load_dwordx4 v12, s[16:19], s62 offen offset:2048 lds
  v_mfma_f32_32x32x16_bf16 v[64:79], a[204:207], a[28:31], v[64:79]
  ds_read_b64_tr_b16 a[196:197], v104 offset:26624
  ds_read_b64_tr_b16 a[198:199], v104 offset:27136
  s_add_u32 s62, s63, 3539072
  s_waitcnt lgkmcnt(4)
  v_mfma_f32_32x32x16_bf16 v[64:79], a[176:179], a[32:35], v[64:79]
  ds_read_b64_tr_b16 a[200:201], v104 offset:28672
  ds_read_b64_tr_b16 a[202:203], v104 offset:29184
  s_add_u32 m0, s61, 122880
  v_mfma_f32_32x32x16_bf16 v[64:79], a[180:183], a[36:39], v[64:79]
  ds_read_b64_tr_b16 a[204:205], v104 offset:30720
  ds_read_b64_tr_b16 a[206:207], v104 offset:31232
  buffer_load_dwordx4 v10, s[16:19], s62 offen offset:0 lds
  v_mfma_f32_32x32x16_bf16 v[64:79], a[184:187], a[40:43], v[64:79]
  ds_read_b64_tr_b16 a[176:177], v104 offset:32768
  ds_read_b64_tr_b16 a[178:179], v104 offset:33280
  buffer_load_dwordx4 v11, s[16:19], s62 offen offset:1024 lds
  v_mfma_f32_32x32x16_bf16 v[64:79], a[188:191], a[44:47], v[64:79]
  ds_read_b64_tr_b16 a[180:181], v104 offset:34816
  ds_read_b64_tr_b16 a[182:183], v104 offset:35328
  buffer_load_dwordx4 v12, s[16:19], s62 offen offset:2048 lds
  s_waitcnt lgkmcnt(4)
  v_mfma_f32_32x32x16_bf16 v[64:79], a[192:195], a[48:51], v[64:79]
  ds_read_b64_tr_b16 a[184:185], v104 offset:36864
  ds_read_b64_tr_b16 a[186:187], v104 offset:37376
  v_mfma_f32_32x32x16_bf16 v[64:79], a[196:199], a[52:55], v[64:79]
  ds_read_b64_tr_b16 a[188:189], v104 offset:38912
  ds_read_b64_tr_b16 a[190:191], v104 offset:39424
  s_add_u32 s62, s63, 3760256
  v_mfma_f32_32x32x16_bf16 v[64:79], a[200:203], a[56:59], v[64:79]
  ds_read_b64_tr_b16 a[192:193], v104 offset:40960
  ds_read_b64_tr_b16 a[194:195], v104 offset:41472
  s_add_u32 m0, s61, 125952
  v_mfma_f32_32x32x16_bf16 v[64:79], a[204:207], a[60:63], v[64:79]
  ds_read_b64_tr_b16 a[196:197], v104 offset:43008
  ds_read_b64_tr_b16 a[198:199], v104 offset:43520
  buffer_load_dwordx4 v10, s[16:19], s62 offen offset:0 lds
  s_waitcnt lgkmcnt(4)
  v_mfma_f32_32x32x16_bf16 v[64:79], a[176:179], a[64:67], v[64:79]
  ds_read_b64_tr_b16 a[200:201], v104 offset:45056
  ds_read_b64_tr_b16 a[202:203], v104 offset:45568
  buffer_load_dwordx4 v11, s[16:19], s62 offen offset:1024 lds
  v_mfma_f32_32x32x16_bf16 v[64:79], a[180:183], a[68:71], v[64:79]
  ds_read_b64_tr_b16 a[204:205], v104 offset:47104
  ds_read_b64_tr_b16 a[206:207], v104 offset:47616
  buffer_load_dwordx4 v12, s[16:19], s62 offen offset:2048 lds
  v_mfma_f32_32x32x16_bf16 v[64:79], a[184:187], a[72:75], v[64:79]
  s_barrier
  ds_read_b64_tr_b16 a[176:177], v105 offset:0
  ds_read_b64_tr_b16 a[178:179], v105 offset:512
  v_mfma_f32_32x32x16_bf16 v[64:79], a[188:191], a[76:79], v[64:79]
  ds_read_b64_tr_b16 a[180:181], v105 offset:2048
  ds_read_b64_tr_b16 a[182:183], v105 offset:2560
  s_add_u32 s62, s63, 256
  s_waitcnt lgkmcnt(4)
  v_mfma_f32_32x32x16_bf16 v[64:79], a[192:195], a[80:83], v[64:79]
  ds_read_b64_tr_b16 a[184:185], v105 offset:4096
  ds_read_b64_tr_b16 a[186:187], v105 offset:4608
  s_add_u32 m0, s61, 0
  v_mfma_f32_32x32x16_bf16 v[64:79], a[196:199], a[84:87], v[64:79]
  ds_read_b64_tr_b16 a[188:189], v105 offset:6144
  ds_read_b64_tr_b16 a[190:191], v105 offset:6656
  buffer_load_dwordx4 v10, s[16:19], s62 offen offset:0 lds
  v_mfma_f32_32x32x16_bf16 v[64:79], a[200:203], a[88:91], v[64:79]
  ds_read_b64_tr_b16 a[192:193], v105 offset:8192
  ds_read_b64_tr_b16 a[194:195], v105 offset:8704
  buffer_load_dwordx4 v11, s[16:19], s62 offen offset:1024 lds
  v_mfma_f32_32x32x16_bf16 v[64:79], a[204:207], a[92:95], v[64:79]
  ds_read_b64_tr_b16 a[196:197], v105 offset:10240
  ds_read_b64_tr_b16 a[198:199], v105 offset:10752
  buffer_load_dwordx4 v12, s[16:19], s62 offen offset:2048 lds
  s_waitcnt lgkmcnt(4)
  v_mfma_f32_32x32x16_bf16 v[64:79], a[176:179], a[96:99], v[64:79]
  ds_read_b64_tr_b16 a[200:201], v105 offset:12288
  ds_read_b64_tr_b16 a[202:203], v105 offset:12800
  v_mfma_f32_32x32x16_bf16 v[64:79], a[180:183], a[100:103], v[64:79]
  ds_read_b64_tr_b16 a[204:205], v105 offset:14336
  ds_read_b64_tr_b16 a[206:207], v105 offset:14848
  s_add_u32 s62, s63, 221440
  v_mfma_f32_32x32x16_bf16 v[64:79], a[184:187], a[104:107], v[64:79]
  ds_read_b64_tr_b16 a[176:177], v105 offset:16384
  ds_read_b64_tr_b16 a[178:179], v105 offset:16896
  s_add_u32 m0, s61, 3072
  v_mfma_f32_32x32x16_bf16 v[64:79], a[188:191], a[108:111], v[64:79]
  ds_read_b64_tr_b16 a[180:181], v105 offset:18432
  ds_read_b64_tr_b16 a[182:183], v105 offset:18944
  buffer_load_dwordx4 v10, s[16:19], s62 offen offset:0 lds
  s_waitcnt lgkmcnt(4)
  v_mfma_f32_32x32x16_bf16 v[64:79], a[192:195], a[112:115], v[64:79]
  ds_read_b64_tr_b16 a[184:185], v105 offset:20480
  ds_read_b64_tr_b16 a[186:187], v105 offset:20992
  buffer_load_dwordx4 v11, s[16:19], s62 offen offset:1024 lds
  v_mfma_f32_32x32x16_bf16 v[64:79], a[196:199], a[116:119], v[64:79]
  ds_read_b64_tr_b16 a[188:189], v105 offset:22528
  ds_read_b64_tr_b16 a[190:191], v105 offset:23040
  buffer_load_dwordx4 v12, s[16:19], s62 offen offset:2048 lds
  v_mfma_f32_32x32x16_bf16 v[64:79], a[200:203], a[120:123], v[64:79]
  s_waitcnt vmcnt(18)
  s_barrier
  ds_read_b64_tr_b16 a[192:193], v105 offset:24576
  ds_read_b64_tr_b16 a[194:195], v105 offset:25088
  v_mfma_f32_32x32x16_bf16 v[64:79], a[204:207], a[124:127], v[64:79]
  ds_read_b64_tr_b16 a[196:197], v105 offset:26624
  ds_read_b64_tr_b16 a[198:199], v105 offset:27136
  s_add_u32 s62, s63, 1769728
  s_waitcnt lgkmcnt(4)
  v_mfma_f32_32x32x16_bf16 v[64:79], a[176:179], a[128:131], v[64:79]
  ds_read_b64_tr_b16 a[200:201], v105 offset:28672
  ds_read_b64_tr_b16 a[202:203], v105 offset:29184
  s_add_u32 m0, s61, 24576
  v_mfma_f32_32x32x16_bf16 v[64:79], a[180:183], a[132:135], v[64:79]
  ds_read_b64_tr_b16 a[204:205], v105 offset:30720
  ds_read_b64_tr_b16 a[206:207], v105 offset:31232
  v_mfma_f32_32x32x16_bf16 v[64:79], a[184:187], a[136:139], v[64:79]
  ds_read_b64_tr_b16 a[176:177], v105 offset:32768
  ds_read_b64_tr_b16 a[178:179], v105 offset:33280
  buffer_load_dwordx4 v10, s[16:19], s62 offen offset:0 lds
  v_mfma_f32_32x32x16_bf16 v[64:79], a[188:191], a[140:143], v[64:79]
  ds_read_b64_tr_b16 a[180:181], v105 offset:34816
  ds_read_b64_tr_b16 a[182:183], v105 offset:35328
  buffer_load_dwordx4 v11, s[16:19], s62 offen offset:1024 lds
  v_mfma_f32_32x32x16_bf16 v[80:95], a[146:149], a[164:167], 0
  buffer_load_dwordx4 v12, s[16:19], s62 offen offset:2048 lds
  s_waitcnt lgkmcnt(4)
  v_mfma_f32_32x32x16_bf16 v[80:95], a[192:195], a[0:3], v[80:95]
  ds_read_b64_tr_b16 a[184:185], v105 offset:36864
  ds_read_b64_tr_b16 a[186:187], v105 offset:37376
  s_add_u32 s62, s63, 1990912
  v_mfma_f32_32x32x16_bf16 v[80:95], a[196:199], a[4:7], v[80:95]
  ds_read_b64_tr_b16 a[188:189], v105 offset:38912
  ds_read_b64_tr_b16 a[190:191], v105 offset:39424
  s_add_u32 m0, s61, 27648
  v_mul_f32 v56, v64, v64
  v_mul_f32 v57, v65, v65
  v_mul_f32 v58, v66, v66
  v_mul_f32 v59, v67, v67
  v_fmamk_f32 v56, v56, 0xbdd2d3e8, v17
  v_mfma_f32_32x32x16_bf16 v[80:95], a[200:203], a[8:11], v[80:95]
  ds_read_b64_tr_b16 a[192:193], v105 offset:40960
  ds_read_b64_tr_b16 a[194:195], v105 offset:41472
  v_fmamk_f32 v57, v57, 0xbdd2d3e8, v17
  v_fmamk_f32 v58, v58, 0xbdd2d3e8, v17
  v_fmamk_f32 v59, v59, 0xbdd2d3e8, v17
  v_mul_f32 v56, v56, v64
  v_mfma_f32_32x32x16_bf16 v[80:95], a[204:207], a[12:15], v[80:95]
  ds_read_b64_tr_b16 a[196:197], v105 offset:43008
  ds_read_b64_tr_b16 a[198:199], v105 offset:43520
  buffer_load_dwordx4 v10, s[16:19], s62 offen offset:0 lds
  v_mul_f32 v57, v57, v65
  v_mul_f32 v58, v58, v66
  v_mul_f32 v59, v59, v67
  v_exp_f32 v56, v56
  s_waitcnt lgkmcnt(4)
  v_mfma_f32_32x32x16_bf16 v[80:95], a[176:179], a[16:19], v[80:95]
  ds_read_b64_tr_b16 a[200:201], v105 offset:45056
  ds_read_b64_tr_b16 a[202:203], v105 offset:45568
  buffer_load_dwordx4 v11, s[16:19], s62 offen offset:1024 lds
  v_exp_f32 v57, v57
  v_exp_f32 v58, v58
  v_mfma_f32_32x32x16_bf16 v[80:95], a[180:183], a[20:23], v[80:95]
  ds_read_b64_tr_b16 a[204:205], v105 offset:47104
  ds_read_b64_tr_b16 a[206:207], v105 offset:47616
  buffer_load_dwordx4 v12, s[16:19], s62 offen offset:2048 lds
  v_exp_f32 v59, v59
  v_add_f32 v56, 1.0, v56
  v_add_f32 v57, 1.0, v57
  v_add_f32 v58, 1.0, v58
  v_mfma_f32_32x32x16_bf16 v[80:95], a[184:187], a[24:27], v[80:95]
  s_waitcnt vmcnt(18)
  s_barrier
  ds_read_b64_tr_b16 a[176:177], v106 offset:0
  ds_read_b64_tr_b16 a[178:179], v106 offset:512
  v_add_f32 v59, 1.0, v59
  v_rcp_f32 v56, v56
  v_rcp_f32 v57, v57
  v_mfma_f32_32x32x16_bf16 v[80:95], a[188:191], a[28:31], v[80:95]
  ds_read_b64_tr_b16 a[180:181], v106 offset:2048
  ds_read_b64_tr_b16 a[182:183], v106 offset:2560
  s_add_u32 s62, s63, 3539200
  v_rcp_f32 v58, v58
  v_rcp_f32 v59, v59
  s_waitcnt lgkmcnt(4)
  v_mfma_f32_32x32x16_bf16 v[80:95], a[192:195], a[32:35], v[80:95]
  ds_read_b64_tr_b16 a[184:185], v106 offset:4096
  ds_read_b64_tr_b16 a[186:187], v106 offset:4608
  s_add_u32 m0, s61, 49152
  v_mul_f32 v56, v56, v64
  v_mul_f32 v57, v57, v65
  v_mul_f32 v58, v58, v66
  v_mul_f32 v59, v59, v67
  v_mfma_f32_32x32x16_bf16 v[80:95], a[196:199], a[36:39], v[80:95]
  ds_read_b64_tr_b16 a[188:189], v106 offset:6144
  ds_read_b64_tr_b16 a[190:191], v106 offset:6656
  buffer_load_dwordx4 v10, s[16:19], s62 offen offset:0 lds
  v_cvt_pk_bf16_f32 v112, v56, v57
  v_cvt_pk_bf16_f32 v113, v58, v59
  v_mul_f32 v60, v68, v68
  v_mul_f32 v61, v69, v69
  v_mul_f32 v62, v70, v70
  v_mfma_f32_32x32x16_bf16 v[80:95], a[200:203], a[40:43], v[80:95]
  ds_read_b64_tr_b16 a[192:193], v106 offset:8192
  ds_read_b64_tr_b16 a[194:195], v106 offset:8704
  buffer_load_dwordx4 v11, s[16:19], s62 offen offset:1024 lds
  v_mul_f32 v63, v71, v71
  v_fmamk_f32 v60, v60, 0xbdd2d3e8, v17
  v_fmamk_f32 v61, v61, 0xbdd2d3e8, v17
  v_fmamk_f32 v62, v62, 0xbdd2d3e8, v17
  v_mfma_f32_32x32x16_bf16 v[80:95], a[204:207], a[44:47], v[80:95]
  ds_read_b64_tr_b16 a[196:197], v106 offset:10240
  ds_read_b64_tr_b16 a[198:199], v106 offset:10752
  buffer_load_dwordx4 v12, s[16:19], s62 offen offset:2048 lds
  v_fmamk_f32 v63, v63, 0xbdd2d3e8, v17
  v_mul_f32 v60, v60, v68
  v_mul_f32 v61, v61, v69
  v_mul_f32 v62, v62, v70
  v_mul_f32 v63, v63, v71
  s_waitcnt lgkmcnt(4)
  v_mfma_f32_32x32x16_bf16 v[80:95], a[176:179], a[48:51], v[80:95]
  ds_read_b64_tr_b16 a[200:201], v106 offset:12288
  ds_read_b64_tr_b16 a[202:203], v106 offset:12800
  v_exp_f32 v60, v60
  v_exp_f32 v61, v61
  v_mfma_f32_32x32x16_bf16 v[80:95], a[180:183], a[52:55], v[80:95]
  ds_read_b64_tr_b16 a[204:205], v106 offset:14336
  ds_read_b64_tr_b16 a[206:207], v106 offset:14848
  s_add_u32 s62, s63, 3760384
  v_exp_f32 v62, v62
  v_exp_f32 v63, v63
  v_add_f32 v60, 1.0, v60
  v_mfma_f32_32x32x16_bf16 v[80:95], a[184:187], a[56:59], v[80:95]
  ds_read_b64_tr_b16 a[176:177], v106 offset:16384
  ds_read_b64_tr_b16 a[178:179], v106 offset:16896
  s_add_u32 m0, s61, 52224
  v_add_f32 v61, 1.0, v61
  v_add_f32 v62, 1.0, v62
  v_add_f32 v63, 1.0, v63
  v_rcp_f32 v60, v60
  v_mfma_f32_32x32x16_bf16 v[80:95], a[188:191], a[60:63], v[80:95]
  ds_read_b64_tr_b16 a[180:181], v106 offset:18432
  ds_read_b64_tr_b16 a[182:183], v106 offset:18944
  buffer_load_dwordx4 v10, s[16:19], s62 offen offset:0 lds
  v_rcp_f32 v61, v61
  v_rcp_f32 v62, v62
  s_waitcnt lgkmcnt(4)
  v_mfma_f32_32x32x16_bf16 v[80:95], a[192:195], a[64:67], v[80:95]
  ds_read_b64_tr_b16 a[184:185], v106 offset:20480
  ds_read_b64_tr_b16 a[186:187], v106 offset:20992
  buffer_load_dwordx4 v11, s[16:19], s62 offen offset:1024 lds
  v_rcp_f32 v63, v63
  v_mul_f32 v60, v60, v68
  v_mul_f32 v61, v61, v69
  v_mfma_f32_32x32x16_bf16 v[80:95], a[196:199], a[68:71], v[80:95]
  ds_read_b64_tr_b16 a[188:189], v106 offset:22528
  ds_read_b64_tr_b16 a[190:191], v106 offset:23040
  buffer_load_dwordx4 v12, s[16:19], s62 offen offset:2048 lds
  v_mul_f32 v62, v62, v70
  v_mul_f32 v63, v63, v71
  v_cvt_pk_bf16_f32 v114, v60, v61
  v_cvt_pk_bf16_f32 v115, v62, v63
  ds_write_b128 v110, v[112:115] offset:0
  v_mfma_f32_32x32x16_bf16 v[80:95], a[200:203], a[72:75], v[80:95]
  s_waitcnt vmcnt(18)
  s_barrier
  ds_read_b64_tr_b16 a[192:193], v106 offset:24576
  ds_read_b64_tr_b16 a[194:195], v106 offset:25088
  v_mul_f32 v56, v72, v72
  v_mul_f32 v57, v73, v73
  v_mul_f32 v58, v74, v74
  v_mul_f32 v59, v75, v75
  v_fmamk_f32 v56, v56, 0xbdd2d3e8, v17
  v_mfma_f32_32x32x16_bf16 v[80:95], a[204:207], a[76:79], v[80:95]
  ds_read_b64_tr_b16 a[196:197], v106 offset:26624
  ds_read_b64_tr_b16 a[198:199], v106 offset:27136
  s_add_u32 s62, s63, 384
  v_fmamk_f32 v57, v57, 0xbdd2d3e8, v17
  v_fmamk_f32 v58, v58, 0xbdd2d3e8, v17
  v_fmamk_f32 v59, v59, 0xbdd2d3e8, v17
  v_mul_f32 v56, v56, v72
  s_waitcnt lgkmcnt(5)
  v_mfma_f32_32x32x16_bf16 v[80:95], a[176:179], a[80:83], v[80:95]
  ds_read_b64_tr_b16 a[200:201], v106 offset:28672
  ds_read_b64_tr_b16 a[202:203], v106 offset:29184
  s_add_u32 m0, s61, 73728
  v_mul_f32 v57, v57, v73
  v_mul_f32 v58, v58, v74
  v_mul_f32 v59, v59, v75
  v_exp_f32 v56, v56
  v_mfma_f32_32x32x16_bf16 v[80:95], a[180:183], a[84:87], v[80:95]
  ds_read_b64_tr_b16 a[204:205], v106 offset:30720
  ds_read_b64_tr_b16 a[206:207], v106 offset:31232
  buffer_load_dwordx4 v10, s[16:19], s62 offen offset:0 lds
  v_exp_f32 v57, v57
  v_exp_f32 v58, v58
  v_mfma_f32_32x32x16_bf16 v[80:95], a[184:187], a[88:91], v[80:95]
  ds_read_b64_tr_b16 a[176:177], v106 offset:32768
  ds_read_b64_tr_b16 a[178:179], v106 offset:33280
  buffer_load_dwordx4 v11, s[16:19], s62 offen offset:1024 lds
  v_exp_f32 v59, v59
  v_add_f32 v56, 1.0, v56
  v_add_f32 v57, 1.0, v57
  v_add_f32 v58, 1.0, v58
  v_mfma_f32_32x32x16_bf16 v[80:95], a[188:191], a[92:95], v[80:95]
  ds_read_b64_tr_b16 a[180:181], v106 offset:34816
  ds_read_b64_tr_b16 a[182:183], v106 offset:35328
  buffer_load_dwordx4 v12, s[16:19], s62 offen offset:2048 lds
  v_add_f32 v59, 1.0, v59
  v_rcp_f32 v56, v56
  v_rcp_f32 v57, v57
  s_waitcnt lgkmcnt(4)
  v_mfma_f32_32x32x16_bf16 v[80:95], a[192:195], a[96:99], v[80:95]
  ds_read_b64_tr_b16 a[184:185], v106 offset:36864
  ds_read_b64_tr_b16 a[186:187], v106 offset:37376
  v_rcp_f32 v58, v58
  v_rcp_f32 v59, v59
  v_mfma_f32_32x32x16_bf16 v[80:95], a[196:199], a[100:103], v[80:95]
  ds_read_b64_tr_b16 a[188:189], v106 offset:38912
  ds_read_b64_tr_b16 a[190:191], v106 offset:39424
  s_add_u32 s62, s63, 221568
  v_mul_f32 v56, v56, v72
  v_mul_f32 v57, v57, v73
  v_mul_f32 v58, v58, v74
  v_mul_f32 v59, v59, v75
  v_mfma_f32_32x32x16_bf16 v[80:95], a[200:203], a[104:107], v[80:95]
  ds_read_b64_tr_b16 a[192:193], v106 offset:40960
  ds_read_b64_tr_b16 a[194:195], v106 offset:41472
  s_add_u32 m0, s61, 76800
  v_cvt_pk_bf16_f32 v116, v56, v57
  v_cvt_pk_bf16_f32 v117, v58, v59
  v_mul_f32 v60, v76, v76
  v_mul_f32 v61, v77, v77
  v_mul_f32 v62, v78, v78
  v_mfma_f32_32x32x16_bf16 v[80:95], a[204:207], a[108:111], v[80:95]
  ds_read_b64_tr_b16 a[196:197], v106 offset:43008
  ds_read_b64_tr_b16 a[198:199], v106 offset:43520
  buffer_load_dwordx4 v10, s[16:19], s62 offen offset:0 lds
  v_mul_f32 v63, v79, v79
  v_fmamk_f32 v60, v60, 0xbdd2d3e8, v17
  v_fmamk_f32 v61, v61, 0xbdd2d3e8, v17
  v_fmamk_f32 v62, v62, 0xbdd2d3e8, v17
  s_waitcnt lgkmcnt(4)
  v_mfma_f32_32x32x16_bf16 v[80:95], a[176:179], a[112:115], v[80:95]
  ds_read_b64_tr_b16 a[200:201], v106 offset:45056
  ds_read_b64_tr_b16 a[202:203], v106 offset:45568
  buffer_load_dwordx4 v11, s[16:19], s62 offen offset:1024 lds
  v_fmamk_f32 v63, v63, 0xbdd2d3e8, v17
  v_mul_f32 v60, v60, v76
  v_mul_f32 v61, v61, v77
  v_mul_f32 v62, v62, v78
  v_mul_f32 v63, v63, v79
  v_mfma_f32_32x32x16_bf16 v[80:95], a[180:183], a[116:119], v[80:95]
  ds_read_b64_tr_b16 a[204:205], v106 offset:47104
  ds_read_b64_tr_b16 a[206:207], v106 offset:47616
  buffer_load_dwordx4 v12, s[16:19], s62 offen offset:2048 lds
  v_exp_f32 v60, v60
  v_exp_f32 v61, v61
  v_mfma_f32_32x32x16_bf16 v[80:95], a[184:187], a[120:123], v[80:95]
  s_waitcnt vmcnt(18)
  s_barrier
  ds_read_b64_tr_b16 a[176:177], v104 offset:0
  ds_read_b64_tr_b16 a[178:179], v104 offset:512
  v_exp_f32 v62, v62
  v_exp_f32 v63, v63
  v_add_f32 v60, 1.0, v60
  v_mfma_f32_32x32x16_bf16 v[80:95], a[188:191], a[124:127], v[80:95]
  ds_read_b64_tr_b16 a[180:181], v104 offset:2048
  ds_read_b64_tr_b16 a[182:183], v104 offset:2560
  s_add_u32 s62, s63, 1769856
  v_add_f32 v61, 1.0, v61
  v_add_f32 v62, 1.0, v62
  v_add_f32 v63, 1.0, v63
  v_rcp_f32 v60, v60
  s_waitcnt lgkmcnt(4)
  v_mfma_f32_32x32x16_bf16 v[80:95], a[192:195], a[128:131], v[80:95]
  ds_read_b64_tr_b16 a[184:185], v104 offset:4096
  ds_read_b64_tr_b16 a[186:187], v104 offset:4608
  s_add_u32 m0, s61, 98304
  v_rcp_f32 v61, v61
  v_rcp_f32 v62, v62
  v_mfma_f32_32x32x16_bf16 v[80:95], a[196:199], a[132:135], v[80:95]
  ds_read_b64_tr_b16 a[188:189], v104 offset:6144
  ds_read_b64_tr_b16 a[190:191], v104 offset:6656
  v_rcp_f32 v63, v63
  v_mul_f32 v60, v60, v76
  v_mul_f32 v61, v61, v77
  v_mfma_f32_32x32x16_bf16 v[80:95], a[200:203], a[136:139], v[80:95]
  ds_read_b64_tr_b16 a[192:193], v104 offset:8192
  ds_read_b64_tr_b16 a[194:195], v104 offset:8704
  buffer_load_dwordx4 v10, s[16:19], s62 offen offset:0 lds
  v_mul_f32 v62, v62, v78
  v_mul_f32 v63, v63, v79
  v_cvt_pk_bf16_f32 v118, v60, v61
  v_cvt_pk_bf16_f32 v119, v62, v63
  ds_write_b128 v110, v[116:119] offset:1024
  v_mfma_f32_32x32x16_bf16 v[80:95], a[204:207], a[140:143], v[80:95]
  ds_read_b64_tr_b16 a[196:197], v104 offset:10240
  ds_read_b64_tr_b16 a[198:199], v104 offset:10752
  buffer_load_dwordx4 v11, s[16:19], s62 offen offset:1024 lds
  v_mfma_f32_32x32x16_bf16 v[64:79], a[148:151], a[164:167], 0
  buffer_load_dwordx4 v12, s[16:19], s62 offen offset:2048 lds
  s_waitcnt lgkmcnt(5)
  v_mfma_f32_32x32x16_bf16 v[64:79], a[176:179], a[0:3], v[64:79]
  ds_read_b64_tr_b16 a[200:201], v104 offset:12288
  ds_read_b64_tr_b16 a[202:203], v104 offset:12800
  s_add_u32 s62, s63, 1991040
  v_mfma_f32_32x32x16_bf16 v[64:79], a[180:183], a[4:7], v[64:79]
  ds_read_b64_tr_b16 a[204:205], v104 offset:14336
  ds_read_b64_tr_b16 a[206:207], v104 offset:14848
  s_add_u32 m0, s61, 101376
  v_mul_f32 v56, v80, v80
  v_mul_f32 v57, v81, v81
  v_mul_f32 v58, v82, v82
  v_mul_f32 v59, v83, v83
  v_fmamk_f32 v56, v56, 0xbdd2d3e8, v17
  v_mfma_f32_32x32x16_bf16 v[64:79], a[184:187], a[8:11], v[64:79]
  ds_read_b64_tr_b16 a[176:177], v104 offset:16384
  ds_read_b64_tr_b16 a[178:179], v104 offset:16896
  v_fmamk_f32 v57, v57, 0xbdd2d3e8, v17
  v_fmamk_f32 v58, v58, 0xbdd2d3e8, v17
  v_fmamk_f32 v59, v59, 0xbdd2d3e8, v17
  v_mul_f32 v56, v56, v80
  v_mfma_f32_32x32x16_bf16 v[64:79], a[188:191], a[12:15], v[64:79]
  ds_read_b64_tr_b16 a[180:181], v104 offset:18432
  ds_read_b64_tr_b16 a[182:183], v104 offset:18944
  buffer_load_dwordx4 v10, s[16:19], s62 offen offset:0 lds
  v_mul_f32 v57, v57, v81
  v_mul_f32 v58, v58, v82
  v_mul_f32 v59, v59, v83
  v_exp_f32 v56, v56
  s_waitcnt lgkmcnt(4)
  v_mfma_f32_32x32x16_bf16 v[64:79], a[192:195], a[16:19], v[64:79]
  ds_read_b64_tr_b16 a[184:185], v104 offset:20480
  ds_read_b64_tr_b16 a[186:187], v104 offset:20992
  buffer_load_dwordx4 v11, s[16:19], s62 offen offset:1024 lds
  v_exp_f32 v57, v57
  v_exp_f32 v58, v58
  v_mfma_f32_32x32x16_bf16 v[64:79], a[196:199], a[20:23], v[64:79]
  ds_read_b64_tr_b16 a[188:189], v104 offset:22528
  ds_read_b64_tr_b16 a[190:191], v104 offset:23040
  buffer_load_dwordx4 v12, s[16:19], s62 offen offset:2048 lds
  v_exp_f32 v59, v59
  v_add_f32 v56, 1.0, v56
  v_add_f32 v57, 1.0, v57
  v_add_f32 v58, 1.0, v58
  v_mfma_f32_32x32x16_bf16 v[64:79], a[200:203], a[24:27], v[64:79]
  s_waitcnt vmcnt(18)
  s_barrier
  ds_read_b64_tr_b16 a[192:193], v104 offset:24576
  ds_read_b64_tr_b16 a[194:195], v104 offset:25088
  v_add_f32 v59, 1.0, v59
  v_rcp_f32 v56, v56
  v_rcp_f32 v57, v57
  v_mfma_f32_32x32x16_bf16 v[64:79], a[204:207], a[28:31], v[64:79]
  ds_read_b64_tr_b16 a[196:197], v104 offset:26624
  ds_read_b64_tr_b16 a[198:199], v104 offset:27136
  s_add_u32 s62, s63, 3539328
  ds_read_b128 v[120:123], v111 offset:0
  ds_read_b128 v[124:127], v111 offset:1024
  v_rcp_f32 v58, v58
  v_rcp_f32 v59, v59
  s_waitcnt lgkmcnt(6)
  v_mfma_f32_32x32x16_bf16 v[64:79], a[176:179], a[32:35], v[64:79]
  ds_read_b64_tr_b16 a[200:201], v104 offset:28672
  ds_read_b64_tr_b16 a[202:203], v104 offset:29184
  s_add_u32 m0, s61, 122880
  v_mul_f32 v56, v56, v80
  v_mul_f32 v57, v57, v81
  v_mul_f32 v58, v58, v82
  v_mul_f32 v59, v59, v83
  v_mfma_f32_32x32x16_bf16 v[64:79], a[180:183], a[36:39], v[64:79]
  ds_read_b64_tr_b16 a[204:205], v104 offset:30720
  ds_read_b64_tr_b16 a[206:207], v104 offset:31232
  buffer_load_dwordx4 v10, s[16:19], s62 offen offset:0 lds
  v_cvt_pk_bf16_f32 v128, v56, v57
  v_cvt_pk_bf16_f32 v129, v58, v59
  v_mul_f32 v60, v84, v84
  v_mul_f32 v61, v85, v85
  v_mul_f32 v62, v86, v86
  v_mfma_f32_32x32x16_bf16 v[64:79], a[184:187], a[40:43], v[64:79]
  ds_read_b64_tr_b16 a[176:177], v104 offset:32768
  ds_read_b64_tr_b16 a[178:179], v104 offset:33280
  buffer_load_dwordx4 v11, s[16:19], s62 offen offset:1024 lds
  v_mul_f32 v63, v87, v87
  v_fmamk_f32 v60, v60, 0xbdd2d3e8, v17
  v_fmamk_f32 v61, v61, 0xbdd2d3e8, v17
  v_fmamk_f32 v62, v62, 0xbdd2d3e8, v17
  v_mfma_f32_32x32x16_bf16 v[64:79], a[188:191], a[44:47], v[64:79]
  ds_read_b64_tr_b16 a[180:181], v104 offset:34816
  ds_read_b64_tr_b16 a[182:183], v104 offset:35328
  buffer_load_dwordx4 v12, s[16:19], s62 offen offset:2048 lds
  v_fmamk_f32 v63, v63, 0xbdd2d3e8, v17
  v_mul_f32 v60, v60, v84
  v_mul_f32 v61, v61, v85
  v_mul_f32 v62, v62, v86
  v_mul_f32 v63, v63, v87
  s_waitcnt lgkmcnt(4)
  v_mfma_f32_32x32x16_bf16 v[64:79], a[192:195], a[48:51], v[64:79]
  ds_read_b64_tr_b16 a[184:185], v104 offset:36864
  ds_read_b64_tr_b16 a[186:187], v104 offset:37376
  v_exp_f32 v60, v60
  v_exp_f32 v61, v61
  v_mfma_f32_32x32x16_bf16 v[64:79], a[196:199], a[52:55], v[64:79]
  ds_read_b64_tr_b16 a[188:189], v104 offset:38912
  ds_read_b64_tr_b16 a[190:191], v104 offset:39424
  s_add_u32 s62, s63, 3760512
  v_exp_f32 v62, v62
  v_exp_f32 v63, v63
  v_add_f32 v60, 1.0, v60
  v_mfma_f32_32x32x16_bf16 v[64:79], a[200:203], a[56:59], v[64:79]
  ds_read_b64_tr_b16 a[192:193], v104 offset:40960
  ds_read_b64_tr_b16 a[194:195], v104 offset:41472
  s_add_u32 m0, s61, 125952
  v_add_f32 v61, 1.0, v61
  v_add_f32 v62, 1.0, v62
  v_add_f32 v63, 1.0, v63
  v_rcp_f32 v60, v60
  v_mfma_f32_32x32x16_bf16 v[64:79], a[204:207], a[60:63], v[64:79]
  ds_read_b64_tr_b16 a[196:197], v104 offset:43008
  ds_read_b64_tr_b16 a[198:199], v104 offset:43520
  buffer_load_dwordx4 v10, s[16:19], s62 offen offset:0 lds
  v_rcp_f32 v61, v61
  v_rcp_f32 v62, v62
  s_waitcnt lgkmcnt(4)
  v_mfma_f32_32x32x16_bf16 v[64:79], a[176:179], a[64:67], v[64:79]
  ds_read_b64_tr_b16 a[200:201], v104 offset:45056
  ds_read_b64_tr_b16 a[202:203], v104 offset:45568
  buffer_load_dwordx4 v11, s[16:19], s62 offen offset:1024 lds
  v_rcp_f32 v63, v63
  v_mul_f32 v60, v60, v84
  v_mul_f32 v61, v61, v85
  v_mfma_f32_32x32x16_bf16 v[64:79], a[180:183], a[68:71], v[64:79]
  ds_read_b64_tr_b16 a[204:205], v104 offset:47104
  ds_read_b64_tr_b16 a[206:207], v104 offset:47616
  buffer_load_dwordx4 v12, s[16:19], s62 offen offset:2048 lds
  v_mul_f32 v62, v62, v86
  v_mul_f32 v63, v63, v87
  v_cvt_pk_bf16_f32 v130, v60, v61
  v_cvt_pk_bf16_f32 v131, v62, v63
  ds_write_b128 v110, v[128:131] offset:8192
  v_mfma_f32_32x32x16_bf16 v[64:79], a[184:187], a[72:75], v[64:79]
  s_waitcnt vmcnt(18)
  s_barrier
  ds_read_b64_tr_b16 a[176:177], v105 offset:0
  ds_read_b64_tr_b16 a[178:179], v105 offset:512
  v_mul_f32 v56, v88, v88
  v_mul_f32 v57, v89, v89
  v_mul_f32 v58, v90, v90
  v_mul_f32 v59, v91, v91
  v_fmamk_f32 v56, v56, 0xbdd2d3e8, v17
  v_mfma_f32_32x32x16_bf16 v[64:79], a[188:191], a[76:79], v[64:79]
  ds_read_b64_tr_b16 a[180:181], v105 offset:2048
  ds_read_b64_tr_b16 a[182:183], v105 offset:2560
  s_add_u32 s62, s63, 512
  v_fmamk_f32 v57, v57, 0xbdd2d3e8, v17
  v_fmamk_f32 v58, v58, 0xbdd2d3e8, v17
  v_fmamk_f32 v59, v59, 0xbdd2d3e8, v17
  v_mul_f32 v56, v56, v88
  s_waitcnt lgkmcnt(5)
  v_mfma_f32_32x32x16_bf16 v[64:79], a[192:195], a[80:83], v[64:79]
  ds_read_b64_tr_b16 a[184:185], v105 offset:4096
  ds_read_b64_tr_b16 a[186:187], v105 offset:4608
  s_add_u32 m0, s61, 0
  v_mul_f32 v57, v57, v89
  v_mul_f32 v58, v58, v90
  v_mul_f32 v59, v59, v91
  v_exp_f32 v56, v56
  v_mfma_f32_32x32x16_bf16 v[64:79], a[196:199], a[84:87], v[64:79]
  ds_read_b64_tr_b16 a[188:189], v105 offset:6144
  ds_read_b64_tr_b16 a[190:191], v105 offset:6656
  buffer_load_dwordx4 v10, s[16:19], s62 offen offset:0 lds
  v_exp_f32 v57, v57
  v_exp_f32 v58, v58
  v_mfma_f32_32x32x16_bf16 v[64:79], a[200:203], a[88:91], v[64:79]
  ds_read_b64_tr_b16 a[192:193], v105 offset:8192
  ds_read_b64_tr_b16 a[194:195], v105 offset:8704
  buffer_load_dwordx4 v11, s[16:19], s62 offen offset:1024 lds
  v_exp_f32 v59, v59
  v_add_f32 v56, 1.0, v56
  v_add_f32 v57, 1.0, v57
  v_add_f32 v58, 1.0, v58
  v_mfma_f32_32x32x16_bf16 v[64:79], a[204:207], a[92:95], v[64:79]
  ds_read_b64_tr_b16 a[196:197], v105 offset:10240
  ds_read_b64_tr_b16 a[198:199], v105 offset:10752
  buffer_load_dwordx4 v12, s[16:19], s62 offen offset:2048 lds
  v_add_f32 v59, 1.0, v59
  v_rcp_f32 v56, v56
  v_rcp_f32 v57, v57
  s_waitcnt lgkmcnt(4)
  v_mfma_f32_32x32x16_bf16 v[64:79], a[176:179], a[96:99], v[64:79]
  ds_read_b64_tr_b16 a[200:201], v105 offset:12288
  ds_read_b64_tr_b16 a[202:203], v105 offset:12800
  v_rcp_f32 v58, v58
  v_rcp_f32 v59, v59
  v_mfma_f32_32x32x16_bf16 v[64:79], a[180:183], a[100:103], v[64:79]
  ds_read_b64_tr_b16 a[204:205], v105 offset:14336
  ds_read_b64_tr_b16 a[206:207], v105 offset:14848
  s_add_u32 s62, s63, 221696
  v_mul_f32 v56, v56, v88
  v_mul_f32 v57, v57, v89
  v_mul_f32 v58, v58, v90
  v_mul_f32 v59, v59, v91
  v_mfma_f32_32x32x16_bf16 v[64:79], a[184:187], a[104:107], v[64:79]
  ds_read_b64_tr_b16 a[176:177], v105 offset:16384
  ds_read_b64_tr_b16 a[178:179], v105 offset:16896
  s_add_u32 m0, s61, 3072
  v_cvt_pk_bf16_f32 v132, v56, v57
  v_cvt_pk_bf16_f32 v133, v58, v59
  v_mul_f32 v60, v92, v92
  v_mul_f32 v61, v93, v93
  v_mul_f32 v62, v94, v94
  v_mfma_f32_32x32x16_bf16 v[64:79], a[188:191], a[108:111], v[64:79]
  ds_read_b64_tr_b16 a[180:181], v105 offset:18432
  ds_read_b64_tr_b16 a[182:183], v105 offset:18944
  buffer_load_dwordx4 v10, s[16:19], s62 offen offset:0 lds
  v_mul_f32 v63, v95, v95
  v_fmamk_f32 v60, v60, 0xbdd2d3e8, v17
  v_fmamk_f32 v61, v61, 0xbdd2d3e8, v17
  v_fmamk_f32 v62, v62, 0xbdd2d3e8, v17
  s_waitcnt lgkmcnt(4)
  v_mfma_f32_32x32x16_bf16 v[64:79], a[192:195], a[112:115], v[64:79]
  ds_read_b64_tr_b16 a[184:185], v105 offset:20480
  ds_read_b64_tr_b16 a[186:187], v105 offset:20992
  buffer_load_dwordx4 v11, s[16:19], s62 offen offset:1024 lds
  v_fmamk_f32 v63, v63, 0xbdd2d3e8, v17
  v_mul_f32 v60, v60, v92
  v_mul_f32 v61, v61, v93
  v_mul_f32 v62, v62, v94
  v_mul_f32 v63, v63, v95
  v_mfma_f32_32x32x16_bf16 v[64:79], a[196:199], a[116:119], v[64:79]
  ds_read_b64_tr_b16 a[188:189], v105 offset:22528
  ds_read_b64_tr_b16 a[190:191], v105 offset:23040
  buffer_load_dwordx4 v12, s[16:19], s62 offen offset:2048 lds
  v_exp_f32 v60, v60
  v_exp_f32 v61, v61
  v_mfma_f32_32x32x16_bf16 v[64:79], a[200:203], a[120:123], v[64:79]
  s_waitcnt vmcnt(18)
  s_barrier
  ds_read_b64_tr_b16 a[192:193], v105 offset:24576
  ds_read_b64_tr_b16 a[194:195], v105 offset:25088
  v_exp_f32 v62, v62
  v_exp_f32 v63, v63
  v_add_f32 v60, 1.0, v60
  v_mfma_f32_32x32x16_bf16 v[64:79], a[204:207], a[124:127], v[64:79]
  ds_read_b64_tr_b16 a[196:197], v105 offset:26624
  ds_read_b64_tr_b16 a[198:199], v105 offset:27136
  s_add_u32 s62, s63, 1769984
  v_add_f32 v61, 1.0, v61
  v_add_f32 v62, 1.0, v62
  v_add_f32 v63, 1.0, v63
  v_rcp_f32 v60, v60
  s_waitcnt lgkmcnt(4)
  v_mfma_f32_32x32x16_bf16 v[64:79], a[176:179], a[128:131], v[64:79]
  ds_read_b64_tr_b16 a[200:201], v105 offset:28672
  ds_read_b64_tr_b16 a[202:203], v105 offset:29184
  s_add_u32 m0, s61, 24576
  v_rcp_f32 v61, v61
  v_rcp_f32 v62, v62
  v_mfma_f32_32x32x16_bf16 v[64:79], a[180:183], a[132:135], v[64:79]
  ds_read_b64_tr_b16 a[204:205], v105 offset:30720
  ds_read_b64_tr_b16 a[206:207], v105 offset:31232
  v_rcp_f32 v63, v63
  v_mul_f32 v60, v60, v92
  v_mul_f32 v61, v61, v93
  v_mfma_f32_32x32x16_bf16 v[64:79], a[184:187], a[136:139], v[64:79]
  ds_read_b64_tr_b16 a[176:177], v105 offset:32768
  ds_read_b64_tr_b16 a[178:179], v105 offset:33280
  buffer_load_dwordx4 v10, s[16:19], s62 offen offset:0 lds
  v_mul_f32 v62, v62, v94
  v_mul_f32 v63, v63, v95
  v_cvt_pk_bf16_f32 v134, v60, v61
  v_cvt_pk_bf16_f32 v135, v62, v63
  ds_write_b128 v110, v[132:135] offset:9216
  v_mfma_f32_32x32x16_bf16 v[64:79], a[188:191], a[140:143], v[64:79]
  ds_read_b64_tr_b16 a[180:181], v105 offset:34816
  ds_read_b64_tr_b16 a[182:183], v105 offset:35328
  buffer_load_dwordx4 v11, s[16:19], s62 offen offset:1024 lds
  v_mfma_f32_32x32x16_bf16 v[80:95], a[150:153], a[164:167], 0
  buffer_load_dwordx4 v12, s[16:19], s62 offen offset:2048 lds
  s_waitcnt lgkmcnt(5)
  v_mfma_f32_32x32x16_bf16 v[80:95], a[192:195], a[0:3], v[80:95]
  ds_read_b64_tr_b16 a[184:185], v105 offset:36864
  ds_read_b64_tr_b16 a[186:187], v105 offset:37376
  s_add_u32 s62, s63, 1991168
  v_mfma_f32_32x32x16_bf16 v[80:95], a[196:199], a[4:7], v[80:95]
  ds_read_b64_tr_b16 a[188:189], v105 offset:38912
  ds_read_b64_tr_b16 a[190:191], v105 offset:39424
  s_add_u32 m0, s61, 27648
  v_mul_f32 v56, v64, v64
  v_mul_f32 v57, v65, v65
  v_mul_f32 v58, v66, v66
  v_mul_f32 v59, v67, v67
  v_fmamk_f32 v56, v56, 0xbdd2d3e8, v17
  v_mfma_f32_32x32x16_bf16 v[80:95], a[200:203], a[8:11], v[80:95]
  ds_read_b64_tr_b16 a[192:193], v105 offset:40960
  ds_read_b64_tr_b16 a[194:195], v105 offset:41472
  v_fmamk_f32 v57, v57, 0xbdd2d3e8, v17
  v_fmamk_f32 v58, v58, 0xbdd2d3e8, v17
  v_fmamk_f32 v59, v59, 0xbdd2d3e8, v17
  v_mul_f32 v56, v56, v64
  v_mfma_f32_32x32x16_bf16 v[80:95], a[204:207], a[12:15], v[80:95]
  ds_read_b64_tr_b16 a[196:197], v105 offset:43008
  ds_read_b64_tr_b16 a[198:199], v105 offset:43520
  buffer_load_dwordx4 v10, s[16:19], s62 offen offset:0 lds
  v_mul_f32 v57, v57, v65
  v_mul_f32 v58, v58, v66
  v_mul_f32 v59, v59, v67
  v_exp_f32 v56, v56
  s_waitcnt lgkmcnt(4)
  v_mfma_f32_32x32x16_bf16 v[80:95], a[176:179], a[16:19], v[80:95]
  ds_read_b64_tr_b16 a[200:201], v105 offset:45056
  ds_read_b64_tr_b16 a[202:203], v105 offset:45568
  buffer_load_dwordx4 v11, s[16:19], s62 offen offset:1024 lds
  v_exp_f32 v57, v57
  v_exp_f32 v58, v58
  v_mfma_f32_32x32x16_bf16 v[80:95], a[180:183], a[20:23], v[80:95]
  ds_read_b64_tr_b16 a[204:205], v105 offset:47104
  ds_read_b64_tr_b16 a[206:207], v105 offset:47616
  buffer_load_dwordx4 v12, s[16:19], s62 offen offset:2048 lds
  v_exp_f32 v59, v59
  v_add_f32 v56, 1.0, v56
  v_add_f32 v57, 1.0, v57
  v_add_f32 v58, 1.0, v58
  v_mfma_f32_32x32x16_bf16 v[80:95], a[184:187], a[24:27], v[80:95]
  s_waitcnt vmcnt(18)
  s_barrier
  ds_read_b64_tr_b16 a[176:177], v106 offset:0
  ds_read_b64_tr_b16 a[178:179], v106 offset:512
  v_add_f32 v59, 1.0, v59
  v_rcp_f32 v56, v56
  v_rcp_f32 v57, v57
  v_mfma_f32_32x32x16_bf16 v[80:95], a[188:191], a[28:31], v[80:95]
  ds_read_b64_tr_b16 a[180:181], v106 offset:2048
  ds_read_b64_tr_b16 a[182:183], v106 offset:2560
  s_add_u32 s62, s63, 3539456
  ds_read_b128 v[136:139], v111 offset:8192
  ds_read_b128 v[140:143], v111 offset:9216
  v_rcp_f32 v58, v58
  v_rcp_f32 v59, v59
  s_waitcnt lgkmcnt(6)
  v_mfma_f32_32x32x16_bf16 v[80:95], a[192:195], a[32:35], v[80:95]
  ds_read_b64_tr_b16 a[184:185], v106 offset:4096
  ds_read_b64_tr_b16 a[186:187], v106 offset:4608
  s_add_u32 m0, s61, 49152
  v_mul_f32 v56, v56, v64
  v_mul_f32 v57, v57, v65
  v_mul_f32 v58, v58, v66
  v_mul_f32 v59, v59, v67
  v_mfma_f32_32x32x16_bf16 v[80:95], a[196:199], a[36:39], v[80:95]
  ds_read_b64_tr_b16 a[188:189], v106 offset:6144
  ds_read_b64_tr_b16 a[190:191], v106 offset:6656
  buffer_load_dwordx4 v10, s[16:19], s62 offen offset:0 lds
  v_cvt_pk_bf16_f32 v144, v56, v57
  v_cvt_pk_bf16_f32 v145, v58, v59
  v_mul_f32 v60, v68, v68
  v_mul_f32 v61, v69, v69
  v_mul_f32 v62, v70, v70
  v_mfma_f32_32x32x16_bf16 v[80:95], a[200:203], a[40:43], v[80:95]
  ds_read_b64_tr_b16 a[192:193], v106 offset:8192
  ds_read_b64_tr_b16 a[194:195], v106 offset:8704
  buffer_load_dwordx4 v11, s[16:19], s62 offen offset:1024 lds
  v_mul_f32 v63, v71, v71
  v_fmamk_f32 v60, v60, 0xbdd2d3e8, v17
  v_fmamk_f32 v61, v61, 0xbdd2d3e8, v17
  v_fmamk_f32 v62, v62, 0xbdd2d3e8, v17
  v_mfma_f32_32x32x16_bf16 v[80:95], a[204:207], a[44:47], v[80:95]
  ds_read_b64_tr_b16 a[196:197], v106 offset:10240
  ds_read_b64_tr_b16 a[198:199], v106 offset:10752
  buffer_load_dwordx4 v12, s[16:19], s62 offen offset:2048 lds
  v_fmamk_f32 v63, v63, 0xbdd2d3e8, v17
  v_mul_f32 v60, v60, v68
  v_mul_f32 v61, v61, v69
  v_mul_f32 v62, v62, v70
  v_mul_f32 v63, v63, v71
  s_waitcnt lgkmcnt(4)
  v_mfma_f32_32x32x16_bf16 v[80:95], a[176:179], a[48:51], v[80:95]
  ds_read_b64_tr_b16 a[200:201], v106 offset:12288
  ds_read_b64_tr_b16 a[202:203], v106 offset:12800
  v_exp_f32 v60, v60
  v_exp_f32 v61, v61
  v_mfma_f32_32x32x16_bf16 v[80:95], a[180:183], a[52:55], v[80:95]
  ds_read_b64_tr_b16 a[204:205], v106 offset:14336
  ds_read_b64_tr_b16 a[206:207], v106 offset:14848
  s_add_u32 s62, s63, 3760640
  v_exp_f32 v62, v62
  v_exp_f32 v63, v63
  v_add_f32 v60, 1.0, v60
  v_mfma_f32_32x32x16_bf16 v[80:95], a[184:187], a[56:59], v[80:95]
  ds_read_b64_tr_b16 a[176:177], v106 offset:16384
  ds_read_b64_tr_b16 a[178:179], v106 offset:16896
  s_add_u32 m0, s61, 52224
  v_add_f32 v61, 1.0, v61
  v_add_f32 v62, 1.0, v62
  v_add_f32 v63, 1.0, v63
  v_rcp_f32 v60, v60
  v_mfma_f32_32x32x16_bf16 v[80:95], a[188:191], a[60:63], v[80:95]
  ds_read_b64_tr_b16 a[180:181], v106 offset:18432
  ds_read_b64_tr_b16 a[182:183], v106 offset:18944
  buffer_load_dwordx4 v10, s[16:19], s62 offen offset:0 lds
  v_rcp_f32 v61, v61
  v_rcp_f32 v62, v62
  s_waitcnt lgkmcnt(4)
  v_mfma_f32_32x32x16_bf16 v[80:95], a[192:195], a[64:67], v[80:95]
  ds_read_b64_tr_b16 a[184:185], v106 offset:20480
  ds_read_b64_tr_b16 a[186:187], v106 offset:20992
  buffer_load_dwordx4 v11, s[16:19], s62 offen offset:1024 lds
  v_rcp_f32 v63, v63
  v_mul_f32 v60, v60, v68
  v_mul_f32 v61, v61, v69
  v_mfma_f32_32x32x16_bf16 v[80:95], a[196:199], a[68:71], v[80:95]
  ds_read_b64_tr_b16 a[188:189], v106 offset:22528
  ds_read_b64_tr_b16 a[190:191], v106 offset:23040
  buffer_load_dwordx4 v12, s[16:19], s62 offen offset:2048 lds
  v_mul_f32 v62, v62, v70
  v_mul_f32 v63, v63, v71
  v_cvt_pk_bf16_f32 v146, v60, v61
  v_cvt_pk_bf16_f32 v147, v62, v63
  ds_write_b128 v110, v[144:147] offset:0
  v_mfma_f32_32x32x16_bf16 v[80:95], a[200:203], a[72:75], v[80:95]
  s_waitcnt vmcnt(18)
  s_barrier
  ds_read_b64_tr_b16 a[192:193], v106 offset:24576
  ds_read_b64_tr_b16 a[194:195], v106 offset:25088
  v_mul_f32 v56, v72, v72
  v_mul_f32 v57, v73, v73
  v_mul_f32 v58, v74, v74
  v_mul_f32 v59, v75, v75
  v_fmamk_f32 v56, v56, 0xbdd2d3e8, v17
  v_mfma_f32_32x32x16_bf16 v[80:95], a[204:207], a[76:79], v[80:95]
  ds_read_b64_tr_b16 a[196:197], v106 offset:26624
  ds_read_b64_tr_b16 a[198:199], v106 offset:27136
  s_add_u32 s62, s63, 640
  v_fmamk_f32 v57, v57, 0xbdd2d3e8, v17
  v_fmamk_f32 v58, v58, 0xbdd2d3e8, v17
  v_fmamk_f32 v59, v59, 0xbdd2d3e8, v17
  v_mul_f32 v56, v56, v72
  s_waitcnt lgkmcnt(5)
  v_mfma_f32_32x32x16_bf16 v[80:95], a[176:179], a[80:83], v[80:95]
  ds_read_b64_tr_b16 a[200:201], v106 offset:28672
  ds_read_b64_tr_b16 a[202:203], v106 offset:29184
  s_add_u32 m0, s61, 73728
  v_mul_f32 v57, v57, v73
  v_mul_f32 v58, v58, v74
  v_mul_f32 v59, v59, v75
  v_exp_f32 v56, v56
  v_mfma_f32_32x32x16_bf16 v[80:95], a[180:183], a[84:87], v[80:95]
  ds_read_b64_tr_b16 a[204:205], v106 offset:30720
  ds_read_b64_tr_b16 a[206:207], v106 offset:31232
  buffer_load_dwordx4 v10, s[16:19], s62 offen offset:0 lds
  v_exp_f32 v57, v57
  v_exp_f32 v58, v58
  v_mfma_f32_32x32x16_bf16 v[80:95], a[184:187], a[88:91], v[80:95]
  ds_read_b64_tr_b16 a[176:177], v106 offset:32768
  ds_read_b64_tr_b16 a[178:179], v106 offset:33280
  buffer_load_dwordx4 v11, s[16:19], s62 offen offset:1024 lds
  v_exp_f32 v59, v59
  v_add_f32 v56, 1.0, v56
  v_add_f32 v57, 1.0, v57
  v_add_f32 v58, 1.0, v58
  v_mfma_f32_32x32x16_bf16 v[80:95], a[188:191], a[92:95], v[80:95]
  ds_read_b64_tr_b16 a[180:181], v106 offset:34816
  ds_read_b64_tr_b16 a[182:183], v106 offset:35328
  buffer_load_dwordx4 v12, s[16:19], s62 offen offset:2048 lds
  v_add_f32 v59, 1.0, v59
  v_rcp_f32 v56, v56
  v_rcp_f32 v57, v57
  s_waitcnt lgkmcnt(4)
  v_mfma_f32_32x32x16_bf16 v[80:95], a[192:195], a[96:99], v[80:95]
  ds_read_b64_tr_b16 a[184:185], v106 offset:36864
  ds_read_b64_tr_b16 a[186:187], v106 offset:37376
  v_rcp_f32 v58, v58
  v_rcp_f32 v59, v59
  v_mfma_f32_32x32x16_bf16 v[80:95], a[196:199], a[100:103], v[80:95]
  ds_read_b64_tr_b16 a[188:189], v106 offset:38912
  ds_read_b64_tr_b16 a[190:191], v106 offset:39424
  s_add_u32 s62, s63, 221824
  v_mul_f32 v56, v56, v72
  v_mul_f32 v57, v57, v73
  v_mul_f32 v58, v58, v74
  v_mul_f32 v59, v59, v75
  v_mfma_f32_32x32x16_bf16 v[80:95], a[200:203], a[104:107], v[80:95]
  ds_read_b64_tr_b16 a[192:193], v106 offset:40960
  ds_read_b64_tr_b16 a[194:195], v106 offset:41472
  s_add_u32 m0, s61, 76800
  v_cvt_pk_bf16_f32 v148, v56, v57
  v_cvt_pk_bf16_f32 v149, v58, v59
  v_mul_f32 v60, v76, v76
  v_mul_f32 v61, v77, v77
  v_mul_f32 v62, v78, v78
  v_mfma_f32_32x32x16_bf16 v[80:95], a[204:207], a[108:111], v[80:95]
  ds_read_b64_tr_b16 a[196:197], v106 offset:43008
  ds_read_b64_tr_b16 a[198:199], v106 offset:43520
  buffer_load_dwordx4 v10, s[16:19], s62 offen offset:0 lds
  v_mul_f32 v63, v79, v79
  v_fmamk_f32 v60, v60, 0xbdd2d3e8, v17
  v_fmamk_f32 v61, v61, 0xbdd2d3e8, v17
  v_fmamk_f32 v62, v62, 0xbdd2d3e8, v17
  s_waitcnt lgkmcnt(4)
  v_mfma_f32_32x32x16_bf16 v[80:95], a[176:179], a[112:115], v[80:95]
  ds_read_b64_tr_b16 a[200:201], v106 offset:45056
  ds_read_b64_tr_b16 a[202:203], v106 offset:45568
  buffer_load_dwordx4 v11, s[16:19], s62 offen offset:1024 lds
  v_fmamk_f32 v63, v63, 0xbdd2d3e8, v17
  v_mul_f32 v60, v60, v76
  v_mul_f32 v61, v61, v77
  v_mul_f32 v62, v62, v78
  v_mul_f32 v63, v63, v79
  v_mfma_f32_32x32x16_bf16 v[80:95], a[180:183], a[116:119], v[80:95]
  ds_read_b64_tr_b16 a[204:205], v106 offset:47104
  ds_read_b64_tr_b16 a[206:207], v106 offset:47616
  buffer_load_dwordx4 v12, s[16:19], s62 offen offset:2048 lds
  v_exp_f32 v60, v60
  v_exp_f32 v61, v61
  v_mfma_f32_32x32x16_bf16 v[80:95], a[184:187], a[120:123], v[80:95]
  s_waitcnt vmcnt(18)
  s_barrier
  ds_read_b64_tr_b16 a[176:177], v104 offset:0
  ds_read_b64_tr_b16 a[178:179], v104 offset:512
  v_exp_f32 v62, v62
  v_exp_f32 v63, v63
  v_add_f32 v60, 1.0, v60
  v_mfma_f32_32x32x16_bf16 v[80:95], a[188:191], a[124:127], v[80:95]
  ds_read_b64_tr_b16 a[180:181], v104 offset:2048
  ds_read_b64_tr_b16 a[182:183], v104 offset:2560
  s_add_u32 s62, s63, 1770112
  v_add_f32 v61, 1.0, v61
  v_add_f32 v62, 1.0, v62
  v_add_f32 v63, 1.0, v63
  v_rcp_f32 v60, v60
  s_waitcnt lgkmcnt(4)
  v_mfma_f32_32x32x16_bf16 v[80:95], a[192:195], a[128:131], v[80:95]
  ds_read_b64_tr_b16 a[184:185], v104 offset:4096
  ds_read_b64_tr_b16 a[186:187], v104 offset:4608
  s_add_u32 m0, s61, 98304
  v_rcp_f32 v61, v61
  v_rcp_f32 v62, v62
  v_mfma_f32_32x32x16_bf16 v[80:95], a[196:199], a[132:135], v[80:95]
  ds_read_b64_tr_b16 a[188:189], v104 offset:6144
  ds_read_b64_tr_b16 a[190:191], v104 offset:6656
  v_rcp_f32 v63, v63
  v_mul_f32 v60, v60, v76
  v_mul_f32 v61, v61, v77
  v_mfma_f32_32x32x16_bf16 v[80:95], a[200:203], a[136:139], v[80:95]
  ds_read_b64_tr_b16 a[192:193], v104 offset:8192
  ds_read_b64_tr_b16 a[194:195], v104 offset:8704
  buffer_load_dwordx4 v10, s[16:19], s62 offen offset:0 lds
  v_mul_f32 v62, v62, v78
  v_mul_f32 v63, v63, v79
  v_cvt_pk_bf16_f32 v150, v60, v61
  v_cvt_pk_bf16_f32 v151, v62, v63
  ds_write_b128 v110, v[148:151] offset:1024
  v_mfma_f32_32x32x16_bf16 v[80:95], a[204:207], a[140:143], v[80:95]
  ds_read_b64_tr_b16 a[196:197], v104 offset:10240
  ds_read_b64_tr_b16 a[198:199], v104 offset:10752
  buffer_load_dwordx4 v11, s[16:19], s62 offen offset:1024 lds
  v_mfma_f32_32x32x16_bf16 v[64:79], a[152:155], a[164:167], 0
  buffer_load_dwordx4 v12, s[16:19], s62 offen offset:2048 lds
  s_waitcnt lgkmcnt(5)
  v_mfma_f32_32x32x16_bf16 v[64:79], a[176:179], a[0:3], v[64:79]
  ds_read_b64_tr_b16 a[200:201], v104 offset:12288
  ds_read_b64_tr_b16 a[202:203], v104 offset:12800
  s_add_u32 s62, s63, 1991296
  v_mfma_f32_32x32x16_bf16 v[64:79], a[180:183], a[4:7], v[64:79]
  ds_read_b64_tr_b16 a[204:205], v104 offset:14336
  ds_read_b64_tr_b16 a[206:207], v104 offset:14848
  s_add_u32 m0, s61, 101376
  v_mul_f32 v56, v80, v80
  v_mul_f32 v57, v81, v81
  v_mul_f32 v58, v82, v82
  v_mul_f32 v59, v83, v83
  v_fmamk_f32 v56, v56, 0xbdd2d3e8, v17
  v_mfma_f32_32x32x16_bf16 v[64:79], a[184:187], a[8:11], v[64:79]
  ds_read_b64_tr_b16 a[176:177], v104 offset:16384
  ds_read_b64_tr_b16 a[178:179], v104 offset:16896
  v_fmamk_f32 v57, v57, 0xbdd2d3e8, v17
  v_fmamk_f32 v58, v58, 0xbdd2d3e8, v17
  v_fmamk_f32 v59, v59, 0xbdd2d3e8, v17
  v_mul_f32 v56, v56, v80
  v_mfma_f32_32x32x16_bf16 v[64:79], a[188:191], a[12:15], v[64:79]
  ds_read_b64_tr_b16 a[180:181], v104 offset:18432
  ds_read_b64_tr_b16 a[182:183], v104 offset:18944
  buffer_load_dwordx4 v10, s[16:19], s62 offen offset:0 lds
  v_mul_f32 v57, v57, v81
  v_mul_f32 v58, v58, v82
  v_mul_f32 v59, v59, v83
  v_exp_f32 v56, v56
  s_waitcnt lgkmcnt(4)
  v_mfma_f32_32x32x16_bf16 v[64:79], a[192:195], a[16:19], v[64:79]
  ds_read_b64_tr_b16 a[184:185], v104 offset:20480
  ds_read_b64_tr_b16 a[186:187], v104 offset:20992
  buffer_load_dwordx4 v11, s[16:19], s62 offen offset:1024 lds
  v_exp_f32 v57, v57
  v_exp_f32 v58, v58
  v_mfma_f32_32x32x16_bf16 v[64:79], a[196:199], a[20:23], v[64:79]
  ds_read_b64_tr_b16 a[188:189], v104 offset:22528
  ds_read_b64_tr_b16 a[190:191], v104 offset:23040
  buffer_load_dwordx4 v12, s[16:19], s62 offen offset:2048 lds
  v_exp_f32 v59, v59
  v_add_f32 v56, 1.0, v56
  v_add_f32 v57, 1.0, v57
  v_add_f32 v58, 1.0, v58
  v_mfma_f32_32x32x16_bf16 v[64:79], a[200:203], a[24:27], v[64:79]
  s_waitcnt vmcnt(18)
  s_barrier
  ds_read_b64_tr_b16 a[192:193], v104 offset:24576
  ds_read_b64_tr_b16 a[194:195], v104 offset:25088
  v_add_f32 v59, 1.0, v59
  v_rcp_f32 v56, v56
  v_rcp_f32 v57, v57
  v_mfma_f32_32x32x16_bf16 v[64:79], a[204:207], a[28:31], v[64:79]
  ds_read_b64_tr_b16 a[196:197], v104 offset:26624
  ds_read_b64_tr_b16 a[198:199], v104 offset:27136
  s_add_u32 s62, s63, 3539584
  ds_read_b128 v[152:155], v111 offset:0
  ds_read_b128 v[156:159], v111 offset:1024
  v_rcp_f32 v58, v58
  v_rcp_f32 v59, v59
  s_waitcnt lgkmcnt(6)
  v_mfma_f32_32x32x16_bf16 v[64:79], a[176:179], a[32:35], v[64:79]
  ds_read_b64_tr_b16 a[200:201], v104 offset:28672
  ds_read_b64_tr_b16 a[202:203], v104 offset:29184
  s_add_u32 m0, s61, 122880
  v_mul_f32 v56, v56, v80
  v_mul_f32 v57, v57, v81
  v_mul_f32 v58, v58, v82
  v_mul_f32 v59, v59, v83
  v_mfma_f32_32x32x16_bf16 v[64:79], a[180:183], a[36:39], v[64:79]
  ds_read_b64_tr_b16 a[204:205], v104 offset:30720
  ds_read_b64_tr_b16 a[206:207], v104 offset:31232
  buffer_load_dwordx4 v10, s[16:19], s62 offen offset:0 lds
  v_cvt_pk_bf16_f32 v160, v56, v57
  v_cvt_pk_bf16_f32 v161, v58, v59
  v_mul_f32 v60, v84, v84
  v_mul_f32 v61, v85, v85
  v_mul_f32 v62, v86, v86
  v_mfma_f32_32x32x16_bf16 v[64:79], a[184:187], a[40:43], v[64:79]
  ds_read_b64_tr_b16 a[176:177], v104 offset:32768
  ds_read_b64_tr_b16 a[178:179], v104 offset:33280
  buffer_load_dwordx4 v11, s[16:19], s62 offen offset:1024 lds
  v_mul_f32 v63, v87, v87
  v_fmamk_f32 v60, v60, 0xbdd2d3e8, v17
  v_fmamk_f32 v61, v61, 0xbdd2d3e8, v17
  v_fmamk_f32 v62, v62, 0xbdd2d3e8, v17
  v_mfma_f32_32x32x16_bf16 v[64:79], a[188:191], a[44:47], v[64:79]
  ds_read_b64_tr_b16 a[180:181], v104 offset:34816
  ds_read_b64_tr_b16 a[182:183], v104 offset:35328
  buffer_load_dwordx4 v12, s[16:19], s62 offen offset:2048 lds
  v_fmamk_f32 v63, v63, 0xbdd2d3e8, v17
  v_mul_f32 v60, v60, v84
  v_mul_f32 v61, v61, v85
  v_mul_f32 v62, v62, v86
  v_mul_f32 v63, v63, v87
  s_waitcnt lgkmcnt(4)
  v_mfma_f32_32x32x16_bf16 v[64:79], a[192:195], a[48:51], v[64:79]
  ds_read_b64_tr_b16 a[184:185], v104 offset:36864
  ds_read_b64_tr_b16 a[186:187], v104 offset:37376
  v_exp_f32 v60, v60
  v_exp_f32 v61, v61
  v_mfma_f32_32x32x16_bf16 v[64:79], a[196:199], a[52:55], v[64:79]
  ds_read_b64_tr_b16 a[188:189], v104 offset:38912
  ds_read_b64_tr_b16 a[190:191], v104 offset:39424
  s_add_u32 s62, s63, 3760768
  v_exp_f32 v62, v62
  v_exp_f32 v63, v63
  v_add_f32 v60, 1.0, v60
  v_mfma_f32_32x32x16_bf16 v[64:79], a[200:203], a[56:59], v[64:79]
  ds_read_b64_tr_b16 a[192:193], v104 offset:40960
  ds_read_b64_tr_b16 a[194:195], v104 offset:41472
  s_add_u32 m0, s61, 125952
  v_add_f32 v61, 1.0, v61
  v_add_f32 v62, 1.0, v62
  v_add_f32 v63, 1.0, v63
  v_rcp_f32 v60, v60
  v_mfma_f32_32x32x16_bf16 v[64:79], a[204:207], a[60:63], v[64:79]
  ds_read_b64_tr_b16 a[196:197], v104 offset:43008
  ds_read_b64_tr_b16 a[198:199], v104 offset:43520
  buffer_load_dwordx4 v10, s[16:19], s62 offen offset:0 lds
  v_rcp_f32 v61, v61
  v_rcp_f32 v62, v62
  s_waitcnt lgkmcnt(4)
  v_mfma_f32_32x32x16_bf16 v[64:79], a[176:179], a[64:67], v[64:79]
  ds_read_b64_tr_b16 a[200:201], v104 offset:45056
  ds_read_b64_tr_b16 a[202:203], v104 offset:45568
  buffer_load_dwordx4 v11, s[16:19], s62 offen offset:1024 lds
  v_rcp_f32 v63, v63
  v_mul_f32 v60, v60, v84
  v_mul_f32 v61, v61, v85
  v_mfma_f32_32x32x16_bf16 v[64:79], a[180:183], a[68:71], v[64:79]
  ds_read_b64_tr_b16 a[204:205], v104 offset:47104
  ds_read_b64_tr_b16 a[206:207], v104 offset:47616
  buffer_load_dwordx4 v12, s[16:19], s62 offen offset:2048 lds
  v_mul_f32 v62, v62, v86
  v_mul_f32 v63, v63, v87
  v_cvt_pk_bf16_f32 v162, v60, v61
  v_cvt_pk_bf16_f32 v163, v62, v63
  ds_write_b128 v110, v[160:163] offset:8192
  v_mfma_f32_32x32x16_bf16 v[64:79], a[184:187], a[72:75], v[64:79]
  s_waitcnt vmcnt(18)
  s_barrier
  ds_read_b64_tr_b16 a[176:177], v105 offset:0
  ds_read_b64_tr_b16 a[178:179], v105 offset:512
  v_mul_f32 v56, v88, v88
  v_mul_f32 v57, v89, v89
  v_mul_f32 v58, v90, v90
  v_mul_f32 v59, v91, v91
  v_fmamk_f32 v56, v56, 0xbdd2d3e8, v17
  v_mfma_f32_32x32x16_bf16 v[64:79], a[188:191], a[76:79], v[64:79]
  ds_read_b64_tr_b16 a[180:181], v105 offset:2048
  ds_read_b64_tr_b16 a[182:183], v105 offset:2560
  s_add_u32 s62, s63, 768
  v_fmamk_f32 v57, v57, 0xbdd2d3e8, v17
  v_fmamk_f32 v58, v58, 0xbdd2d3e8, v17
  v_fmamk_f32 v59, v59, 0xbdd2d3e8, v17
  v_mul_f32 v56, v56, v88
  s_waitcnt lgkmcnt(5)
  v_mfma_f32_32x32x16_bf16 v[64:79], a[192:195], a[80:83], v[64:79]
  ds_read_b64_tr_b16 a[184:185], v105 offset:4096
  ds_read_b64_tr_b16 a[186:187], v105 offset:4608
  s_add_u32 m0, s61, 0
  v_mul_f32 v57, v57, v89
  v_mul_f32 v58, v58, v90
  v_mul_f32 v59, v59, v91
  v_exp_f32 v56, v56
  v_mfma_f32_32x32x16_bf16 v[64:79], a[196:199], a[84:87], v[64:79]
  ds_read_b64_tr_b16 a[188:189], v105 offset:6144
  ds_read_b64_tr_b16 a[190:191], v105 offset:6656
  buffer_load_dwordx4 v10, s[16:19], s62 offen offset:0 lds
  v_exp_f32 v57, v57
  v_exp_f32 v58, v58
  v_mfma_f32_32x32x16_bf16 v[64:79], a[200:203], a[88:91], v[64:79]
  ds_read_b64_tr_b16 a[192:193], v105 offset:8192
  ds_read_b64_tr_b16 a[194:195], v105 offset:8704
  buffer_load_dwordx4 v11, s[16:19], s62 offen offset:1024 lds
  v_exp_f32 v59, v59
  v_add_f32 v56, 1.0, v56
  v_add_f32 v57, 1.0, v57
  v_add_f32 v58, 1.0, v58
  v_mfma_f32_32x32x16_bf16 v[64:79], a[204:207], a[92:95], v[64:79]
  ds_read_b64_tr_b16 a[196:197], v105 offset:10240
  ds_read_b64_tr_b16 a[198:199], v105 offset:10752
  buffer_load_dwordx4 v12, s[16:19], s62 offen offset:2048 lds
  v_add_f32 v59, 1.0, v59
  v_rcp_f32 v56, v56
  v_rcp_f32 v57, v57
  s_waitcnt lgkmcnt(4)
  v_mfma_f32_32x32x16_bf16 v[64:79], a[176:179], a[96:99], v[64:79]
  ds_read_b64_tr_b16 a[200:201], v105 offset:12288
  ds_read_b64_tr_b16 a[202:203], v105 offset:12800
  v_rcp_f32 v58, v58
  v_rcp_f32 v59, v59
  v_mfma_f32_32x32x16_bf16 v[64:79], a[180:183], a[100:103], v[64:79]
  ds_read_b64_tr_b16 a[204:205], v105 offset:14336
  ds_read_b64_tr_b16 a[206:207], v105 offset:14848
  s_add_u32 s62, s63, 221952
  v_mul_f32 v56, v56, v88
  v_mul_f32 v57, v57, v89
  v_mul_f32 v58, v58, v90
  v_mul_f32 v59, v59, v91
  v_mfma_f32_32x32x16_bf16 v[64:79], a[184:187], a[104:107], v[64:79]
  ds_read_b64_tr_b16 a[176:177], v105 offset:16384
  ds_read_b64_tr_b16 a[178:179], v105 offset:16896
  s_add_u32 m0, s61, 3072
  v_cvt_pk_bf16_f32 v164, v56, v57
  v_cvt_pk_bf16_f32 v165, v58, v59
  v_mul_f32 v60, v92, v92
  v_mul_f32 v61, v93, v93
  v_mul_f32 v62, v94, v94
  v_mfma_f32_32x32x16_bf16 v[64:79], a[188:191], a[108:111], v[64:79]
  ds_read_b64_tr_b16 a[180:181], v105 offset:18432
  ds_read_b64_tr_b16 a[182:183], v105 offset:18944
  buffer_load_dwordx4 v10, s[16:19], s62 offen offset:0 lds
  v_mul_f32 v63, v95, v95
  v_fmamk_f32 v60, v60, 0xbdd2d3e8, v17
  v_fmamk_f32 v61, v61, 0xbdd2d3e8, v17
  v_fmamk_f32 v62, v62, 0xbdd2d3e8, v17
  s_waitcnt lgkmcnt(4)
  v_mfma_f32_32x32x16_bf16 v[64:79], a[192:195], a[112:115], v[64:79]
  ds_read_b64_tr_b16 a[184:185], v105 offset:20480
  ds_read_b64_tr_b16 a[186:187], v105 offset:20992
  buffer_load_dwordx4 v11, s[16:19], s62 offen offset:1024 lds
  v_fmamk_f32 v63, v63, 0xbdd2d3e8, v17
  v_mul_f32 v60, v60, v92
  v_mul_f32 v61, v61, v93
  v_mul_f32 v62, v62, v94
  v_mul_f32 v63, v63, v95
  v_mfma_f32_32x32x16_bf16 v[64:79], a[196:199], a[116:119], v[64:79]
  ds_read_b64_tr_b16 a[188:189], v105 offset:22528
  ds_read_b64_tr_b16 a[190:191], v105 offset:23040
  buffer_load_dwordx4 v12, s[16:19], s62 offen offset:2048 lds
  v_exp_f32 v60, v60
  v_exp_f32 v61, v61
  v_mfma_f32_32x32x16_bf16 v[64:79], a[200:203], a[120:123], v[64:79]
  s_waitcnt vmcnt(18)
  s_barrier
  ds_read_b64_tr_b16 a[192:193], v105 offset:24576
  ds_read_b64_tr_b16 a[194:195], v105 offset:25088
  v_exp_f32 v62, v62
  v_exp_f32 v63, v63
  v_add_f32 v60, 1.0, v60
  v_mfma_f32_32x32x16_bf16 v[64:79], a[204:207], a[124:127], v[64:79]
  ds_read_b64_tr_b16 a[196:197], v105 offset:26624
  ds_read_b64_tr_b16 a[198:199], v105 offset:27136
  s_add_u32 s62, s63, 1770240
  v_add_f32 v61, 1.0, v61
  v_add_f32 v62, 1.0, v62
  v_add_f32 v63, 1.0, v63
  v_rcp_f32 v60, v60
  s_waitcnt lgkmcnt(4)
  v_mfma_f32_32x32x16_bf16 v[64:79], a[176:179], a[128:131], v[64:79]
  ds_read_b64_tr_b16 a[200:201], v105 offset:28672
  ds_read_b64_tr_b16 a[202:203], v105 offset:29184
  s_add_u32 m0, s61, 24576
  v_rcp_f32 v61, v61
  v_rcp_f32 v62, v62
  v_mfma_f32_32x32x16_bf16 v[64:79], a[180:183], a[132:135], v[64:79]
  ds_read_b64_tr_b16 a[204:205], v105 offset:30720
  ds_read_b64_tr_b16 a[206:207], v105 offset:31232
  v_rcp_f32 v63, v63
  v_mul_f32 v60, v60, v92
  v_mul_f32 v61, v61, v93
  v_mfma_f32_32x32x16_bf16 v[64:79], a[184:187], a[136:139], v[64:79]
  ds_read_b64_tr_b16 a[176:177], v105 offset:32768
  ds_read_b64_tr_b16 a[178:179], v105 offset:33280
  buffer_load_dwordx4 v10, s[16:19], s62 offen offset:0 lds
  v_mul_f32 v62, v62, v94
  v_mul_f32 v63, v63, v95
  v_cvt_pk_bf16_f32 v166, v60, v61
  v_cvt_pk_bf16_f32 v167, v62, v63
  ds_write_b128 v110, v[164:167] offset:9216
  v_mfma_f32_32x32x16_bf16 v[64:79], a[188:191], a[140:143], v[64:79]
  ds_read_b64_tr_b16 a[180:181], v105 offset:34816
  ds_read_b64_tr_b16 a[182:183], v105 offset:35328
  buffer_load_dwordx4 v11, s[16:19], s62 offen offset:1024 lds
  v_mfma_f32_32x32x16_bf16 v[80:95], a[154:157], a[164:167], 0
  buffer_load_dwordx4 v12, s[16:19], s62 offen offset:2048 lds
  s_waitcnt lgkmcnt(5)
  v_mfma_f32_32x32x16_bf16 v[80:95], a[192:195], a[0:3], v[80:95]
  ds_read_b64_tr_b16 a[184:185], v105 offset:36864
  ds_read_b64_tr_b16 a[186:187], v105 offset:37376
  s_add_u32 s62, s63, 1991424
  v_mfma_f32_32x32x16_bf16 v[80:95], a[196:199], a[4:7], v[80:95]
  ds_read_b64_tr_b16 a[188:189], v105 offset:38912
  ds_read_b64_tr_b16 a[190:191], v105 offset:39424
  s_add_u32 m0, s61, 27648
  v_mul_f32 v56, v64, v64
  v_mul_f32 v57, v65, v65
  v_mul_f32 v58, v66, v66
  v_mul_f32 v59, v67, v67
  v_fmamk_f32 v56, v56, 0xbdd2d3e8, v17
  v_mfma_f32_32x32x16_bf16 v[80:95], a[200:203], a[8:11], v[80:95]
  ds_read_b64_tr_b16 a[192:193], v105 offset:40960
  ds_read_b64_tr_b16 a[194:195], v105 offset:41472
  v_fmamk_f32 v57, v57, 0xbdd2d3e8, v17
  v_fmamk_f32 v58, v58, 0xbdd2d3e8, v17
  v_fmamk_f32 v59, v59, 0xbdd2d3e8, v17
  v_mul_f32 v56, v56, v64
  v_mfma_f32_32x32x16_bf16 v[80:95], a[204:207], a[12:15], v[80:95]
  ds_read_b64_tr_b16 a[196:197], v105 offset:43008
  ds_read_b64_tr_b16 a[198:199], v105 offset:43520
  buffer_load_dwordx4 v10, s[16:19], s62 offen offset:0 lds
  v_mul_f32 v57, v57, v65
  v_mul_f32 v58, v58, v66
  v_mul_f32 v59, v59, v67
  v_exp_f32 v56, v56
  s_waitcnt lgkmcnt(4)
  v_mfma_f32_32x32x16_bf16 v[80:95], a[176:179], a[16:19], v[80:95]
  ds_read_b64_tr_b16 a[200:201], v105 offset:45056
  ds_read_b64_tr_b16 a[202:203], v105 offset:45568
  buffer_load_dwordx4 v11, s[16:19], s62 offen offset:1024 lds
  v_exp_f32 v57, v57
  v_exp_f32 v58, v58
  v_mfma_f32_32x32x16_bf16 v[80:95], a[180:183], a[20:23], v[80:95]
  ds_read_b64_tr_b16 a[204:205], v105 offset:47104
  ds_read_b64_tr_b16 a[206:207], v105 offset:47616
  buffer_load_dwordx4 v12, s[16:19], s62 offen offset:2048 lds
  v_exp_f32 v59, v59
  v_add_f32 v56, 1.0, v56
  v_add_f32 v57, 1.0, v57
  v_add_f32 v58, 1.0, v58
  v_mfma_f32_32x32x16_bf16 v[80:95], a[184:187], a[24:27], v[80:95]
  s_waitcnt vmcnt(18)
  s_barrier
  ds_read_b64_tr_b16 a[176:177], v106 offset:0
  ds_read_b64_tr_b16 a[178:179], v106 offset:512
  v_add_f32 v59, 1.0, v59
  v_rcp_f32 v56, v56
  v_rcp_f32 v57, v57
  v_mfma_f32_32x32x16_bf16 v[80:95], a[188:191], a[28:31], v[80:95]
  ds_read_b64_tr_b16 a[180:181], v106 offset:2048
  ds_read_b64_tr_b16 a[182:183], v106 offset:2560
  s_add_u32 s62, s63, 3539712
  ds_read_b128 v[168:171], v111 offset:8192
  ds_read_b128 v[172:175], v111 offset:9216
  v_rcp_f32 v58, v58
  v_rcp_f32 v59, v59
  s_waitcnt lgkmcnt(6)
  v_mfma_f32_32x32x16_bf16 v[80:95], a[192:195], a[32:35], v[80:95]
  ds_read_b64_tr_b16 a[184:185], v106 offset:4096
  ds_read_b64_tr_b16 a[186:187], v106 offset:4608
  s_add_u32 m0, s61, 49152
  v_mul_f32 v56, v56, v64
  v_mul_f32 v57, v57, v65
  v_mul_f32 v58, v58, v66
  v_mul_f32 v59, v59, v67
  v_mfma_f32_32x32x16_bf16 v[80:95], a[196:199], a[36:39], v[80:95]
  ds_read_b64_tr_b16 a[188:189], v106 offset:6144
  ds_read_b64_tr_b16 a[190:191], v106 offset:6656
  buffer_load_dwordx4 v10, s[16:19], s62 offen offset:0 lds
  v_cvt_pk_bf16_f32 v176, v56, v57
  v_cvt_pk_bf16_f32 v177, v58, v59
  v_mul_f32 v60, v68, v68
  v_mul_f32 v61, v69, v69
  v_mul_f32 v62, v70, v70
  v_mfma_f32_32x32x16_bf16 v[80:95], a[200:203], a[40:43], v[80:95]
  ds_read_b64_tr_b16 a[192:193], v106 offset:8192
  ds_read_b64_tr_b16 a[194:195], v106 offset:8704
  buffer_load_dwordx4 v11, s[16:19], s62 offen offset:1024 lds
  v_mul_f32 v63, v71, v71
  v_fmamk_f32 v60, v60, 0xbdd2d3e8, v17
  v_fmamk_f32 v61, v61, 0xbdd2d3e8, v17
  v_fmamk_f32 v62, v62, 0xbdd2d3e8, v17
  v_mfma_f32_32x32x16_bf16 v[80:95], a[204:207], a[44:47], v[80:95]
  ds_read_b64_tr_b16 a[196:197], v106 offset:10240
  ds_read_b64_tr_b16 a[198:199], v106 offset:10752
  buffer_load_dwordx4 v12, s[16:19], s62 offen offset:2048 lds
  v_fmamk_f32 v63, v63, 0xbdd2d3e8, v17
  v_mul_f32 v60, v60, v68
  v_mul_f32 v61, v61, v69
  v_mul_f32 v62, v62, v70
  v_mul_f32 v63, v63, v71
  s_waitcnt lgkmcnt(4)
  v_mfma_f32_32x32x16_bf16 v[80:95], a[176:179], a[48:51], v[80:95]
  ds_read_b64_tr_b16 a[200:201], v106 offset:12288
  ds_read_b64_tr_b16 a[202:203], v106 offset:12800
  v_exp_f32 v60, v60
  v_exp_f32 v61, v61
  v_mfma_f32_32x32x16_bf16 v[80:95], a[180:183], a[52:55], v[80:95]
  ds_read_b64_tr_b16 a[204:205], v106 offset:14336
  ds_read_b64_tr_b16 a[206:207], v106 offset:14848
  s_add_u32 s62, s63, 3760896
  v_exp_f32 v62, v62
  v_exp_f32 v63, v63
  v_add_f32 v60, 1.0, v60
  v_mfma_f32_32x32x16_bf16 v[80:95], a[184:187], a[56:59], v[80:95]
  ds_read_b64_tr_b16 a[176:177], v106 offset:16384
  ds_read_b64_tr_b16 a[178:179], v106 offset:16896
  s_add_u32 m0, s61, 52224
  v_add_f32 v61, 1.0, v61
  v_add_f32 v62, 1.0, v62
  v_add_f32 v63, 1.0, v63
  v_rcp_f32 v60, v60
  v_mfma_f32_32x32x16_bf16 v[80:95], a[188:191], a[60:63], v[80:95]
  ds_read_b64_tr_b16 a[180:181], v106 offset:18432
  ds_read_b64_tr_b16 a[182:183], v106 offset:18944
  buffer_load_dwordx4 v10, s[16:19], s62 offen offset:0 lds
  v_rcp_f32 v61, v61
  v_rcp_f32 v62, v62
  s_waitcnt lgkmcnt(4)
  v_mfma_f32_32x32x16_bf16 v[80:95], a[192:195], a[64:67], v[80:95]
  ds_read_b64_tr_b16 a[184:185], v106 offset:20480
  ds_read_b64_tr_b16 a[186:187], v106 offset:20992
  buffer_load_dwordx4 v11, s[16:19], s62 offen offset:1024 lds
  v_rcp_f32 v63, v63
  v_mul_f32 v60, v60, v68
  v_mul_f32 v61, v61, v69
  v_mfma_f32_32x32x16_bf16 v[80:95], a[196:199], a[68:71], v[80:95]
  ds_read_b64_tr_b16 a[188:189], v106 offset:22528
  ds_read_b64_tr_b16 a[190:191], v106 offset:23040
  buffer_load_dwordx4 v12, s[16:19], s62 offen offset:2048 lds
  v_mul_f32 v62, v62, v70
  v_mul_f32 v63, v63, v71
  v_cvt_pk_bf16_f32 v178, v60, v61
  v_cvt_pk_bf16_f32 v179, v62, v63
  ds_write_b128 v110, v[176:179] offset:0
  v_mfma_f32_32x32x16_bf16 v[80:95], a[200:203], a[72:75], v[80:95]
  s_waitcnt vmcnt(18)
  s_barrier
  ds_read_b64_tr_b16 a[192:193], v106 offset:24576
  ds_read_b64_tr_b16 a[194:195], v106 offset:25088
  v_mul_f32 v56, v72, v72
  v_mul_f32 v57, v73, v73
  v_mul_f32 v58, v74, v74
  v_mul_f32 v59, v75, v75
  v_fmamk_f32 v56, v56, 0xbdd2d3e8, v17
  v_mfma_f32_32x32x16_bf16 v[80:95], a[204:207], a[76:79], v[80:95]
  ds_read_b64_tr_b16 a[196:197], v106 offset:26624
  ds_read_b64_tr_b16 a[198:199], v106 offset:27136
  s_add_u32 s62, s63, 896
  v_fmamk_f32 v57, v57, 0xbdd2d3e8, v17
  v_fmamk_f32 v58, v58, 0xbdd2d3e8, v17
  v_fmamk_f32 v59, v59, 0xbdd2d3e8, v17
  v_mul_f32 v56, v56, v72
  s_waitcnt lgkmcnt(5)
  v_mfma_f32_32x32x16_bf16 v[80:95], a[176:179], a[80:83], v[80:95]
  ds_read_b64_tr_b16 a[200:201], v106 offset:28672
  ds_read_b64_tr_b16 a[202:203], v106 offset:29184
  s_add_u32 m0, s61, 73728
  v_mul_f32 v57, v57, v73
  v_mul_f32 v58, v58, v74
  v_mul_f32 v59, v59, v75
  v_exp_f32 v56, v56
  v_mfma_f32_32x32x16_bf16 v[80:95], a[180:183], a[84:87], v[80:95]
  ds_read_b64_tr_b16 a[204:205], v106 offset:30720
  ds_read_b64_tr_b16 a[206:207], v106 offset:31232
  buffer_load_dwordx4 v10, s[16:19], s62 offen offset:0 lds
  v_exp_f32 v57, v57
  v_exp_f32 v58, v58
  v_mfma_f32_32x32x16_bf16 v[80:95], a[184:187], a[88:91], v[80:95]
  ds_read_b64_tr_b16 a[176:177], v106 offset:32768
  ds_read_b64_tr_b16 a[178:179], v106 offset:33280
  buffer_load_dwordx4 v11, s[16:19], s62 offen offset:1024 lds
  v_exp_f32 v59, v59
  v_add_f32 v56, 1.0, v56
  v_add_f32 v57, 1.0, v57
  v_add_f32 v58, 1.0, v58
  v_mfma_f32_32x32x16_bf16 v[80:95], a[188:191], a[92:95], v[80:95]
  ds_read_b64_tr_b16 a[180:181], v106 offset:34816
  ds_read_b64_tr_b16 a[182:183], v106 offset:35328
  buffer_load_dwordx4 v12, s[16:19], s62 offen offset:2048 lds
  v_add_f32 v59, 1.0, v59
  v_rcp_f32 v56, v56
  v_rcp_f32 v57, v57
  s_waitcnt lgkmcnt(4)
  v_mfma_f32_32x32x16_bf16 v[80:95], a[192:195], a[96:99], v[80:95]
  ds_read_b64_tr_b16 a[184:185], v106 offset:36864
  ds_read_b64_tr_b16 a[186:187], v106 offset:37376
  v_rcp_f32 v58, v58
  v_rcp_f32 v59, v59
  v_mfma_f32_32x32x16_bf16 v[80:95], a[196:199], a[100:103], v[80:95]
  ds_read_b64_tr_b16 a[188:189], v106 offset:38912
  ds_read_b64_tr_b16 a[190:191], v106 offset:39424
  s_add_u32 s62, s63, 222080
  v_mul_f32 v56, v56, v72
  v_mul_f32 v57, v57, v73
  v_mul_f32 v58, v58, v74
  v_mul_f32 v59, v59, v75
  v_mfma_f32_32x32x16_bf16 v[80:95], a[200:203], a[104:107], v[80:95]
  ds_read_b64_tr_b16 a[192:193], v106 offset:40960
  ds_read_b64_tr_b16 a[194:195], v106 offset:41472
  s_add_u32 m0, s61, 76800
  v_cvt_pk_bf16_f32 v180, v56, v57
  v_cvt_pk_bf16_f32 v181, v58, v59
  v_mul_f32 v60, v76, v76
  v_mul_f32 v61, v77, v77
  v_mul_f32 v62, v78, v78
  v_mfma_f32_32x32x16_bf16 v[80:95], a[204:207], a[108:111], v[80:95]
  ds_read_b64_tr_b16 a[196:197], v106 offset:43008
  ds_read_b64_tr_b16 a[198:199], v106 offset:43520
  buffer_load_dwordx4 v10, s[16:19], s62 offen offset:0 lds
  v_mul_f32 v63, v79, v79
  v_fmamk_f32 v60, v60, 0xbdd2d3e8, v17
  v_fmamk_f32 v61, v61, 0xbdd2d3e8, v17
  v_fmamk_f32 v62, v62, 0xbdd2d3e8, v17
  s_waitcnt lgkmcnt(4)
  v_mfma_f32_32x32x16_bf16 v[80:95], a[176:179], a[112:115], v[80:95]
  ds_read_b64_tr_b16 a[200:201], v106 offset:45056
  ds_read_b64_tr_b16 a[202:203], v106 offset:45568
  buffer_load_dwordx4 v11, s[16:19], s62 offen offset:1024 lds
  v_fmamk_f32 v63, v63, 0xbdd2d3e8, v17
  v_mul_f32 v60, v60, v76
  v_mul_f32 v61, v61, v77
  v_mul_f32 v62, v62, v78
  v_mul_f32 v63, v63, v79
  v_mfma_f32_32x32x16_bf16 v[80:95], a[180:183], a[116:119], v[80:95]
  ds_read_b64_tr_b16 a[204:205], v106 offset:47104
  ds_read_b64_tr_b16 a[206:207], v106 offset:47616
  buffer_load_dwordx4 v12, s[16:19], s62 offen offset:2048 lds
  v_exp_f32 v60, v60
  v_exp_f32 v61, v61
  v_mfma_f32_32x32x16_bf16 v[80:95], a[184:187], a[120:123], v[80:95]
  s_waitcnt vmcnt(18)
  s_barrier
  ds_read_b64_tr_b16 a[176:177], v104 offset:0
  ds_read_b64_tr_b16 a[178:179], v104 offset:512
  v_exp_f32 v62, v62
  v_exp_f32 v63, v63
  v_add_f32 v60, 1.0, v60
  v_mfma_f32_32x32x16_bf16 v[80:95], a[188:191], a[124:127], v[80:95]
  ds_read_b64_tr_b16 a[180:181], v104 offset:2048
  ds_read_b64_tr_b16 a[182:183], v104 offset:2560
  s_add_u32 s62, s63, 1770368
  v_add_f32 v61, 1.0, v61
  v_add_f32 v62, 1.0, v62
  v_add_f32 v63, 1.0, v63
  v_rcp_f32 v60, v60
  s_waitcnt lgkmcnt(4)
  v_mfma_f32_32x32x16_bf16 v[80:95], a[192:195], a[128:131], v[80:95]
  ds_read_b64_tr_b16 a[184:185], v104 offset:4096
  ds_read_b64_tr_b16 a[186:187], v104 offset:4608
  s_add_u32 m0, s61, 98304
  v_rcp_f32 v61, v61
  v_rcp_f32 v62, v62
  v_mfma_f32_32x32x16_bf16 v[80:95], a[196:199], a[132:135], v[80:95]
  ds_read_b64_tr_b16 a[188:189], v104 offset:6144
  ds_read_b64_tr_b16 a[190:191], v104 offset:6656
  v_rcp_f32 v63, v63
  v_mul_f32 v60, v60, v76
  v_mul_f32 v61, v61, v77
  v_mfma_f32_32x32x16_bf16 v[80:95], a[200:203], a[136:139], v[80:95]
  ds_read_b64_tr_b16 a[192:193], v104 offset:8192
  ds_read_b64_tr_b16 a[194:195], v104 offset:8704
  buffer_load_dwordx4 v10, s[16:19], s62 offen offset:0 lds
  v_mul_f32 v62, v62, v78
  v_mul_f32 v63, v63, v79
  v_cvt_pk_bf16_f32 v182, v60, v61
  v_cvt_pk_bf16_f32 v183, v62, v63
  ds_write_b128 v110, v[180:183] offset:1024
  v_mfma_f32_32x32x16_bf16 v[80:95], a[204:207], a[140:143], v[80:95]
  ds_read_b64_tr_b16 a[196:197], v104 offset:10240
  ds_read_b64_tr_b16 a[198:199], v104 offset:10752
  buffer_load_dwordx4 v11, s[16:19], s62 offen offset:1024 lds
  v_mfma_f32_32x32x16_bf16 v[64:79], a[156:159], a[164:167], 0
  buffer_load_dwordx4 v12, s[16:19], s62 offen offset:2048 lds
  s_waitcnt lgkmcnt(5)
  v_mfma_f32_32x32x16_bf16 v[64:79], a[176:179], a[0:3], v[64:79]
  ds_read_b64_tr_b16 a[200:201], v104 offset:12288
  ds_read_b64_tr_b16 a[202:203], v104 offset:12800
  s_add_u32 s62, s63, 1991552
  v_mfma_f32_32x32x16_bf16 v[64:79], a[180:183], a[4:7], v[64:79]
  ds_read_b64_tr_b16 a[204:205], v104 offset:14336
  ds_read_b64_tr_b16 a[206:207], v104 offset:14848
  s_add_u32 m0, s61, 101376
  v_mul_f32 v56, v80, v80
  v_mul_f32 v57, v81, v81
  v_mul_f32 v58, v82, v82
  v_mul_f32 v59, v83, v83
  v_fmamk_f32 v56, v56, 0xbdd2d3e8, v17
  v_mfma_f32_32x32x16_bf16 v[64:79], a[184:187], a[8:11], v[64:79]
  ds_read_b64_tr_b16 a[176:177], v104 offset:16384
  ds_read_b64_tr_b16 a[178:179], v104 offset:16896
  v_fmamk_f32 v57, v57, 0xbdd2d3e8, v17
  v_fmamk_f32 v58, v58, 0xbdd2d3e8, v17
  v_fmamk_f32 v59, v59, 0xbdd2d3e8, v17
  v_mul_f32 v56, v56, v80
  v_mfma_f32_32x32x16_bf16 v[64:79], a[188:191], a[12:15], v[64:79]
  ds_read_b64_tr_b16 a[180:181], v104 offset:18432
  ds_read_b64_tr_b16 a[182:183], v104 offset:18944
  buffer_load_dwordx4 v10, s[16:19], s62 offen offset:0 lds
  v_mul_f32 v57, v57, v81
  v_mul_f32 v58, v58, v82
  v_mul_f32 v59, v59, v83
  v_exp_f32 v56, v56
  s_waitcnt lgkmcnt(4)
  v_mfma_f32_32x32x16_bf16 v[64:79], a[192:195], a[16:19], v[64:79]
  ds_read_b64_tr_b16 a[184:185], v104 offset:20480
  ds_read_b64_tr_b16 a[186:187], v104 offset:20992
  buffer_load_dwordx4 v11, s[16:19], s62 offen offset:1024 lds
  v_exp_f32 v57, v57
  v_exp_f32 v58, v58
  v_mfma_f32_32x32x16_bf16 v[64:79], a[196:199], a[20:23], v[64:79]
  ds_read_b64_tr_b16 a[188:189], v104 offset:22528
  ds_read_b64_tr_b16 a[190:191], v104 offset:23040
  buffer_load_dwordx4 v12, s[16:19], s62 offen offset:2048 lds
  v_exp_f32 v59, v59
  v_add_f32 v56, 1.0, v56
  v_add_f32 v57, 1.0, v57
  v_add_f32 v58, 1.0, v58
  v_mfma_f32_32x32x16_bf16 v[64:79], a[200:203], a[24:27], v[64:79]
  s_waitcnt vmcnt(18)
  s_barrier
  ds_read_b64_tr_b16 a[192:193], v104 offset:24576
  ds_read_b64_tr_b16 a[194:195], v104 offset:25088
  v_add_f32 v59, 1.0, v59
  v_rcp_f32 v56, v56
  v_rcp_f32 v57, v57
  v_mfma_f32_32x32x16_bf16 v[64:79], a[204:207], a[28:31], v[64:79]
  ds_read_b64_tr_b16 a[196:197], v104 offset:26624
  ds_read_b64_tr_b16 a[198:199], v104 offset:27136
  s_add_u32 s62, s63, 3539840
  ds_read_b128 v[184:187], v111 offset:0
  ds_read_b128 v[188:191], v111 offset:1024
  v_rcp_f32 v58, v58
  v_rcp_f32 v59, v59
  s_waitcnt lgkmcnt(6)
  v_mfma_f32_32x32x16_bf16 v[64:79], a[176:179], a[32:35], v[64:79]
  ds_read_b64_tr_b16 a[200:201], v104 offset:28672
  ds_read_b64_tr_b16 a[202:203], v104 offset:29184
  s_add_u32 m0, s61, 122880
  v_mul_f32 v56, v56, v80
  v_mul_f32 v57, v57, v81
  v_mul_f32 v58, v58, v82
  v_mul_f32 v59, v59, v83
  v_mfma_f32_32x32x16_bf16 v[64:79], a[180:183], a[36:39], v[64:79]
  ds_read_b64_tr_b16 a[204:205], v104 offset:30720
  ds_read_b64_tr_b16 a[206:207], v104 offset:31232
  buffer_load_dwordx4 v10, s[16:19], s62 offen offset:0 lds
  v_cvt_pk_bf16_f32 v192, v56, v57
  v_cvt_pk_bf16_f32 v193, v58, v59
  v_mul_f32 v60, v84, v84
  v_mul_f32 v61, v85, v85
  v_mul_f32 v62, v86, v86
  v_mfma_f32_32x32x16_bf16 v[64:79], a[184:187], a[40:43], v[64:79]
  ds_read_b64_tr_b16 a[176:177], v104 offset:32768
  ds_read_b64_tr_b16 a[178:179], v104 offset:33280
  buffer_load_dwordx4 v11, s[16:19], s62 offen offset:1024 lds
  v_mul_f32 v63, v87, v87
  v_fmamk_f32 v60, v60, 0xbdd2d3e8, v17
  v_fmamk_f32 v61, v61, 0xbdd2d3e8, v17
  v_fmamk_f32 v62, v62, 0xbdd2d3e8, v17
  v_mfma_f32_32x32x16_bf16 v[64:79], a[188:191], a[44:47], v[64:79]
  ds_read_b64_tr_b16 a[180:181], v104 offset:34816
  ds_read_b64_tr_b16 a[182:183], v104 offset:35328
  buffer_load_dwordx4 v12, s[16:19], s62 offen offset:2048 lds
  v_fmamk_f32 v63, v63, 0xbdd2d3e8, v17
  v_mul_f32 v60, v60, v84
  v_mul_f32 v61, v61, v85
  v_mul_f32 v62, v62, v86
  v_mul_f32 v63, v63, v87
  s_waitcnt lgkmcnt(4)
  v_mfma_f32_32x32x16_bf16 v[64:79], a[192:195], a[48:51], v[64:79]
  ds_read_b64_tr_b16 a[184:185], v104 offset:36864
  ds_read_b64_tr_b16 a[186:187], v104 offset:37376
  v_exp_f32 v60, v60
  v_exp_f32 v61, v61
  v_mfma_f32_32x32x16_bf16 v[64:79], a[196:199], a[52:55], v[64:79]
  ds_read_b64_tr_b16 a[188:189], v104 offset:38912
  ds_read_b64_tr_b16 a[190:191], v104 offset:39424
  s_add_u32 s62, s63, 3761024
  v_exp_f32 v62, v62
  v_exp_f32 v63, v63
  v_add_f32 v60, 1.0, v60
  v_mfma_f32_32x32x16_bf16 v[64:79], a[200:203], a[56:59], v[64:79]
  ds_read_b64_tr_b16 a[192:193], v104 offset:40960
  ds_read_b64_tr_b16 a[194:195], v104 offset:41472
  s_add_u32 m0, s61, 125952
  v_add_f32 v61, 1.0, v61
  v_add_f32 v62, 1.0, v62
  v_add_f32 v63, 1.0, v63
  v_rcp_f32 v60, v60
  v_mfma_f32_32x32x16_bf16 v[64:79], a[204:207], a[60:63], v[64:79]
  ds_read_b64_tr_b16 a[196:197], v104 offset:43008
  ds_read_b64_tr_b16 a[198:199], v104 offset:43520
  buffer_load_dwordx4 v10, s[16:19], s62 offen offset:0 lds
  v_rcp_f32 v61, v61
  v_rcp_f32 v62, v62
  s_waitcnt lgkmcnt(4)
  v_mfma_f32_32x32x16_bf16 v[64:79], a[176:179], a[64:67], v[64:79]
  ds_read_b64_tr_b16 a[200:201], v104 offset:45056
  ds_read_b64_tr_b16 a[202:203], v104 offset:45568
  buffer_load_dwordx4 v11, s[16:19], s62 offen offset:1024 lds
  v_rcp_f32 v63, v63
  v_mul_f32 v60, v60, v84
  v_mul_f32 v61, v61, v85
  v_mfma_f32_32x32x16_bf16 v[64:79], a[180:183], a[68:71], v[64:79]
  ds_read_b64_tr_b16 a[204:205], v104 offset:47104
  ds_read_b64_tr_b16 a[206:207], v104 offset:47616
  buffer_load_dwordx4 v12, s[16:19], s62 offen offset:2048 lds
  v_mul_f32 v62, v62, v86
  v_mul_f32 v63, v63, v87
  v_cvt_pk_bf16_f32 v194, v60, v61
  v_cvt_pk_bf16_f32 v195, v62, v63
  ds_write_b128 v110, v[192:195] offset:8192
  v_mfma_f32_32x32x16_bf16 v[64:79], a[184:187], a[72:75], v[64:79]
  s_waitcnt vmcnt(18)
  s_barrier
  ds_read_b64_tr_b16 a[176:177], v105 offset:0
  ds_read_b64_tr_b16 a[178:179], v105 offset:512
  v_mul_f32 v56, v88, v88
  v_mul_f32 v57, v89, v89
  v_mul_f32 v58, v90, v90
  v_mul_f32 v59, v91, v91
  v_fmamk_f32 v56, v56, 0xbdd2d3e8, v17
  v_mfma_f32_32x32x16_bf16 v[64:79], a[188:191], a[76:79], v[64:79]
  ds_read_b64_tr_b16 a[180:181], v105 offset:2048
  ds_read_b64_tr_b16 a[182:183], v105 offset:2560
  s_add_u32 s62, s63, 1024
  v_fmamk_f32 v57, v57, 0xbdd2d3e8, v17
  v_fmamk_f32 v58, v58, 0xbdd2d3e8, v17
  v_fmamk_f32 v59, v59, 0xbdd2d3e8, v17
  v_mul_f32 v56, v56, v88
  s_waitcnt lgkmcnt(5)
  v_mfma_f32_32x32x16_bf16 v[64:79], a[192:195], a[80:83], v[64:79]
  ds_read_b64_tr_b16 a[184:185], v105 offset:4096
  ds_read_b64_tr_b16 a[186:187], v105 offset:4608
  s_add_u32 m0, s61, 0
  v_mul_f32 v57, v57, v89
  v_mul_f32 v58, v58, v90
  v_mul_f32 v59, v59, v91
  v_exp_f32 v56, v56
  v_mfma_f32_32x32x16_bf16 v[64:79], a[196:199], a[84:87], v[64:79]
  ds_read_b64_tr_b16 a[188:189], v105 offset:6144
  ds_read_b64_tr_b16 a[190:191], v105 offset:6656
  buffer_load_dwordx4 v10, s[16:19], s62 offen offset:0 lds
  v_exp_f32 v57, v57
  v_exp_f32 v58, v58
  v_mfma_f32_32x32x16_bf16 v[64:79], a[200:203], a[88:91], v[64:79]
  ds_read_b64_tr_b16 a[192:193], v105 offset:8192
  ds_read_b64_tr_b16 a[194:195], v105 offset:8704
  buffer_load_dwordx4 v11, s[16:19], s62 offen offset:1024 lds
  v_exp_f32 v59, v59
  v_add_f32 v56, 1.0, v56
  v_add_f32 v57, 1.0, v57
  v_add_f32 v58, 1.0, v58
  v_mfma_f32_32x32x16_bf16 v[64:79], a[204:207], a[92:95], v[64:79]
  ds_read_b64_tr_b16 a[196:197], v105 offset:10240
  ds_read_b64_tr_b16 a[198:199], v105 offset:10752
  buffer_load_dwordx4 v12, s[16:19], s62 offen offset:2048 lds
  v_add_f32 v59, 1.0, v59
  v_rcp_f32 v56, v56
  v_rcp_f32 v57, v57
  s_waitcnt lgkmcnt(4)
  v_mfma_f32_32x32x16_bf16 v[64:79], a[176:179], a[96:99], v[64:79]
  ds_read_b64_tr_b16 a[200:201], v105 offset:12288
  ds_read_b64_tr_b16 a[202:203], v105 offset:12800
  v_rcp_f32 v58, v58
  v_rcp_f32 v59, v59
  v_mfma_f32_32x32x16_bf16 v[64:79], a[180:183], a[100:103], v[64:79]
  ds_read_b64_tr_b16 a[204:205], v105 offset:14336
  ds_read_b64_tr_b16 a[206:207], v105 offset:14848
  s_add_u32 s62, s63, 222208
  v_mul_f32 v56, v56, v88
  v_mul_f32 v57, v57, v89
  v_mul_f32 v58, v58, v90
  v_mul_f32 v59, v59, v91
  v_mfma_f32_32x32x16_bf16 v[64:79], a[184:187], a[104:107], v[64:79]
  ds_read_b64_tr_b16 a[176:177], v105 offset:16384
  ds_read_b64_tr_b16 a[178:179], v105 offset:16896
  s_add_u32 m0, s61, 3072
  v_cvt_pk_bf16_f32 v196, v56, v57
  v_cvt_pk_bf16_f32 v197, v58, v59
  v_mul_f32 v60, v92, v92
  v_mul_f32 v61, v93, v93
  v_mul_f32 v62, v94, v94
  v_mfma_f32_32x32x16_bf16 v[64:79], a[188:191], a[108:111], v[64:79]
  ds_read_b64_tr_b16 a[180:181], v105 offset:18432
  ds_read_b64_tr_b16 a[182:183], v105 offset:18944
  buffer_load_dwordx4 v10, s[16:19], s62 offen offset:0 lds
  v_mul_f32 v63, v95, v95
  v_fmamk_f32 v60, v60, 0xbdd2d3e8, v17
  v_fmamk_f32 v61, v61, 0xbdd2d3e8, v17
  v_fmamk_f32 v62, v62, 0xbdd2d3e8, v17
  s_waitcnt lgkmcnt(4)
  v_mfma_f32_32x32x16_bf16 v[64:79], a[192:195], a[112:115], v[64:79]
  ds_read_b64_tr_b16 a[184:185], v105 offset:20480
  ds_read_b64_tr_b16 a[186:187], v105 offset:20992
  buffer_load_dwordx4 v11, s[16:19], s62 offen offset:1024 lds
  v_fmamk_f32 v63, v63, 0xbdd2d3e8, v17
  v_mul_f32 v60, v60, v92
  v_mul_f32 v61, v61, v93
  v_mul_f32 v62, v62, v94
  v_mul_f32 v63, v63, v95
  v_mfma_f32_32x32x16_bf16 v[64:79], a[196:199], a[116:119], v[64:79]
  ds_read_b64_tr_b16 a[188:189], v105 offset:22528
  ds_read_b64_tr_b16 a[190:191], v105 offset:23040
  buffer_load_dwordx4 v12, s[16:19], s62 offen offset:2048 lds
  v_exp_f32 v60, v60
  v_exp_f32 v61, v61
  v_mfma_f32_32x32x16_bf16 v[64:79], a[200:203], a[120:123], v[64:79]
  s_waitcnt vmcnt(18)
  s_barrier
  ds_read_b64_tr_b16 a[192:193], v105 offset:24576
  ds_read_b64_tr_b16 a[194:195], v105 offset:25088
  v_exp_f32 v62, v62
  v_exp_f32 v63, v63
  v_add_f32 v60, 1.0, v60
  v_mfma_f32_32x32x16_bf16 v[64:79], a[204:207], a[124:127], v[64:79]
  ds_read_b64_tr_b16 a[196:197], v105 offset:26624
  ds_read_b64_tr_b16 a[198:199], v105 offset:27136
  s_add_u32 s62, s63, 1770496
  v_add_f32 v61, 1.0, v61
  v_add_f32 v62, 1.0, v62
  v_add_f32 v63, 1.0, v63
  v_rcp_f32 v60, v60
  s_waitcnt lgkmcnt(4)
  v_mfma_f32_32x32x16_bf16 v[64:79], a[176:179], a[128:131], v[64:79]
  ds_read_b64_tr_b16 a[200:201], v105 offset:28672
  ds_read_b64_tr_b16 a[202:203], v105 offset:29184
  s_add_u32 m0, s61, 24576
  v_rcp_f32 v61, v61
  v_rcp_f32 v62, v62
  v_mfma_f32_32x32x16_bf16 v[64:79], a[180:183], a[132:135], v[64:79]
  ds_read_b64_tr_b16 a[204:205], v105 offset:30720
  ds_read_b64_tr_b16 a[206:207], v105 offset:31232
  v_rcp_f32 v63, v63
  v_mul_f32 v60, v60, v92
  v_mul_f32 v61, v61, v93
  v_mfma_f32_32x32x16_bf16 v[64:79], a[184:187], a[136:139], v[64:79]
  ds_read_b64_tr_b16 a[176:177], v105 offset:32768
  ds_read_b64_tr_b16 a[178:179], v105 offset:33280
  buffer_load_dwordx4 v10, s[16:19], s62 offen offset:0 lds
  v_mul_f32 v62, v62, v94
  v_mul_f32 v63, v63, v95
  v_cvt_pk_bf16_f32 v198, v60, v61
  v_cvt_pk_bf16_f32 v199, v62, v63
  ds_write_b128 v110, v[196:199] offset:9216
  v_mfma_f32_32x32x16_bf16 v[64:79], a[188:191], a[140:143], v[64:79]
  ds_read_b64_tr_b16 a[180:181], v105 offset:34816
  ds_read_b64_tr_b16 a[182:183], v105 offset:35328
  buffer_load_dwordx4 v11, s[16:19], s62 offen offset:1024 lds
  v_mfma_f32_32x32x16_bf16 v[80:95], a[158:161], a[164:167], 0
  buffer_load_dwordx4 v12, s[16:19], s62 offen offset:2048 lds
  s_waitcnt lgkmcnt(5)
  v_mfma_f32_32x32x16_bf16 v[80:95], a[192:195], a[0:3], v[80:95]
  ds_read_b64_tr_b16 a[184:185], v105 offset:36864
  ds_read_b64_tr_b16 a[186:187], v105 offset:37376
  s_add_u32 s62, s63, 1991680
  v_mfma_f32_32x32x16_bf16 v[80:95], a[196:199], a[4:7], v[80:95]
  ds_read_b64_tr_b16 a[188:189], v105 offset:38912
  ds_read_b64_tr_b16 a[190:191], v105 offset:39424
  s_add_u32 m0, s61, 27648
  v_mul_f32 v56, v64, v64
  v_mul_f32 v57, v65, v65
  v_mul_f32 v58, v66, v66
  v_mul_f32 v59, v67, v67
  v_fmamk_f32 v56, v56, 0xbdd2d3e8, v17
  v_mfma_f32_32x32x16_bf16 v[80:95], a[200:203], a[8:11], v[80:95]
  ds_read_b64_tr_b16 a[192:193], v105 offset:40960
  ds_read_b64_tr_b16 a[194:195], v105 offset:41472
  v_fmamk_f32 v57, v57, 0xbdd2d3e8, v17
  v_fmamk_f32 v58, v58, 0xbdd2d3e8, v17
  v_fmamk_f32 v59, v59, 0xbdd2d3e8, v17
  v_mul_f32 v56, v56, v64
  v_mfma_f32_32x32x16_bf16 v[80:95], a[204:207], a[12:15], v[80:95]
  ds_read_b64_tr_b16 a[196:197], v105 offset:43008
  ds_read_b64_tr_b16 a[198:199], v105 offset:43520
  buffer_load_dwordx4 v10, s[16:19], s62 offen offset:0 lds
  v_mul_f32 v57, v57, v65
  v_mul_f32 v58, v58, v66
  v_mul_f32 v59, v59, v67
  v_exp_f32 v56, v56
  s_waitcnt lgkmcnt(4)
  v_mfma_f32_32x32x16_bf16 v[80:95], a[176:179], a[16:19], v[80:95]
  ds_read_b64_tr_b16 a[200:201], v105 offset:45056
  ds_read_b64_tr_b16 a[202:203], v105 offset:45568
  buffer_load_dwordx4 v11, s[16:19], s62 offen offset:1024 lds
  v_exp_f32 v57, v57
  v_exp_f32 v58, v58
  v_mfma_f32_32x32x16_bf16 v[80:95], a[180:183], a[20:23], v[80:95]
  ds_read_b64_tr_b16 a[204:205], v105 offset:47104
  ds_read_b64_tr_b16 a[206:207], v105 offset:47616
  buffer_load_dwordx4 v12, s[16:19], s62 offen offset:2048 lds
  v_exp_f32 v59, v59
  v_add_f32 v56, 1.0, v56
  v_add_f32 v57, 1.0, v57
  v_add_f32 v58, 1.0, v58
  v_mfma_f32_32x32x16_bf16 v[80:95], a[184:187], a[24:27], v[80:95]
  s_waitcnt vmcnt(18)
  s_barrier
  ds_read_b64_tr_b16 a[176:177], v106 offset:0
  ds_read_b64_tr_b16 a[178:179], v106 offset:512
  v_add_f32 v59, 1.0, v59
  v_rcp_f32 v56, v56
  v_rcp_f32 v57, v57
  v_mfma_f32_32x32x16_bf16 v[80:95], a[188:191], a[28:31], v[80:95]
  ds_read_b64_tr_b16 a[180:181], v106 offset:2048
  ds_read_b64_tr_b16 a[182:183], v106 offset:2560
  s_add_u32 s62, s63, 3539968
  ds_read_b128 v[200:203], v111 offset:8192
  ds_read_b128 v[204:207], v111 offset:9216
  v_rcp_f32 v58, v58
  v_rcp_f32 v59, v59
  s_waitcnt lgkmcnt(6)
  v_mfma_f32_32x32x16_bf16 v[80:95], a[192:195], a[32:35], v[80:95]
  ds_read_b64_tr_b16 a[184:185], v106 offset:4096
  ds_read_b64_tr_b16 a[186:187], v106 offset:4608
  s_add_u32 m0, s61, 49152
  v_mul_f32 v56, v56, v64
  v_mul_f32 v57, v57, v65
  v_mul_f32 v58, v58, v66
  v_mul_f32 v59, v59, v67
  v_mfma_f32_32x32x16_bf16 v[80:95], a[196:199], a[36:39], v[80:95]
  ds_read_b64_tr_b16 a[188:189], v106 offset:6144
  ds_read_b64_tr_b16 a[190:191], v106 offset:6656
  buffer_load_dwordx4 v10, s[16:19], s62 offen offset:0 lds
  v_cvt_pk_bf16_f32 v208, v56, v57
  v_cvt_pk_bf16_f32 v209, v58, v59
  v_mul_f32 v60, v68, v68
  v_mul_f32 v61, v69, v69
  v_mul_f32 v62, v70, v70
  v_mfma_f32_32x32x16_bf16 v[80:95], a[200:203], a[40:43], v[80:95]
  ds_read_b64_tr_b16 a[192:193], v106 offset:8192
  ds_read_b64_tr_b16 a[194:195], v106 offset:8704
  buffer_load_dwordx4 v11, s[16:19], s62 offen offset:1024 lds
  v_mul_f32 v63, v71, v71
  v_fmamk_f32 v60, v60, 0xbdd2d3e8, v17
  v_fmamk_f32 v61, v61, 0xbdd2d3e8, v17
  v_fmamk_f32 v62, v62, 0xbdd2d3e8, v17
  v_mfma_f32_32x32x16_bf16 v[80:95], a[204:207], a[44:47], v[80:95]
  ds_read_b64_tr_b16 a[196:197], v106 offset:10240
  ds_read_b64_tr_b16 a[198:199], v106 offset:10752
  buffer_load_dwordx4 v12, s[16:19], s62 offen offset:2048 lds
  v_fmamk_f32 v63, v63, 0xbdd2d3e8, v17
  v_mul_f32 v60, v60, v68
  v_mul_f32 v61, v61, v69
  v_mul_f32 v62, v62, v70
  v_mul_f32 v63, v63, v71
  s_waitcnt lgkmcnt(4)
  v_mfma_f32_32x32x16_bf16 v[80:95], a[176:179], a[48:51], v[80:95]
  ds_read_b64_tr_b16 a[200:201], v106 offset:12288
  ds_read_b64_tr_b16 a[202:203], v106 offset:12800
  v_exp_f32 v60, v60
  v_exp_f32 v61, v61
  v_mfma_f32_32x32x16_bf16 v[80:95], a[180:183], a[52:55], v[80:95]
  ds_read_b64_tr_b16 a[204:205], v106 offset:14336
  ds_read_b64_tr_b16 a[206:207], v106 offset:14848
  s_add_u32 s62, s63, 3761152
  v_exp_f32 v62, v62
  v_exp_f32 v63, v63
  v_add_f32 v60, 1.0, v60
  v_mfma_f32_32x32x16_bf16 v[80:95], a[184:187], a[56:59], v[80:95]
  ds_read_b64_tr_b16 a[176:177], v106 offset:16384
  ds_read_b64_tr_b16 a[178:179], v106 offset:16896
  s_add_u32 m0, s61, 52224
  v_add_f32 v61, 1.0, v61
  v_add_f32 v62, 1.0, v62
  v_add_f32 v63, 1.0, v63
  v_rcp_f32 v60, v60
  v_mfma_f32_32x32x16_bf16 v[80:95], a[188:191], a[60:63], v[80:95]
  ds_read_b64_tr_b16 a[180:181], v106 offset:18432
  ds_read_b64_tr_b16 a[182:183], v106 offset:18944
  buffer_load_dwordx4 v10, s[16:19], s62 offen offset:0 lds
  v_rcp_f32 v61, v61
  v_rcp_f32 v62, v62
  s_waitcnt lgkmcnt(4)
  v_mfma_f32_32x32x16_bf16 v[80:95], a[192:195], a[64:67], v[80:95]
  ds_read_b64_tr_b16 a[184:185], v106 offset:20480
  ds_read_b64_tr_b16 a[186:187], v106 offset:20992
  buffer_load_dwordx4 v11, s[16:19], s62 offen offset:1024 lds
  v_rcp_f32 v63, v63
  v_mul_f32 v60, v60, v68
  v_mul_f32 v61, v61, v69
  v_mfma_f32_32x32x16_bf16 v[80:95], a[196:199], a[68:71], v[80:95]
  ds_read_b64_tr_b16 a[188:189], v106 offset:22528
  ds_read_b64_tr_b16 a[190:191], v106 offset:23040
  buffer_load_dwordx4 v12, s[16:19], s62 offen offset:2048 lds
  v_mul_f32 v62, v62, v70
  v_mul_f32 v63, v63, v71
  v_cvt_pk_bf16_f32 v210, v60, v61
  v_cvt_pk_bf16_f32 v211, v62, v63
  ds_write_b128 v110, v[208:211] offset:0
  v_mfma_f32_32x32x16_bf16 v[80:95], a[200:203], a[72:75], v[80:95]
  s_waitcnt vmcnt(18)
  s_barrier
  ds_read_b64_tr_b16 a[192:193], v106 offset:24576
  ds_read_b64_tr_b16 a[194:195], v106 offset:25088
  v_mul_f32 v56, v72, v72
  v_mul_f32 v57, v73, v73
  v_mul_f32 v58, v74, v74
  v_mul_f32 v59, v75, v75
  v_fmamk_f32 v56, v56, 0xbdd2d3e8, v17
  v_mfma_f32_32x32x16_bf16 v[80:95], a[204:207], a[76:79], v[80:95]
  ds_read_b64_tr_b16 a[196:197], v106 offset:26624
  ds_read_b64_tr_b16 a[198:199], v106 offset:27136
  s_mul_i32 s63, s45, 663552
  s_mul_i32 s62, s46, 55296
  s_add_u32 s63, s63, s62
  s_mul_i32 s61, s46, 6144
  v_fmamk_f32 v57, v57, 0xbdd2d3e8, v17
  v_fmamk_f32 v58, v58, 0xbdd2d3e8, v17
  v_fmamk_f32 v59, v59, 0xbdd2d3e8, v17
  v_mul_f32 v56, v56, v72
  s_waitcnt lgkmcnt(5)
  v_mfma_f32_32x32x16_bf16 v[80:95], a[176:179], a[80:83], v[80:95]
  ds_read_b64_tr_b16 a[200:201], v106 offset:28672
  ds_read_b64_tr_b16 a[202:203], v106 offset:29184
  s_add_u32 s62, s63, 0
  v_mul_f32 v57, v57, v73
  v_mul_f32 v58, v58, v74
  v_mul_f32 v59, v59, v75
  v_exp_f32 v56, v56
  v_mfma_f32_32x32x16_bf16 v[80:95], a[180:183], a[84:87], v[80:95]
  ds_read_b64_tr_b16 a[204:205], v106 offset:30720
  ds_read_b64_tr_b16 a[206:207], v106 offset:31232
  s_add_u32 m0, s61, 73728
  v_exp_f32 v57, v57
  v_exp_f32 v58, v58
  v_mfma_f32_32x32x16_bf16 v[80:95], a[184:187], a[88:91], v[80:95]
  ds_read_b64_tr_b16 a[176:177], v106 offset:32768
  ds_read_b64_tr_b16 a[178:179], v106 offset:33280
  buffer_load_dwordx4 v13, s[20:23], s62 offen offset:0 lds
  v_exp_f32 v59, v59
  v_add_f32 v56, 1.0, v56
  v_add_f32 v57, 1.0, v57
  v_add_f32 v58, 1.0, v58
  v_mfma_f32_32x32x16_bf16 v[80:95], a[188:191], a[92:95], v[80:95]
  ds_read_b64_tr_b16 a[180:181], v106 offset:34816
  ds_read_b64_tr_b16 a[182:183], v106 offset:35328
  buffer_load_dwordx4 v14, s[20:23], s62 offen offset:1024 lds
  v_add_f32 v59, 1.0, v59
  v_rcp_f32 v56, v56
  v_rcp_f32 v57, v57
  s_waitcnt lgkmcnt(4)
  v_mfma_f32_32x32x16_bf16 v[80:95], a[192:195], a[96:99], v[80:95]
  ds_read_b64_tr_b16 a[184:185], v106 offset:36864
  ds_read_b64_tr_b16 a[186:187], v106 offset:37376
  buffer_load_dwordx4 v15, s[20:23], s62 offen offset:2048 lds
  v_rcp_f32 v58, v58
  v_rcp_f32 v59, v59
  v_mfma_f32_32x32x16_bf16 v[80:95], a[196:199], a[100:103], v[80:95]
  ds_read_b64_tr_b16 a[188:189], v106 offset:38912
  ds_read_b64_tr_b16 a[190:191], v106 offset:39424
  s_add_u32 s62, s63, 27648
  v_mul_f32 v56, v56, v72
  v_mul_f32 v57, v57, v73
  v_mul_f32 v58, v58, v74
  v_mul_f32 v59, v59, v75
  v_mfma_f32_32x32x16_bf16 v[80:95], a[200:203], a[104:107], v[80:95]
  ds_read_b64_tr_b16 a[192:193], v106 offset:40960
  ds_read_b64_tr_b16 a[194:195], v106 offset:41472
  s_add_u32 m0, s61, 76800
  v_cvt_pk_bf16_f32 v212, v56, v57
  v_cvt_pk_bf16_f32 v213, v58, v59
  v_mul_f32 v60, v76, v76
  v_mul_f32 v61, v77, v77
  v_mul_f32 v62, v78, v78
  v_mfma_f32_32x32x16_bf16 v[80:95], a[204:207], a[108:111], v[80:95]
  ds_read_b64_tr_b16 a[196:197], v106 offset:43008
  ds_read_b64_tr_b16 a[198:199], v106 offset:43520
  buffer_load_dwordx4 v13, s[20:23], s62 offen offset:0 lds
  v_mul_f32 v63, v79, v79
  v_fmamk_f32 v60, v60, 0xbdd2d3e8, v17
  v_fmamk_f32 v61, v61, 0xbdd2d3e8, v17
  v_fmamk_f32 v62, v62, 0xbdd2d3e8, v17
  s_waitcnt lgkmcnt(4)
  v_mfma_f32_32x32x16_bf16 v[80:95], a[176:179], a[112:115], v[80:95]
  ds_read_b64_tr_b16 a[200:201], v106 offset:45056
  ds_read_b64_tr_b16 a[202:203], v106 offset:45568
  buffer_load_dwordx4 v14, s[20:23], s62 offen offset:1024 lds
  v_fmamk_f32 v63, v63, 0xbdd2d3e8, v17
  v_mul_f32 v60, v60, v76
  v_mul_f32 v61, v61, v77
  v_mul_f32 v62, v62, v78
  v_mul_f32 v63, v63, v79
  v_mfma_f32_32x32x16_bf16 v[80:95], a[180:183], a[116:119], v[80:95]
  ds_read_b64_tr_b16 a[204:205], v106 offset:47104
  ds_read_b64_tr_b16 a[206:207], v106 offset:47616
  buffer_load_dwordx4 v15, s[20:23], s62 offen offset:2048 lds
  v_exp_f32 v60, v60
  v_exp_f32 v61, v61
  v_mfma_f32_32x32x16_bf16 v[80:95], a[184:187], a[120:123], v[80:95]
  s_waitcnt vmcnt(18)
  s_barrier
  ds_read_b64_tr_b16 a[176:177], v104 offset:0
  ds_read_b64_tr_b16 a[178:179], v104 offset:512
  v_exp_f32 v62, v62
  v_exp_f32 v63, v63
  v_add_f32 v60, 1.0, v60
  v_mfma_f32_32x32x16_bf16 v[80:95], a[188:191], a[124:127], v[80:95]
  ds_read_b64_tr_b16 a[180:181], v104 offset:2048
  ds_read_b64_tr_b16 a[182:183], v104 offset:2560
  s_add_u32 s62, s63, 221184
  v_add_f32 v61, 1.0, v61
  v_add_f32 v62, 1.0, v62
  v_add_f32 v63, 1.0, v63
  v_rcp_f32 v60, v60
  s_waitcnt lgkmcnt(4)
  v_mfma_f32_32x32x16_bf16 v[80:95], a[192:195], a[128:131], v[80:95]
  ds_read_b64_tr_b16 a[184:185], v104 offset:4096
  ds_read_b64_tr_b16 a[186:187], v104 offset:4608
  s_add_u32 m0, s61, 98304
  v_rcp_f32 v61, v61
  v_rcp_f32 v62, v62
  v_mfma_f32_32x32x16_bf16 v[80:95], a[196:199], a[132:135], v[80:95]
  ds_read_b64_tr_b16 a[188:189], v104 offset:6144
  ds_read_b64_tr_b16 a[190:191], v104 offset:6656
  v_rcp_f32 v63, v63
  v_mul_f32 v60, v60, v76
  v_mul_f32 v61, v61, v77
  v_mfma_f32_32x32x16_bf16 v[80:95], a[200:203], a[136:139], v[80:95]
  ds_read_b64_tr_b16 a[192:193], v104 offset:8192
  ds_read_b64_tr_b16 a[194:195], v104 offset:8704
  buffer_load_dwordx4 v13, s[20:23], s62 offen offset:0 lds
  v_mul_f32 v62, v62, v78
  v_mul_f32 v63, v63, v79
  v_cvt_pk_bf16_f32 v214, v60, v61
  v_cvt_pk_bf16_f32 v215, v62, v63
  ds_write_b128 v110, v[212:215] offset:1024
  v_mfma_f32_32x32x16_bf16 v[80:95], a[204:207], a[140:143], v[80:95]
  ds_read_b64_tr_b16 a[196:197], v104 offset:10240
  ds_read_b64_tr_b16 a[198:199], v104 offset:10752
  buffer_load_dwordx4 v14, s[20:23], s62 offen offset:1024 lds
  v_mfma_f32_32x32x16_bf16 v[64:79], a[160:163], a[164:167], 0
  buffer_load_dwordx4 v15, s[20:23], s62 offen offset:2048 lds
  s_waitcnt lgkmcnt(5)
  v_mfma_f32_32x32x16_bf16 v[64:79], a[176:179], a[0:3], v[64:79]
  ds_read_b64_tr_b16 a[200:201], v104 offset:12288
  ds_read_b64_tr_b16 a[202:203], v104 offset:12800
  s_add_u32 s62, s63, 248832
  v_mfma_f32_32x32x16_bf16 v[64:79], a[180:183], a[4:7], v[64:79]
  ds_read_b64_tr_b16 a[204:205], v104 offset:14336
  ds_read_b64_tr_b16 a[206:207], v104 offset:14848
  s_add_u32 m0, s61, 101376
  v_mul_f32 v56, v80, v80
  v_mul_f32 v57, v81, v81
  v_mul_f32 v58, v82, v82
  v_mul_f32 v59, v83, v83
  v_fmamk_f32 v56, v56, 0xbdd2d3e8, v17
  v_mfma_f32_32x32x16_bf16 v[64:79], a[184:187], a[8:11], v[64:79]
  ds_read_b64_tr_b16 a[176:177], v104 offset:16384
  ds_read_b64_tr_b16 a[178:179], v104 offset:16896
  v_fmamk_f32 v57, v57, 0xbdd2d3e8, v17
  v_fmamk_f32 v58, v58, 0xbdd2d3e8, v17
  v_fmamk_f32 v59, v59, 0xbdd2d3e8, v17
  v_mul_f32 v56, v56, v80
  v_mfma_f32_32x32x16_bf16 v[64:79], a[188:191], a[12:15], v[64:79]
  ds_read_b64_tr_b16 a[180:181], v104 offset:18432
  ds_read_b64_tr_b16 a[182:183], v104 offset:18944
  buffer_load_dwordx4 v13, s[20:23], s62 offen offset:0 lds
  v_mul_f32 v57, v57, v81
  v_mul_f32 v58, v58, v82
  v_mul_f32 v59, v59, v83
  v_exp_f32 v56, v56
  s_waitcnt lgkmcnt(4)
  v_mfma_f32_32x32x16_bf16 v[64:79], a[192:195], a[16:19], v[64:79]
  ds_read_b64_tr_b16 a[184:185], v104 offset:20480
  ds_read_b64_tr_b16 a[186:187], v104 offset:20992
  buffer_load_dwordx4 v14, s[20:23], s62 offen offset:1024 lds
  v_exp_f32 v57, v57
  v_exp_f32 v58, v58
  v_mfma_f32_32x32x16_bf16 v[64:79], a[196:199], a[20:23], v[64:79]
  ds_read_b64_tr_b16 a[188:189], v104 offset:22528
  ds_read_b64_tr_b16 a[190:191], v104 offset:23040
  buffer_load_dwordx4 v15, s[20:23], s62 offen offset:2048 lds
  v_exp_f32 v59, v59
  v_add_f32 v56, 1.0, v56
  v_add_f32 v57, 1.0, v57
  v_add_f32 v58, 1.0, v58
  v_mfma_f32_32x32x16_bf16 v[64:79], a[200:203], a[24:27], v[64:79]
  s_waitcnt vmcnt(18)
  s_barrier
  ds_read_b64_tr_b16 a[192:193], v104 offset:24576
  ds_read_b64_tr_b16 a[194:195], v104 offset:25088
  v_add_f32 v59, 1.0, v59
  v_rcp_f32 v56, v56
  v_rcp_f32 v57, v57
  v_mfma_f32_32x32x16_bf16 v[64:79], a[204:207], a[28:31], v[64:79]
  ds_read_b64_tr_b16 a[196:197], v104 offset:26624
  ds_read_b64_tr_b16 a[198:199], v104 offset:27136
  s_add_u32 s62, s63, 442368
  ds_read_b128 v[216:219], v111 offset:0
  ds_read_b128 v[220:223], v111 offset:1024
  v_rcp_f32 v58, v58
  v_rcp_f32 v59, v59
  s_waitcnt lgkmcnt(6)
  v_mfma_f32_32x32x16_bf16 v[64:79], a[176:179], a[32:35], v[64:79]
  ds_read_b64_tr_b16 a[200:201], v104 offset:28672
  ds_read_b64_tr_b16 a[202:203], v104 offset:29184
  s_add_u32 m0, s61, 122880
  v_mul_f32 v56, v56, v80
  v_mul_f32 v57, v57, v81
  v_mul_f32 v58, v58, v82
  v_mul_f32 v59, v59, v83
  v_mfma_f32_32x32x16_bf16 v[64:79], a[180:183], a[36:39], v[64:79]
  ds_read_b64_tr_b16 a[204:205], v104 offset:30720
  ds_read_b64_tr_b16 a[206:207], v104 offset:31232
  buffer_load_dwordx4 v13, s[20:23], s62 offen offset:0 lds
  v_cvt_pk_bf16_f32 v224, v56, v57
  v_cvt_pk_bf16_f32 v225, v58, v59
  v_mul_f32 v60, v84, v84
  v_mul_f32 v61, v85, v85
  v_mul_f32 v62, v86, v86
  v_mfma_f32_32x32x16_bf16 v[64:79], a[184:187], a[40:43], v[64:79]
  ds_read_b64_tr_b16 a[176:177], v104 offset:32768
  ds_read_b64_tr_b16 a[178:179], v104 offset:33280
  buffer_load_dwordx4 v14, s[20:23], s62 offen offset:1024 lds
  v_mul_f32 v63, v87, v87
  v_fmamk_f32 v60, v60, 0xbdd2d3e8, v17
  v_fmamk_f32 v61, v61, 0xbdd2d3e8, v17
  v_fmamk_f32 v62, v62, 0xbdd2d3e8, v17
  v_mfma_f32_32x32x16_bf16 v[64:79], a[188:191], a[44:47], v[64:79]
  ds_read_b64_tr_b16 a[180:181], v104 offset:34816
  ds_read_b64_tr_b16 a[182:183], v104 offset:35328
  buffer_load_dwordx4 v15, s[20:23], s62 offen offset:2048 lds
  v_fmamk_f32 v63, v63, 0xbdd2d3e8, v17
  v_mul_f32 v60, v60, v84
  v_mul_f32 v61, v61, v85
  v_mul_f32 v62, v62, v86
  v_mul_f32 v63, v63, v87
  s_waitcnt lgkmcnt(4)
  v_mfma_f32_32x32x16_bf16 v[64:79], a[192:195], a[48:51], v[64:79]
  ds_read_b64_tr_b16 a[184:185], v104 offset:36864
  ds_read_b64_tr_b16 a[186:187], v104 offset:37376
  v_add_u32 v98, s58, v104
  v_add_u32 v101, s59, v104
  v_add_u32 v99, s58, v105
  v_add_u32 v102, s59, v105
  v_add_u32 v100, s58, v106
  v_add_u32 v103, s59, v106
  v_exp_f32 v60, v60
  v_exp_f32 v61, v61
  v_mfma_f32_32x32x16_bf16 v[64:79], a[196:199], a[52:55], v[64:79]
  ds_read_b64_tr_b16 a[188:189], v104 offset:38912
  ds_read_b64_tr_b16 a[190:191], v104 offset:39424
  s_add_u32 s62, s63, 470016
  v_exp_f32 v62, v62
  v_exp_f32 v63, v63
  v_add_f32 v60, 1.0, v60
  v_mfma_f32_32x32x16_bf16 v[64:79], a[200:203], a[56:59], v[64:79]
  ds_read_b64_tr_b16 a[192:193], v104 offset:40960
  ds_read_b64_tr_b16 a[194:195], v104 offset:41472
  s_add_u32 m0, s61, 125952
  v_add_f32 v61, 1.0, v61
  v_add_f32 v62, 1.0, v62
  v_add_f32 v63, 1.0, v63
  v_rcp_f32 v60, v60
  v_mfma_f32_32x32x16_bf16 v[64:79], a[204:207], a[60:63], v[64:79]
  ds_read_b64_tr_b16 a[196:197], v104 offset:43008
  ds_read_b64_tr_b16 a[198:199], v104 offset:43520
  buffer_load_dwordx4 v13, s[20:23], s62 offen offset:0 lds
  v_rcp_f32 v61, v61
  v_rcp_f32 v62, v62
  s_waitcnt lgkmcnt(4)
  v_mfma_f32_32x32x16_bf16 v[64:79], a[176:179], a[64:67], v[64:79]
  ds_read_b64_tr_b16 a[200:201], v104 offset:45056
  ds_read_b64_tr_b16 a[202:203], v104 offset:45568
  buffer_load_dwordx4 v14, s[20:23], s62 offen offset:1024 lds
  v_rcp_f32 v63, v63
  v_mul_f32 v60, v60, v84
  v_mul_f32 v61, v61, v85
  v_mfma_f32_32x32x16_bf16 v[64:79], a[180:183], a[68:71], v[64:79]
  ds_read_b64_tr_b16 a[204:205], v104 offset:47104
  ds_read_b64_tr_b16 a[206:207], v104 offset:47616
  buffer_load_dwordx4 v15, s[20:23], s62 offen offset:2048 lds
  v_mul_f32 v62, v62, v86
  v_mul_f32 v63, v63, v87
  v_cvt_pk_bf16_f32 v226, v60, v61
  v_cvt_pk_bf16_f32 v227, v62, v63
  ds_write_b128 v110, v[224:227] offset:8192
  v_mfma_f32_32x32x16_bf16 v[64:79], a[184:187], a[72:75], v[64:79]
  s_waitcnt vmcnt(18)
  s_barrier
  ds_read_b64_tr_b16 a[176:177], v105 offset:0
  ds_read_b64_tr_b16 a[178:179], v105 offset:512
  v_mul_f32 v56, v88, v88
  v_mul_f32 v57, v89, v89
  v_mul_f32 v58, v90, v90
  v_mul_f32 v59, v91, v91
  v_fmamk_f32 v56, v56, 0xbdd2d3e8, v17
  v_mfma_f32_32x32x16_bf16 v[64:79], a[188:191], a[76:79], v[64:79]
  ds_read_b64_tr_b16 a[180:181], v105 offset:2048
  ds_read_b64_tr_b16 a[182:183], v105 offset:2560
  s_add_u32 s62, s63, 128
  v_fmamk_f32 v57, v57, 0xbdd2d3e8, v17
  v_fmamk_f32 v58, v58, 0xbdd2d3e8, v17
  v_fmamk_f32 v59, v59, 0xbdd2d3e8, v17
  v_mul_f32 v56, v56, v88
  s_waitcnt lgkmcnt(5)
  v_mfma_f32_32x32x16_bf16 v[64:79], a[192:195], a[80:83], v[64:79]
  ds_read_b64_tr_b16 a[184:185], v105 offset:4096
  ds_read_b64_tr_b16 a[186:187], v105 offset:4608
  s_add_u32 m0, s61, 0
  v_mul_f32 v57, v57, v89
  v_mul_f32 v58, v58, v90
  v_mul_f32 v59, v59, v91
  v_exp_f32 v56, v56
  v_mfma_f32_32x32x16_bf16 v[64:79], a[196:199], a[84:87], v[64:79]
  ds_read_b64_tr_b16 a[188:189], v105 offset:6144
  ds_read_b64_tr_b16 a[190:191], v105 offset:6656
  buffer_load_dwordx4 v13, s[20:23], s62 offen offset:0 lds
  v_exp_f32 v57, v57
  v_exp_f32 v58, v58
  v_mfma_f32_32x32x16_bf16 v[64:79], a[200:203], a[88:91], v[64:79]
  ds_read_b64_tr_b16 a[192:193], v105 offset:8192
  ds_read_b64_tr_b16 a[194:195], v105 offset:8704
  buffer_load_dwordx4 v14, s[20:23], s62 offen offset:1024 lds
  v_exp_f32 v59, v59
  v_add_f32 v56, 1.0, v56
  v_add_f32 v57, 1.0, v57
  v_add_f32 v58, 1.0, v58
  v_mfma_f32_32x32x16_bf16 v[64:79], a[204:207], a[92:95], v[64:79]
  ds_read_b64_tr_b16 a[196:197], v105 offset:10240
  ds_read_b64_tr_b16 a[198:199], v105 offset:10752
  buffer_load_dwordx4 v15, s[20:23], s62 offen offset:2048 lds
  v_add_f32 v59, 1.0, v59
  v_rcp_f32 v56, v56
  v_rcp_f32 v57, v57
  s_waitcnt lgkmcnt(4)
  v_mfma_f32_32x32x16_bf16 v[64:79], a[176:179], a[96:99], v[64:79]
  ds_read_b64_tr_b16 a[200:201], v105 offset:12288
  ds_read_b64_tr_b16 a[202:203], v105 offset:12800
  v_rcp_f32 v58, v58
  v_rcp_f32 v59, v59
  v_mfma_f32_32x32x16_bf16 v[64:79], a[180:183], a[100:103], v[64:79]
  ds_read_b64_tr_b16 a[204:205], v105 offset:14336
  ds_read_b64_tr_b16 a[206:207], v105 offset:14848
  s_add_u32 s62, s63, 27776
  v_mul_f32 v56, v56, v88
  v_mul_f32 v57, v57, v89
  v_mul_f32 v58, v58, v90
  v_mul_f32 v59, v59, v91
  v_mfma_f32_32x32x16_bf16 v[64:79], a[184:187], a[104:107], v[64:79]
  ds_read_b64_tr_b16 a[176:177], v105 offset:16384
  ds_read_b64_tr_b16 a[178:179], v105 offset:16896
  s_add_u32 m0, s61, 3072
  v_cvt_pk_bf16_f32 v228, v56, v57
  v_cvt_pk_bf16_f32 v229, v58, v59
  v_mul_f32 v60, v92, v92
  v_mul_f32 v61, v93, v93
  v_mul_f32 v62, v94, v94
  v_mfma_f32_32x32x16_bf16 v[64:79], a[188:191], a[108:111], v[64:79]
  ds_read_b64_tr_b16 a[180:181], v105 offset:18432
  ds_read_b64_tr_b16 a[182:183], v105 offset:18944
  buffer_load_dwordx4 v13, s[20:23], s62 offen offset:0 lds
  v_mul_f32 v63, v95, v95
  v_fmamk_f32 v60, v60, 0xbdd2d3e8, v17
  v_fmamk_f32 v61, v61, 0xbdd2d3e8, v17
  v_fmamk_f32 v62, v62, 0xbdd2d3e8, v17
  s_waitcnt lgkmcnt(4)
  v_mfma_f32_32x32x16_bf16 v[64:79], a[192:195], a[112:115], v[64:79]
  ds_read_b64_tr_b16 a[184:185], v105 offset:20480
  ds_read_b64_tr_b16 a[186:187], v105 offset:20992
  buffer_load_dwordx4 v14, s[20:23], s62 offen offset:1024 lds
  v_fmamk_f32 v63, v63, 0xbdd2d3e8, v17
  v_mul_f32 v60, v60, v92
  v_mul_f32 v61, v61, v93
  v_mul_f32 v62, v62, v94
  v_mul_f32 v63, v63, v95
  v_mfma_f32_32x32x16_bf16 v[64:79], a[196:199], a[116:119], v[64:79]
  ds_read_b64_tr_b16 a[188:189], v105 offset:22528
  ds_read_b64_tr_b16 a[190:191], v105 offset:23040
  buffer_load_dwordx4 v15, s[20:23], s62 offen offset:2048 lds
  v_exp_f32 v60, v60
  v_exp_f32 v61, v61
  v_mfma_f32_32x32x16_bf16 v[64:79], a[200:203], a[120:123], v[64:79]
  s_waitcnt vmcnt(18)
  s_barrier
  ds_read_b64_tr_b16 a[192:193], v99 offset:24576
  ds_read_b64_tr_b16 a[194:195], v99 offset:25088
  v_exp_f32 v62, v62
  v_exp_f32 v63, v63
  v_add_f32 v60, 1.0, v60
  v_mfma_f32_32x32x16_bf16 v[64:79], a[204:207], a[124:127], v[64:79]
  ds_read_b64_tr_b16 a[196:197], v99 offset:26624
  ds_read_b64_tr_b16 a[198:199], v99 offset:27136
  s_add_u32 s62, s63, 221312
  v_add_f32 v61, 1.0, v61
  v_add_f32 v62, 1.0, v62
  v_add_f32 v63, 1.0, v63
  v_rcp_f32 v60, v60
  s_waitcnt lgkmcnt(4)
  v_mfma_f32_32x32x16_bf16 v[64:79], a[176:179], a[128:131], v[64:79]
  ds_read_b64_tr_b16 a[200:201], v102 offset:24576
  ds_read_b64_tr_b16 a[202:203], v102 offset:25088
  s_add_u32 m0, s61, 24576
  v_rcp_f32 v61, v61
  v_rcp_f32 v62, v62
  v_mfma_f32_32x32x16_bf16 v[64:79], a[180:183], a[132:135], v[64:79]
  ds_read_b64_tr_b16 a[204:205], v102 offset:26624
  ds_read_b64_tr_b16 a[206:207], v102 offset:27136
  buffer_load_dwordx4 v13, s[20:23], s62 offen offset:0 lds
  v_rcp_f32 v63, v63
  v_mul_f32 v60, v60, v92
  v_mul_f32 v61, v61, v93
  v_mfma_f32_32x32x16_bf16 v[64:79], a[184:187], a[136:139], v[64:79]
  ds_read_b64_tr_b16 a[176:177], v99 offset:32768
  ds_read_b64_tr_b16 a[178:179], v99 offset:33280
  buffer_load_dwordx4 v14, s[20:23], s62 offen offset:1024 lds
  v_mul_f32 v62, v62, v94
  v_mul_f32 v63, v63, v95
  v_cvt_pk_bf16_f32 v230, v60, v61
  v_cvt_pk_bf16_f32 v231, v62, v63
  ds_write_b128 v110, v[228:231] offset:9216
  v_mfma_f32_32x32x16_bf16 v[64:79], a[188:191], a[140:143], v[64:79]
  ds_read_b64_tr_b16 a[180:181], v99 offset:34816
  ds_read_b64_tr_b16 a[182:183], v99 offset:35328
  buffer_load_dwordx4 v15, s[20:23], s62 offen offset:2048 lds
  s_waitcnt lgkmcnt(5)
  v_mfma_f32_32x32x16_bf16 v[80:95], a[192:195], v[112:115], 0
  ds_read_b64_tr_b16 a[184:185], v102 offset:32768
  ds_read_b64_tr_b16 a[186:187], v102 offset:33280
  v_mfma_f32_32x32x16_bf16 v[80:95], a[196:199], v[116:119], v[80:95]
  ds_read_b64_tr_b16 a[188:189], v102 offset:34816
  ds_read_b64_tr_b16 a[190:191], v102 offset:35328
  s_add_u32 s62, s63, 248960
  s_nop 0
  v_mul_f32 v56, v64, v64
  v_mul_f32 v57, v65, v65
  v_mul_f32 v58, v66, v66
  v_mul_f32 v59, v67, v67
  v_fmamk_f32 v56, v56, 0xbdd2d3e8, v17
  v_mfma_f32_32x32x16_bf16 v[80:95], a[200:203], v[120:123], v[80:95]
  ds_read_b64_tr_b16 a[192:193], v99 offset:40960
  ds_read_b64_tr_b16 a[194:195], v99 offset:41472
  s_add_u32 m0, s61, 27648
  v_fmamk_f32 v57, v57, 0xbdd2d3e8, v17
  v_fmamk_f32 v58, v58, 0xbdd2d3e8, v17
  v_fmamk_f32 v59, v59, 0xbdd2d3e8, v17
  v_mul_f32 v56, v56, v64
  v_mul_f32 v57, v57, v65
  v_mul_f32 v58, v58, v66
  v_mfma_f32_32x32x16_bf16 v[80:95], a[204:207], v[124:127], v[80:95]
  ds_read_b64_tr_b16 a[196:197], v99 offset:43008
  ds_read_b64_tr_b16 a[198:199], v99 offset:43520
  buffer_load_dwordx4 v13, s[20:23], s62 offen offset:0 lds
  v_mul_f32 v59, v59, v67
  v_exp_f32 v56, v56
  v_exp_f32 v57, v57
  s_waitcnt lgkmcnt(4)
  v_mfma_f32_32x32x16_bf16 v[80:95], a[176:179], v[128:131], v[80:95]
  ds_read_b64_tr_b16 a[200:201], v102 offset:40960
  ds_read_b64_tr_b16 a[202:203], v102 offset:41472
  buffer_load_dwordx4 v14, s[20:23], s62 offen offset:1024 lds
  v_exp_f32 v58, v58
  v_exp_f32 v59, v59
  v_add_f32 v56, 1.0, v56
  v_add_f32 v57, 1.0, v57
  v_mfma_f32_32x32x16_bf16 v[80:95], a[180:183], v[132:135], v[80:95]
  ds_read_b64_tr_b16 a[204:205], v102 offset:43008
  ds_read_b64_tr_b16 a[206:207], v102 offset:43520
  buffer_load_dwordx4 v15, s[20:23], s62 offen offset:2048 lds
  v_add_f32 v58, 1.0, v58
  v_add_f32 v59, 1.0, v59
  v_rcp_f32 v56, v56
  v_rcp_f32 v57, v57
  v_mfma_f32_32x32x16_bf16 v[80:95], a[184:187], v[136:139], v[80:95]
  s_waitcnt vmcnt(18)
  s_barrier
  ds_read_b64_tr_b16 a[176:177], v100 offset:0
  ds_read_b64_tr_b16 a[178:179], v100 offset:512
  v_rcp_f32 v58, v58
  v_rcp_f32 v59, v59
  v_mul_f32 v56, v56, v64
  v_mfma_f32_32x32x16_bf16 v[80:95], a[188:191], v[140:143], v[80:95]
  ds_read_b64_tr_b16 a[180:181], v100 offset:2048
  ds_read_b64_tr_b16 a[182:183], v100 offset:2560
  s_add_u32 s62, s63, 442496
  ds_read_b128 v[232:235], v111 offset:8192
  ds_read_b128 v[236:239], v111 offset:9216
  v_mul_f32 v57, v57, v65
  v_mul_f32 v58, v58, v66
  v_mul_f32 v59, v59, v67
  v_cvt_pk_bf16_f32 v240, v56, v57
  v_cvt_pk_bf16_f32 v241, v58, v59
  s_waitcnt lgkmcnt(6)
  v_mfma_f32_32x32x16_bf16 v[80:95], a[192:195], v[144:147], v[80:95]
  ds_read_b64_tr_b16 a[184:185], v103 offset:0
  ds_read_b64_tr_b16 a[186:187], v103 offset:512
  s_add_u32 m0, s61, 49152
  v_mul_f32 v60, v68, v68
  v_mul_f32 v61, v69, v69
  v_mul_f32 v62, v70, v70
  v_mul_f32 v63, v71, v71
  v_fmamk_f32 v60, v60, 0xbdd2d3e8, v17
  v_fmamk_f32 v61, v61, 0xbdd2d3e8, v17
  v_mfma_f32_32x32x16_bf16 v[80:95], a[196:199], v[148:151], v[80:95]
  ds_read_b64_tr_b16 a[188:189], v103 offset:2048
  ds_read_b64_tr_b16 a[190:191], v103 offset:2560
  buffer_load_dwordx4 v13, s[20:23], s62 offen offset:0 lds
  v_fmamk_f32 v62, v62, 0xbdd2d3e8, v17
  v_fmamk_f32 v63, v63, 0xbdd2d3e8, v17
  v_mul_f32 v60, v60, v68
  v_mul_f32 v61, v61, v69
  v_mul_f32 v62, v62, v70
  v_mfma_f32_32x32x16_bf16 v[80:95], a[200:203], v[152:155], v[80:95]
  ds_read_b64_tr_b16 a[192:193], v100 offset:8192
  ds_read_b64_tr_b16 a[194:195], v100 offset:8704
  buffer_load_dwordx4 v14, s[20:23], s62 offen offset:1024 lds
  v_mul_f32 v63, v63, v71
  v_exp_f32 v60, v60
  v_exp_f32 v61, v61
  v_mfma_f32_32x32x16_bf16 v[80:95], a[204:207], v[156:159], v[80:95]
  ds_read_b64_tr_b16 a[196:197], v100 offset:10240
  ds_read_b64_tr_b16 a[198:199], v100 offset:10752
  buffer_load_dwordx4 v15, s[20:23], s62 offen offset:2048 lds
  v_exp_f32 v62, v62
  v_exp_f32 v63, v63
  v_add_f32 v60, 1.0, v60
  v_add_f32 v61, 1.0, v61
  s_waitcnt lgkmcnt(4)
  v_mfma_f32_32x32x16_bf16 v[80:95], a[176:179], v[160:163], v[80:95]
  ds_read_b64_tr_b16 a[200:201], v103 offset:8192
  ds_read_b64_tr_b16 a[202:203], v103 offset:8704
  v_add_f32 v62, 1.0, v62
  v_add_f32 v63, 1.0, v63
  v_rcp_f32 v60, v60
  v_rcp_f32 v61, v61
  v_mfma_f32_32x32x16_bf16 v[80:95], a[180:183], v[164:167], v[80:95]
  ds_read_b64_tr_b16 a[204:205], v103 offset:10240
  ds_read_b64_tr_b16 a[206:207], v103 offset:10752
  s_add_u32 s62, s63, 470144
  v_rcp_f32 v62, v62
  v_rcp_f32 v63, v63
  v_mul_f32 v60, v60, v68
  v_mfma_f32_32x32x16_bf16 v[80:95], a[184:187], v[168:171], v[80:95]
  ds_read_b64_tr_b16 a[176:177], v100 offset:16384
  ds_read_b64_tr_b16 a[178:179], v100 offset:16896
  s_add_u32 m0, s61, 52224
  v_mul_f32 v61, v61, v69
  v_mul_f32 v62, v62, v70
  v_mul_f32 v63, v63, v71
  v_cvt_pk_bf16_f32 v242, v60, v61
  v_cvt_pk_bf16_f32 v243, v62, v63
  ds_write_b128 v110, v[240:243] offset:0
  v_mfma_f32_32x32x16_bf16 v[80:95], a[188:191], v[172:175], v[80:95]
  ds_read_b64_tr_b16 a[180:181], v100 offset:18432
  ds_read_b64_tr_b16 a[182:183], v100 offset:18944
  buffer_load_dwordx4 v13, s[20:23], s62 offen offset:0 lds
  v_mul_f32 v56, v72, v72
  v_mul_f32 v57, v73, v73
  v_mul_f32 v58, v74, v74
  v_mul_f32 v59, v75, v75
  v_fmamk_f32 v56, v56, 0xbdd2d3e8, v17
  s_waitcnt lgkmcnt(5)
  v_mfma_f32_32x32x16_bf16 v[80:95], a[192:195], v[176:179], v[80:95]
  ds_read_b64_tr_b16 a[184:185], v103 offset:16384
  ds_read_b64_tr_b16 a[186:187], v103 offset:16896
  buffer_load_dwordx4 v14, s[20:23], s62 offen offset:1024 lds
  v_fmamk_f32 v57, v57, 0xbdd2d3e8, v17
  v_fmamk_f32 v58, v58, 0xbdd2d3e8, v17
  v_fmamk_f32 v59, v59, 0xbdd2d3e8, v17
  v_mul_f32 v56, v56, v72
  v_mul_f32 v57, v57, v73
  v_mul_f32 v58, v58, v74
  v_mfma_f32_32x32x16_bf16 v[80:95], a[196:199], v[180:183], v[80:95]
  ds_read_b64_tr_b16 a[188:189], v103 offset:18432
  ds_read_b64_tr_b16 a[190:191], v103 offset:18944
  buffer_load_dwordx4 v15, s[20:23], s62 offen offset:2048 lds
  v_mul_f32 v59, v59, v75
  v_exp_f32 v56, v56
  v_exp_f32 v57, v57
  v_mfma_f32_32x32x16_bf16 v[80:95], a[200:203], v[184:187], v[80:95]
  s_waitcnt vmcnt(18)
  s_barrier
  ds_read_b64_tr_b16 a[192:193], v100 offset:24576
  ds_read_b64_tr_b16 a[194:195], v100 offset:25088
  v_exp_f32 v58, v58
  v_exp_f32 v59, v59
  v_add_f32 v56, 1.0, v56
  v_add_f32 v57, 1.0, v57
  v_mfma_f32_32x32x16_bf16 v[80:95], a[204:207], v[188:191], v[80:95]
  ds_read_b64_tr_b16 a[196:197], v100 offset:26624
  ds_read_b64_tr_b16 a[198:199], v100 offset:27136
  s_add_u32 s62, s63, 256
  v_add_f32 v58, 1.0, v58
  v_add_f32 v59, 1.0, v59
  v_rcp_f32 v56, v56
  v_rcp_f32 v57, v57
  s_waitcnt lgkmcnt(4)
  v_mfma_f32_32x32x16_bf16 v[80:95], a[176:179], v[192:195], v[80:95]
  ds_read_b64_tr_b16 a[200:201], v103 offset:24576
  ds_read_b64_tr_b16 a[202:203], v103 offset:25088
  s_add_u32 m0, s61, 73728
  v_rcp_f32 v58, v58
  v_rcp_f32 v59, v59
  v_mul_f32 v56, v56, v72
  v_mfma_f32_32x32x16_bf16 v[80:95], a[180:183], v[196:199], v[80:95]
  ds_read_b64_tr_b16 a[204:205], v103 offset:26624
  ds_read_b64_tr_b16 a[206:207], v103 offset:27136
  buffer_load_dwordx4 v13, s[20:23], s62 offen offset:0 lds
  v_mul_f32 v57, v57, v73
  v_mul_f32 v58, v58, v74
  v_mul_f32 v59, v59, v75
  v_cvt_pk_bf16_f32 v244, v56, v57
  v_cvt_pk_bf16_f32 v245, v58, v59
  v_mfma_f32_32x32x16_bf16 v[80:95], a[184:187], v[200:203], v[80:95]
  ds_read_b64_tr_b16 a[176:177], v100 offset:32768
  ds_read_b64_tr_b16 a[178:179], v100 offset:33280
  buffer_load_dwordx4 v14, s[20:23], s62 offen offset:1024 lds
  v_mul_f32 v60, v76, v76
  v_mul_f32 v61, v77, v77
  v_mul_f32 v62, v78, v78
  v_mul_f32 v63, v79, v79
  v_fmamk_f32 v60, v60, 0xbdd2d3e8, v17
  v_fmamk_f32 v61, v61, 0xbdd2d3e8, v17
  v_mfma_f32_32x32x16_bf16 v[80:95], a[188:191], v[204:207], v[80:95]
  ds_read_b64_tr_b16 a[180:181], v100 offset:34816
  ds_read_b64_tr_b16 a[182:183], v100 offset:35328
  buffer_load_dwordx4 v15, s[20:23], s62 offen offset:2048 lds
  v_fmamk_f32 v62, v62, 0xbdd2d3e8, v17
  v_fmamk_f32 v63, v63, 0xbdd2d3e8, v17
  v_mul_f32 v60, v60, v76
  v_mul_f32 v61, v61, v77
  v_mul_f32 v62, v62, v78
  s_waitcnt lgkmcnt(4)
  v_mfma_f32_32x32x16_bf16 v[80:95], a[192:195], v[208:211], v[80:95]
  ds_read_b64_tr_b16 a[184:185], v103 offset:32768
  ds_read_b64_tr_b16 a[186:187], v103 offset:33280
  v_mul_f32 v63, v63, v79
  v_exp_f32 v60, v60
  v_exp_f32 v61, v61
  v_mfma_f32_32x32x16_bf16 v[80:95], a[196:199], v[212:215], v[80:95]
  ds_read_b64_tr_b16 a[188:189], v103 offset:34816
  ds_read_b64_tr_b16 a[190:191], v103 offset:35328
  s_add_u32 s62, s63, 27904
  v_exp_f32 v62, v62
  v_exp_f32 v63, v63
  v_add_f32 v60, 1.0, v60
  v_add_f32 v61, 1.0, v61
  v_mfma_f32_32x32x16_bf16 v[80:95], a[200:203], v[216:219], v[80:95]
  ds_read_b64_tr_b16 a[192:193], v100 offset:40960
  ds_read_b64_tr_b16 a[194:195], v100 offset:41472
  s_add_u32 m0, s61, 76800
  v_add_f32 v62, 1.0, v62
  v_add_f32 v63, 1.0, v63
  v_rcp_f32 v60, v60
  v_rcp_f32 v61, v61
  v_mfma_f32_32x32x16_bf16 v[80:95], a[204:207], v[220:223], v[80:95]
  ds_read_b64_tr_b16 a[196:197], v100 offset:43008
  ds_read_b64_tr_b16 a[198:199], v100 offset:43520
  buffer_load_dwordx4 v13, s[20:23], s62 offen offset:0 lds
  v_rcp_f32 v62, v62
  v_rcp_f32 v63, v63
  v_mul_f32 v60, v60, v76
  s_waitcnt lgkmcnt(4)
  v_mfma_f32_32x32x16_bf16 v[80:95], a[176:179], v[224:227], v[80:95]
  ds_read_b64_tr_b16 a[200:201], v103 offset:40960
  ds_read_b64_tr_b16 a[202:203], v103 offset:41472
  buffer_load_dwordx4 v14, s[20:23], s62 offen offset:1024 lds
  v_mul_f32 v61, v61, v77
  v_mul_f32 v62, v62, v78
  v_mul_f32 v63, v63, v79
  v_cvt_pk_bf16_f32 v246, v60, v61
  v_cvt_pk_bf16_f32 v247, v62, v63
  ds_write_b128 v110, v[244:247] offset:1024
  v_mfma_f32_32x32x16_bf16 v[80:95], a[180:183], v[228:231], v[80:95]
  ds_read_b64_tr_b16 a[204:205], v103 offset:43008
  ds_read_b64_tr_b16 a[206:207], v103 offset:43520
  buffer_load_dwordx4 v15, s[20:23], s62 offen offset:2048 lds
  s_waitcnt lgkmcnt(2)
  s_barrier
  ds_read_b128 v[248:251], v111 offset:0
  ds_read_b128 v[252:255], v111 offset:1024
  v_mfma_f32_32x32x16_bf16 v[80:95], a[184:187], v[232:235], v[80:95]
  s_waitcnt vmcnt(18)
  s_barrier
  ds_read_b64_tr_b16 a[176:177], v98 offset:0
  ds_read_b64_tr_b16 a[178:179], v98 offset:512
  v_mfma_f32_32x32x16_bf16 v[80:95], a[188:191], v[236:239], v[80:95]
  ds_read_b64_tr_b16 a[180:181], v98 offset:2048
  ds_read_b64_tr_b16 a[182:183], v98 offset:2560
  s_add_u32 s62, s63, 221440
  s_waitcnt lgkmcnt(6)
  v_mfma_f32_32x32x16_bf16 v[80:95], a[192:195], v[240:243], v[80:95]
  ds_read_b64_tr_b16 a[184:185], v101 offset:0
  ds_read_b64_tr_b16 a[186:187], v101 offset:512
  s_add_u32 m0, s61, 98304
  v_mfma_f32_32x32x16_bf16 v[80:95], a[196:199], v[244:247], v[80:95]
  ds_read_b64_tr_b16 a[188:189], v101 offset:2048
  ds_read_b64_tr_b16 a[190:191], v101 offset:2560
  buffer_load_dwordx4 v13, s[20:23], s62 offen offset:0 lds
  s_waitcnt lgkmcnt(8)
  v_mfma_f32_32x32x16_bf16 v[80:95], a[200:203], v[248:251], v[80:95]
  ds_read_b64_tr_b16 a[192:193], v98 offset:8192
  ds_read_b64_tr_b16 a[194:195], v98 offset:8704
  buffer_load_dwordx4 v14, s[20:23], s62 offen offset:1024 lds
  v_mfma_f32_32x32x16_bf16 v[80:95], a[204:207], v[252:255], v[80:95]
  ds_read_b64_tr_b16 a[196:197], v98 offset:10240
  ds_read_b64_tr_b16 a[198:199], v98 offset:10752
  buffer_load_dwordx4 v15, s[20:23], s62 offen offset:2048 lds
  s_waitcnt lgkmcnt(4)
  v_mfma_f32_32x32x16_bf16 v[64:79], a[176:179], v[112:115], 0
  ds_read_b64_tr_b16 a[200:201], v101 offset:8192
  ds_read_b64_tr_b16 a[202:203], v101 offset:8704
  v_mfma_f32_32x32x16_bf16 v[64:79], a[180:183], v[116:119], v[64:79]
  ds_read_b64_tr_b16 a[204:205], v101 offset:10240
  ds_read_b64_tr_b16 a[206:207], v101 offset:10752
  s_add_u32 s62, s63, 249088
  v_mfma_f32_32x32x16_bf16 v[64:79], a[184:187], v[120:123], v[64:79]
  ds_read_b64_tr_b16 a[176:177], v98 offset:16384
  ds_read_b64_tr_b16 a[178:179], v98 offset:16896
  s_add_u32 m0, s61, 101376
  v_mfma_f32_32x32x16_bf16 v[64:79], a[188:191], v[124:127], v[64:79]
  ds_read_b64_tr_b16 a[180:181], v98 offset:18432
  ds_read_b64_tr_b16 a[182:183], v98 offset:18944
  buffer_load_dwordx4 v13, s[20:23], s62 offen offset:0 lds
  v_cvt_pk_bf16_f32 v56, v80, v81
  s_waitcnt lgkmcnt(4)
  v_mfma_f32_32x32x16_bf16 v[64:79], a[192:195], v[128:131], v[64:79]
  ds_read_b64_tr_b16 a[184:185], v101 offset:16384
  ds_read_b64_tr_b16 a[186:187], v101 offset:16896
  buffer_load_dwordx4 v14, s[20:23], s62 offen offset:1024 lds
  v_cvt_pk_bf16_f32 v57, v82, v83
  v_mfma_f32_32x32x16_bf16 v[64:79], a[196:199], v[132:135], v[64:79]
  ds_read_b64_tr_b16 a[188:189], v101 offset:18432
  ds_read_b64_tr_b16 a[190:191], v101 offset:18944
  buffer_load_dwordx4 v15, s[20:23], s62 offen offset:2048 lds
  v_cvt_pk_bf16_f32 v58, v84, v85
  v_mfma_f32_32x32x16_bf16 v[64:79], a[200:203], v[136:139], v[64:79]
  s_waitcnt vmcnt(18)
  s_barrier
  ds_read_b64_tr_b16 a[192:193], v98 offset:24576
  ds_read_b64_tr_b16 a[194:195], v98 offset:25088
  v_cvt_pk_bf16_f32 v59, v86, v87
  v_mfma_f32_32x32x16_bf16 v[64:79], a[204:207], v[140:143], v[64:79]
  ds_read_b64_tr_b16 a[196:197], v98 offset:26624
  ds_read_b64_tr_b16 a[198:199], v98 offset:27136
  s_add_u32 s62, s63, 442624
  buffer_store_dwordx4 v[56:59], v18, s[32:35], s60 offen sc1
  s_waitcnt lgkmcnt(4)
  v_mfma_f32_32x32x16_bf16 v[64:79], a[176:179], v[144:147], v[64:79]
  ds_read_b64_tr_b16 a[200:201], v101 offset:24576
  ds_read_b64_tr_b16 a[202:203], v101 offset:25088
  s_add_u32 m0, s61, 122880
  v_cvt_pk_bf16_f32 v60, v88, v89
  v_cvt_pk_bf16_f32 v61, v90, v91
  v_mfma_f32_32x32x16_bf16 v[64:79], a[180:183], v[148:151], v[64:79]
  ds_read_b64_tr_b16 a[204:205], v101 offset:26624
  ds_read_b64_tr_b16 a[206:207], v101 offset:27136
  buffer_load_dwordx4 v13, s[20:23], s62 offen offset:0 lds
  v_cvt_pk_bf16_f32 v62, v92, v93
  v_mfma_f32_32x32x16_bf16 v[64:79], a[184:187], v[152:155], v[64:79]
  ds_read_b64_tr_b16 a[176:177], v98 offset:32768
  ds_read_b64_tr_b16 a[178:179], v98 offset:33280
  buffer_load_dwordx4 v14, s[20:23], s62 offen offset:1024 lds
  v_cvt_pk_bf16_f32 v63, v94, v95
  v_mfma_f32_32x32x16_bf16 v[64:79], a[188:191], v[156:159], v[64:79]
  ds_read_b64_tr_b16 a[180:181], v98 offset:34816
  ds_read_b64_tr_b16 a[182:183], v98 offset:35328
  buffer_load_dwordx4 v15, s[20:23], s62 offen offset:2048 lds
  buffer_store_dwordx4 v[60:63], v18, s[32:35], s60 offen offset:256 sc1
  s_waitcnt lgkmcnt(4)
  v_mfma_f32_32x32x16_bf16 v[64:79], a[192:195], v[160:163], v[64:79]
  ds_read_b64_tr_b16 a[184:185], v101 offset:32768
  ds_read_b64_tr_b16 a[186:187], v101 offset:33280
  s_add_u32 s60, s60, 1024
  v_mfma_f32_32x32x16_bf16 v[64:79], a[196:199], v[164:167], v[64:79]
  ds_read_b64_tr_b16 a[188:189], v101 offset:34816
  ds_read_b64_tr_b16 a[190:191], v101 offset:35328
  s_add_u32 s62, s63, 470272
  v_mfma_f32_32x32x16_bf16 v[64:79], a[200:203], v[168:171], v[64:79]
  ds_read_b64_tr_b16 a[192:193], v98 offset:40960
  ds_read_b64_tr_b16 a[194:195], v98 offset:41472
  s_add_u32 m0, s61, 125952
  v_mfma_f32_32x32x16_bf16 v[64:79], a[204:207], v[172:175], v[64:79]
  ds_read_b64_tr_b16 a[196:197], v98 offset:43008
  ds_read_b64_tr_b16 a[198:199], v98 offset:43520
  buffer_load_dwordx4 v13, s[20:23], s62 offen offset:0 lds
  s_waitcnt lgkmcnt(4)
  v_mfma_f32_32x32x16_bf16 v[64:79], a[176:179], v[176:179], v[64:79]
  ds_read_b64_tr_b16 a[200:201], v101 offset:40960
  ds_read_b64_tr_b16 a[202:203], v101 offset:41472
  buffer_load_dwordx4 v14, s[20:23], s62 offen offset:1024 lds
  v_mfma_f32_32x32x16_bf16 v[64:79], a[180:183], v[180:183], v[64:79]
  ds_read_b64_tr_b16 a[204:205], v101 offset:43008
  ds_read_b64_tr_b16 a[206:207], v101 offset:43520
  buffer_load_dwordx4 v15, s[20:23], s62 offen offset:2048 lds
  v_mfma_f32_32x32x16_bf16 v[64:79], a[184:187], v[184:187], v[64:79]
  s_waitcnt vmcnt(20)
  s_barrier
  ds_read_b64_tr_b16 a[176:177], v99 offset:0
  ds_read_b64_tr_b16 a[178:179], v99 offset:512
  v_mfma_f32_32x32x16_bf16 v[64:79], a[188:191], v[188:191], v[64:79]
  ds_read_b64_tr_b16 a[180:181], v99 offset:2048
  ds_read_b64_tr_b16 a[182:183], v99 offset:2560
  s_add_u32 s62, s63, 384
  s_waitcnt lgkmcnt(4)
  v_mfma_f32_32x32x16_bf16 v[64:79], a[192:195], v[192:195], v[64:79]
  ds_read_b64_tr_b16 a[184:185], v102 offset:0
  ds_read_b64_tr_b16 a[186:187], v102 offset:512
  s_add_u32 m0, s61, 0
  v_mfma_f32_32x32x16_bf16 v[64:79], a[196:199], v[196:199], v[64:79]
  ds_read_b64_tr_b16 a[188:189], v102 offset:2048
  ds_read_b64_tr_b16 a[190:191], v102 offset:2560
  buffer_load_dwordx4 v13, s[20:23], s62 offen offset:0 lds
  v_mfma_f32_32x32x16_bf16 v[64:79], a[200:203], v[200:203], v[64:79]
  ds_read_b64_tr_b16 a[192:193], v99 offset:8192
  ds_read_b64_tr_b16 a[194:195], v99 offset:8704
  buffer_load_dwordx4 v14, s[20:23], s62 offen offset:1024 lds
  v_mfma_f32_32x32x16_bf16 v[64:79], a[204:207], v[204:207], v[64:79]
  ds_read_b64_tr_b16 a[196:197], v99 offset:10240
  ds_read_b64_tr_b16 a[198:199], v99 offset:10752
  buffer_load_dwordx4 v15, s[20:23], s62 offen offset:2048 lds
  s_waitcnt lgkmcnt(4)
  v_mfma_f32_32x32x16_bf16 v[64:79], a[176:179], v[208:211], v[64:79]
  ds_read_b64_tr_b16 a[200:201], v102 offset:8192
  ds_read_b64_tr_b16 a[202:203], v102 offset:8704
  v_mfma_f32_32x32x16_bf16 v[64:79], a[180:183], v[212:215], v[64:79]
  ds_read_b64_tr_b16 a[204:205], v102 offset:10240
  ds_read_b64_tr_b16 a[206:207], v102 offset:10752
  s_add_u32 s62, s63, 28032
  v_mfma_f32_32x32x16_bf16 v[64:79], a[184:187], v[216:219], v[64:79]
  ds_read_b64_tr_b16 a[176:177], v99 offset:16384
  ds_read_b64_tr_b16 a[178:179], v99 offset:16896
  s_add_u32 m0, s61, 3072
  v_mfma_f32_32x32x16_bf16 v[64:79], a[188:191], v[220:223], v[64:79]
  ds_read_b64_tr_b16 a[180:181], v99 offset:18432
  ds_read_b64_tr_b16 a[182:183], v99 offset:18944
  buffer_load_dwordx4 v13, s[20:23], s62 offen offset:0 lds
  s_waitcnt lgkmcnt(4)
  v_mfma_f32_32x32x16_bf16 v[64:79], a[192:195], v[224:227], v[64:79]
  ds_read_b64_tr_b16 a[184:185], v102 offset:16384
  ds_read_b64_tr_b16 a[186:187], v102 offset:16896
  buffer_load_dwordx4 v14, s[20:23], s62 offen offset:1024 lds
  v_mfma_f32_32x32x16_bf16 v[64:79], a[196:199], v[228:231], v[64:79]
  ds_read_b64_tr_b16 a[188:189], v102 offset:18432
  ds_read_b64_tr_b16 a[190:191], v102 offset:18944
  buffer_load_dwordx4 v15, s[20:23], s62 offen offset:2048 lds
  v_mfma_f32_32x32x16_bf16 v[64:79], a[200:203], v[232:235], v[64:79]
  s_waitcnt vmcnt(20)
  s_barrier
  ds_read_b64_tr_b16 a[192:193], v99 offset:24576
  ds_read_b64_tr_b16 a[194:195], v99 offset:25088
  v_mfma_f32_32x32x16_bf16 v[64:79], a[204:207], v[236:239], v[64:79]
  ds_read_b64_tr_b16 a[196:197], v99 offset:26624
  ds_read_b64_tr_b16 a[198:199], v99 offset:27136
  s_add_u32 s62, s63, 221568
  s_waitcnt lgkmcnt(4)
  v_mfma_f32_32x32x16_bf16 v[64:79], a[176:179], v[240:243], v[64:79]
  ds_read_b64_tr_b16 a[200:201], v102 offset:24576
  ds_read_b64_tr_b16 a[202:203], v102 offset:25088
  s_add_u32 m0, s61, 24576
  v_mfma_f32_32x32x16_bf16 v[64:79], a[180:183], v[244:247], v[64:79]
  ds_read_b64_tr_b16 a[204:205], v102 offset:26624
  ds_read_b64_tr_b16 a[206:207], v102 offset:27136
  buffer_load_dwordx4 v13, s[20:23], s62 offen offset:0 lds
  v_mfma_f32_32x32x16_bf16 v[64:79], a[184:187], v[248:251], v[64:79]
  ds_read_b64_tr_b16 a[176:177], v99 offset:32768
  ds_read_b64_tr_b16 a[178:179], v99 offset:33280
  buffer_load_dwordx4 v14, s[20:23], s62 offen offset:1024 lds
  v_mfma_f32_32x32x16_bf16 v[64:79], a[188:191], v[252:255], v[64:79]
  ds_read_b64_tr_b16 a[180:181], v99 offset:34816
  ds_read_b64_tr_b16 a[182:183], v99 offset:35328
  buffer_load_dwordx4 v15, s[20:23], s62 offen offset:2048 lds
  s_waitcnt lgkmcnt(4)
  v_mfma_f32_32x32x16_bf16 v[80:95], a[192:195], v[112:115], 0
  ds_read_b64_tr_b16 a[184:185], v102 offset:32768
  ds_read_b64_tr_b16 a[186:187], v102 offset:33280
  v_mfma_f32_32x32x16_bf16 v[80:95], a[196:199], v[116:119], v[80:95]
  ds_read_b64_tr_b16 a[188:189], v102 offset:34816
  ds_read_b64_tr_b16 a[190:191], v102 offset:35328
  s_add_u32 s62, s63, 249216
  v_mfma_f32_32x32x16_bf16 v[80:95], a[200:203], v[120:123], v[80:95]
  ds_read_b64_tr_b16 a[192:193], v99 offset:40960
  ds_read_b64_tr_b16 a[194:195], v99 offset:41472
  s_add_u32 m0, s61, 27648
  v_mfma_f32_32x32x16_bf16 v[80:95], a[204:207], v[124:127], v[80:95]
  ds_read_b64_tr_b16 a[196:197], v99 offset:43008
  ds_read_b64_tr_b16 a[198:199], v99 offset:43520
  buffer_load_dwordx4 v13, s[20:23], s62 offen offset:0 lds
  v_cvt_pk_bf16_f32 v56, v64, v65
  s_waitcnt lgkmcnt(4)
  v_mfma_f32_32x32x16_bf16 v[80:95], a[176:179], v[128:131], v[80:95]
  ds_read_b64_tr_b16 a[200:201], v102 offset:40960
  ds_read_b64_tr_b16 a[202:203], v102 offset:41472
  buffer_load_dwordx4 v14, s[20:23], s62 offen offset:1024 lds
  v_cvt_pk_bf16_f32 v57, v66, v67
  v_mfma_f32_32x32x16_bf16 v[80:95], a[180:183], v[132:135], v[80:95]
  ds_read_b64_tr_b16 a[204:205], v102 offset:43008
  ds_read_b64_tr_b16 a[206:207], v102 offset:43520
  buffer_load_dwordx4 v15, s[20:23], s62 offen offset:2048 lds
  v_cvt_pk_bf16_f32 v58, v68, v69
  v_mfma_f32_32x32x16_bf16 v[80:95], a[184:187], v[136:139], v[80:95]
  s_waitcnt vmcnt(20)
  s_barrier
  ds_read_b64_tr_b16 a[176:177], v100 offset:0
  ds_read_b64_tr_b16 a[178:179], v100 offset:512
  v_cvt_pk_bf16_f32 v59, v70, v71
  v_mfma_f32_32x32x16_bf16 v[80:95], a[188:191], v[140:143], v[80:95]
  ds_read_b64_tr_b16 a[180:181], v100 offset:2048
  ds_read_b64_tr_b16 a[182:183], v100 offset:2560
  s_add_u32 s62, s63, 442752
  buffer_store_dwordx4 v[56:59], v18, s[32:35], s60 offen sc1
  s_waitcnt lgkmcnt(4)
  v_mfma_f32_32x32x16_bf16 v[80:95], a[192:195], v[144:147], v[80:95]
  ds_read_b64_tr_b16 a[184:185], v103 offset:0
  ds_read_b64_tr_b16 a[186:187], v103 offset:512
  s_add_u32 m0, s61, 49152
  v_cvt_pk_bf16_f32 v60, v72, v73
  v_cvt_pk_bf16_f32 v61, v74, v75
  v_mfma_f32_32x32x16_bf16 v[80:95], a[196:199], v[148:151], v[80:95]
  ds_read_b64_tr_b16 a[188:189], v103 offset:2048
  ds_read_b64_tr_b16 a[190:191], v103 offset:2560
  buffer_load_dwordx4 v13, s[20:23], s62 offen offset:0 lds
  v_cvt_pk_bf16_f32 v62, v76, v77
  v_mfma_f32_32x32x16_bf16 v[80:95], a[200:203], v[152:155], v[80:95]
  ds_read_b64_tr_b16 a[192:193], v100 offset:8192
  ds_read_b64_tr_b16 a[194:195], v100 offset:8704
  buffer_load_dwordx4 v14, s[20:23], s62 offen offset:1024 lds
  v_cvt_pk_bf16_f32 v63, v78, v79
  v_mfma_f32_32x32x16_bf16 v[80:95], a[204:207], v[156:159], v[80:95]
  ds_read_b64_tr_b16 a[196:197], v100 offset:10240
  ds_read_b64_tr_b16 a[198:199], v100 offset:10752
  buffer_load_dwordx4 v15, s[20:23], s62 offen offset:2048 lds
  buffer_store_dwordx4 v[60:63], v18, s[32:35], s60 offen offset:256 sc1
  s_waitcnt lgkmcnt(4)
  v_mfma_f32_32x32x16_bf16 v[80:95], a[176:179], v[160:163], v[80:95]
  ds_read_b64_tr_b16 a[200:201], v103 offset:8192
  ds_read_b64_tr_b16 a[202:203], v103 offset:8704
  s_add_u32 s60, s60, 1024
  v_mfma_f32_32x32x16_bf16 v[80:95], a[180:183], v[164:167], v[80:95]
  ds_read_b64_tr_b16 a[204:205], v103 offset:10240
  ds_read_b64_tr_b16 a[206:207], v103 offset:10752
  s_add_u32 s62, s63, 470400
  v_mfma_f32_32x32x16_bf16 v[80:95], a[184:187], v[168:171], v[80:95]
  ds_read_b64_tr_b16 a[176:177], v100 offset:16384
  ds_read_b64_tr_b16 a[178:179], v100 offset:16896
  s_add_u32 m0, s61, 52224
  v_mfma_f32_32x32x16_bf16 v[80:95], a[188:191], v[172:175], v[80:95]
  ds_read_b64_tr_b16 a[180:181], v100 offset:18432
  ds_read_b64_tr_b16 a[182:183], v100 offset:18944
  buffer_load_dwordx4 v13, s[20:23], s62 offen offset:0 lds
  s_waitcnt lgkmcnt(4)
  v_mfma_f32_32x32x16_bf16 v[80:95], a[192:195], v[176:179], v[80:95]
  ds_read_b64_tr_b16 a[184:185], v103 offset:16384
  ds_read_b64_tr_b16 a[186:187], v103 offset:16896
  buffer_load_dwordx4 v14, s[20:23], s62 offen offset:1024 lds
  v_mfma_f32_32x32x16_bf16 v[80:95], a[196:199], v[180:183], v[80:95]
  ds_read_b64_tr_b16 a[188:189], v103 offset:18432
  ds_read_b64_tr_b16 a[190:191], v103 offset:18944
  buffer_load_dwordx4 v15, s[20:23], s62 offen offset:2048 lds
  v_mfma_f32_32x32x16_bf16 v[80:95], a[200:203], v[184:187], v[80:95]
  s_waitcnt vmcnt(20)
  s_barrier
  ds_read_b64_tr_b16 a[192:193], v100 offset:24576
  ds_read_b64_tr_b16 a[194:195], v100 offset:25088
  v_mfma_f32_32x32x16_bf16 v[80:95], a[204:207], v[188:191], v[80:95]
  ds_read_b64_tr_b16 a[196:197], v100 offset:26624
  ds_read_b64_tr_b16 a[198:199], v100 offset:27136
  s_add_u32 s62, s63, 512
  s_waitcnt lgkmcnt(4)
  v_mfma_f32_32x32x16_bf16 v[80:95], a[176:179], v[192:195], v[80:95]
  ds_read_b64_tr_b16 a[200:201], v103 offset:24576
  ds_read_b64_tr_b16 a[202:203], v103 offset:25088
  s_add_u32 m0, s61, 73728
  v_mfma_f32_32x32x16_bf16 v[80:95], a[180:183], v[196:199], v[80:95]
  ds_read_b64_tr_b16 a[204:205], v103 offset:26624
  ds_read_b64_tr_b16 a[206:207], v103 offset:27136
  buffer_load_dwordx4 v13, s[20:23], s62 offen offset:0 lds
  v_mfma_f32_32x32x16_bf16 v[80:95], a[184:187], v[200:203], v[80:95]
  ds_read_b64_tr_b16 a[176:177], v100 offset:32768
  ds_read_b64_tr_b16 a[178:179], v100 offset:33280
  buffer_load_dwordx4 v14, s[20:23], s62 offen offset:1024 lds
  v_mfma_f32_32x32x16_bf16 v[80:95], a[188:191], v[204:207], v[80:95]
  ds_read_b64_tr_b16 a[180:181], v100 offset:34816
  ds_read_b64_tr_b16 a[182:183], v100 offset:35328
  buffer_load_dwordx4 v15, s[20:23], s62 offen offset:2048 lds
  s_waitcnt lgkmcnt(4)
  v_mfma_f32_32x32x16_bf16 v[80:95], a[192:195], v[208:211], v[80:95]
  ds_read_b64_tr_b16 a[184:185], v103 offset:32768
  ds_read_b64_tr_b16 a[186:187], v103 offset:33280
  v_mfma_f32_32x32x16_bf16 v[80:95], a[196:199], v[212:215], v[80:95]
  ds_read_b64_tr_b16 a[188:189], v103 offset:34816
  ds_read_b64_tr_b16 a[190:191], v103 offset:35328
  s_add_u32 s62, s63, 28160
  v_mfma_f32_32x32x16_bf16 v[80:95], a[200:203], v[216:219], v[80:95]
  ds_read_b64_tr_b16 a[192:193], v100 offset:40960
  ds_read_b64_tr_b16 a[194:195], v100 offset:41472
  s_add_u32 m0, s61, 76800
  v_mfma_f32_32x32x16_bf16 v[80:95], a[204:207], v[220:223], v[80:95]
  ds_read_b64_tr_b16 a[196:197], v100 offset:43008
  ds_read_b64_tr_b16 a[198:199], v100 offset:43520
  buffer_load_dwordx4 v13, s[20:23], s62 offen offset:0 lds
  s_waitcnt lgkmcnt(4)
  v_mfma_f32_32x32x16_bf16 v[80:95], a[176:179], v[224:227], v[80:95]
  ds_read_b64_tr_b16 a[200:201], v103 offset:40960
  ds_read_b64_tr_b16 a[202:203], v103 offset:41472
  buffer_load_dwordx4 v14, s[20:23], s62 offen offset:1024 lds
  v_mfma_f32_32x32x16_bf16 v[80:95], a[180:183], v[228:231], v[80:95]
  ds_read_b64_tr_b16 a[204:205], v103 offset:43008
  ds_read_b64_tr_b16 a[206:207], v103 offset:43520
  buffer_load_dwordx4 v15, s[20:23], s62 offen offset:2048 lds
  v_mfma_f32_32x32x16_bf16 v[80:95], a[184:187], v[232:235], v[80:95]
  s_waitcnt vmcnt(20)
  s_barrier
  ds_read_b64_tr_b16 a[176:177], v98 offset:0
  ds_read_b64_tr_b16 a[178:179], v98 offset:512
  v_mfma_f32_32x32x16_bf16 v[80:95], a[188:191], v[236:239], v[80:95]
  ds_read_b64_tr_b16 a[180:181], v98 offset:2048
  ds_read_b64_tr_b16 a[182:183], v98 offset:2560
  s_add_u32 s62, s63, 221696
  s_waitcnt lgkmcnt(4)
  v_mfma_f32_32x32x16_bf16 v[80:95], a[192:195], v[240:243], v[80:95]
  ds_read_b64_tr_b16 a[184:185], v101 offset:0
  ds_read_b64_tr_b16 a[186:187], v101 offset:512
  s_add_u32 m0, s61, 98304
  v_mfma_f32_32x32x16_bf16 v[80:95], a[196:199], v[244:247], v[80:95]
  ds_read_b64_tr_b16 a[188:189], v101 offset:2048
  ds_read_b64_tr_b16 a[190:191], v101 offset:2560
  buffer_load_dwordx4 v13, s[20:23], s62 offen offset:0 lds
  v_mfma_f32_32x32x16_bf16 v[80:95], a[200:203], v[248:251], v[80:95]
  ds_read_b64_tr_b16 a[192:193], v98 offset:8192
  ds_read_b64_tr_b16 a[194:195], v98 offset:8704
  buffer_load_dwordx4 v14, s[20:23], s62 offen offset:1024 lds
  v_mfma_f32_32x32x16_bf16 v[80:95], a[204:207], v[252:255], v[80:95]
  ds_read_b64_tr_b16 a[196:197], v98 offset:10240
  ds_read_b64_tr_b16 a[198:199], v98 offset:10752
  buffer_load_dwordx4 v15, s[20:23], s62 offen offset:2048 lds
  s_waitcnt lgkmcnt(4)
  v_mfma_f32_32x32x16_bf16 v[64:79], a[176:179], v[112:115], 0
  ds_read_b64_tr_b16 a[200:201], v101 offset:8192
  ds_read_b64_tr_b16 a[202:203], v101 offset:8704
  v_mfma_f32_32x32x16_bf16 v[64:79], a[180:183], v[116:119], v[64:79]
  ds_read_b64_tr_b16 a[204:205], v101 offset:10240
  ds_read_b64_tr_b16 a[206:207], v101 offset:10752
  s_add_u32 s62, s63, 249344
  v_mfma_f32_32x32x16_bf16 v[64:79], a[184:187], v[120:123], v[64:79]
  ds_read_b64_tr_b16 a[176:177], v98 offset:16384
  ds_read_b64_tr_b16 a[178:179], v98 offset:16896
  s_add_u32 m0, s61, 101376
  v_mfma_f32_32x32x16_bf16 v[64:79], a[188:191], v[124:127], v[64:79]
  ds_read_b64_tr_b16 a[180:181], v98 offset:18432
  ds_read_b64_tr_b16 a[182:183], v98 offset:18944
  buffer_load_dwordx4 v13, s[20:23], s62 offen offset:0 lds
  v_cvt_pk_bf16_f32 v56, v80, v81
  s_waitcnt lgkmcnt(4)
  v_mfma_f32_32x32x16_bf16 v[64:79], a[192:195], v[128:131], v[64:79]
  ds_read_b64_tr_b16 a[184:185], v101 offset:16384
  ds_read_b64_tr_b16 a[186:187], v101 offset:16896
  buffer_load_dwordx4 v14, s[20:23], s62 offen offset:1024 lds
  v_cvt_pk_bf16_f32 v57, v82, v83
  v_mfma_f32_32x32x16_bf16 v[64:79], a[196:199], v[132:135], v[64:79]
  ds_read_b64_tr_b16 a[188:189], v101 offset:18432
  ds_read_b64_tr_b16 a[190:191], v101 offset:18944
  buffer_load_dwordx4 v15, s[20:23], s62 offen offset:2048 lds
  v_cvt_pk_bf16_f32 v58, v84, v85
  v_mfma_f32_32x32x16_bf16 v[64:79], a[200:203], v[136:139], v[64:79]
  s_waitcnt vmcnt(20)
  s_barrier
  ds_read_b64_tr_b16 a[192:193], v98 offset:24576
  ds_read_b64_tr_b16 a[194:195], v98 offset:25088
  v_cvt_pk_bf16_f32 v59, v86, v87
  v_mfma_f32_32x32x16_bf16 v[64:79], a[204:207], v[140:143], v[64:79]
  ds_read_b64_tr_b16 a[196:197], v98 offset:26624
  ds_read_b64_tr_b16 a[198:199], v98 offset:27136
  s_add_u32 s62, s63, 442880
  buffer_store_dwordx4 v[56:59], v18, s[32:35], s60 offen sc1
  s_waitcnt lgkmcnt(4)
  v_mfma_f32_32x32x16_bf16 v[64:79], a[176:179], v[144:147], v[64:79]
  ds_read_b64_tr_b16 a[200:201], v101 offset:24576
  ds_read_b64_tr_b16 a[202:203], v101 offset:25088
  s_add_u32 m0, s61, 122880
  v_cvt_pk_bf16_f32 v60, v88, v89
  v_cvt_pk_bf16_f32 v61, v90, v91
  v_mfma_f32_32x32x16_bf16 v[64:79], a[180:183], v[148:151], v[64:79]
  ds_read_b64_tr_b16 a[204:205], v101 offset:26624
  ds_read_b64_tr_b16 a[206:207], v101 offset:27136
  buffer_load_dwordx4 v13, s[20:23], s62 offen offset:0 lds
  v_cvt_pk_bf16_f32 v62, v92, v93
  v_mfma_f32_32x32x16_bf16 v[64:79], a[184:187], v[152:155], v[64:79]
  ds_read_b64_tr_b16 a[176:177], v98 offset:32768
  ds_read_b64_tr_b16 a[178:179], v98 offset:33280
  buffer_load_dwordx4 v14, s[20:23], s62 offen offset:1024 lds
  v_cvt_pk_bf16_f32 v63, v94, v95
  v_mfma_f32_32x32x16_bf16 v[64:79], a[188:191], v[156:159], v[64:79]
  ds_read_b64_tr_b16 a[180:181], v98 offset:34816
  ds_read_b64_tr_b16 a[182:183], v98 offset:35328
  buffer_load_dwordx4 v15, s[20:23], s62 offen offset:2048 lds
  buffer_store_dwordx4 v[60:63], v18, s[32:35], s60 offen offset:256 sc1
  s_waitcnt lgkmcnt(4)
  v_mfma_f32_32x32x16_bf16 v[64:79], a[192:195], v[160:163], v[64:79]
  ds_read_b64_tr_b16 a[184:185], v101 offset:32768
  ds_read_b64_tr_b16 a[186:187], v101 offset:33280
  s_add_u32 s60, s60, 1024
  v_mfma_f32_32x32x16_bf16 v[64:79], a[196:199], v[164:167], v[64:79]
  ds_read_b64_tr_b16 a[188:189], v101 offset:34816
  ds_read_b64_tr_b16 a[190:191], v101 offset:35328
  s_add_u32 s62, s63, 470528
  v_mfma_f32_32x32x16_bf16 v[64:79], a[200:203], v[168:171], v[64:79]
  ds_read_b64_tr_b16 a[192:193], v98 offset:40960
  ds_read_b64_tr_b16 a[194:195], v98 offset:41472
  s_add_u32 m0, s61, 125952
  v_mfma_f32_32x32x16_bf16 v[64:79], a[204:207], v[172:175], v[64:79]
  ds_read_b64_tr_b16 a[196:197], v98 offset:43008
  ds_read_b64_tr_b16 a[198:199], v98 offset:43520
  buffer_load_dwordx4 v13, s[20:23], s62 offen offset:0 lds
  s_waitcnt lgkmcnt(4)
  v_mfma_f32_32x32x16_bf16 v[64:79], a[176:179], v[176:179], v[64:79]
  ds_read_b64_tr_b16 a[200:201], v101 offset:40960
  ds_read_b64_tr_b16 a[202:203], v101 offset:41472
  buffer_load_dwordx4 v14, s[20:23], s62 offen offset:1024 lds
  v_mfma_f32_32x32x16_bf16 v[64:79], a[180:183], v[180:183], v[64:79]
  ds_read_b64_tr_b16 a[204:205], v101 offset:43008
  ds_read_b64_tr_b16 a[206:207], v101 offset:43520
  buffer_load_dwordx4 v15, s[20:23], s62 offen offset:2048 lds
  v_mfma_f32_32x32x16_bf16 v[64:79], a[184:187], v[184:187], v[64:79]
  s_waitcnt vmcnt(20)
  s_barrier
  ds_read_b64_tr_b16 a[176:177], v99 offset:0
  ds_read_b64_tr_b16 a[178:179], v99 offset:512
  v_mfma_f32_32x32x16_bf16 v[64:79], a[188:191], v[188:191], v[64:79]
  ds_read_b64_tr_b16 a[180:181], v99 offset:2048
  ds_read_b64_tr_b16 a[182:183], v99 offset:2560
  s_add_u32 s62, s63, 640
  s_waitcnt lgkmcnt(4)
  v_mfma_f32_32x32x16_bf16 v[64:79], a[192:195], v[192:195], v[64:79]
  ds_read_b64_tr_b16 a[184:185], v102 offset:0
  ds_read_b64_tr_b16 a[186:187], v102 offset:512
  s_add_u32 m0, s61, 0
  v_mfma_f32_32x32x16_bf16 v[64:79], a[196:199], v[196:199], v[64:79]
  ds_read_b64_tr_b16 a[188:189], v102 offset:2048
  ds_read_b64_tr_b16 a[190:191], v102 offset:2560
  buffer_load_dwordx4 v13, s[20:23], s62 offen offset:0 lds
  v_mfma_f32_32x32x16_bf16 v[64:79], a[200:203], v[200:203], v[64:79]
  ds_read_b64_tr_b16 a[192:193], v99 offset:8192
  ds_read_b64_tr_b16 a[194:195], v99 offset:8704
  buffer_load_dwordx4 v14, s[20:23], s62 offen offset:1024 lds
  v_mfma_f32_32x32x16_bf16 v[64:79], a[204:207], v[204:207], v[64:79]
  ds_read_b64_tr_b16 a[196:197], v99 offset:10240
  ds_read_b64_tr_b16 a[198:199], v99 offset:10752
  buffer_load_dwordx4 v15, s[20:23], s62 offen offset:2048 lds
  s_waitcnt lgkmcnt(4)
  v_mfma_f32_32x32x16_bf16 v[64:79], a[176:179], v[208:211], v[64:79]
  ds_read_b64_tr_b16 a[200:201], v102 offset:8192
  ds_read_b64_tr_b16 a[202:203], v102 offset:8704
  v_mfma_f32_32x32x16_bf16 v[64:79], a[180:183], v[212:215], v[64:79]
  ds_read_b64_tr_b16 a[204:205], v102 offset:10240
  ds_read_b64_tr_b16 a[206:207], v102 offset:10752
  s_add_u32 s62, s63, 28288
  v_mfma_f32_32x32x16_bf16 v[64:79], a[184:187], v[216:219], v[64:79]
  ds_read_b64_tr_b16 a[176:177], v99 offset:16384
  ds_read_b64_tr_b16 a[178:179], v99 offset:16896
  s_add_u32 m0, s61, 3072
  v_mfma_f32_32x32x16_bf16 v[64:79], a[188:191], v[220:223], v[64:79]
  ds_read_b64_tr_b16 a[180:181], v99 offset:18432
  ds_read_b64_tr_b16 a[182:183], v99 offset:18944
  buffer_load_dwordx4 v13, s[20:23], s62 offen offset:0 lds
  s_waitcnt lgkmcnt(4)
  v_mfma_f32_32x32x16_bf16 v[64:79], a[192:195], v[224:227], v[64:79]
  ds_read_b64_tr_b16 a[184:185], v102 offset:16384
  ds_read_b64_tr_b16 a[186:187], v102 offset:16896
  buffer_load_dwordx4 v14, s[20:23], s62 offen offset:1024 lds
  v_mfma_f32_32x32x16_bf16 v[64:79], a[196:199], v[228:231], v[64:79]
  ds_read_b64_tr_b16 a[188:189], v102 offset:18432
  ds_read_b64_tr_b16 a[190:191], v102 offset:18944
  buffer_load_dwordx4 v15, s[20:23], s62 offen offset:2048 lds
  v_mfma_f32_32x32x16_bf16 v[64:79], a[200:203], v[232:235], v[64:79]
  s_waitcnt vmcnt(20)
  s_barrier
  ds_read_b64_tr_b16 a[192:193], v99 offset:24576
  ds_read_b64_tr_b16 a[194:195], v99 offset:25088
  v_mfma_f32_32x32x16_bf16 v[64:79], a[204:207], v[236:239], v[64:79]
  ds_read_b64_tr_b16 a[196:197], v99 offset:26624
  ds_read_b64_tr_b16 a[198:199], v99 offset:27136
  s_add_u32 s62, s63, 221824
  s_waitcnt lgkmcnt(4)
  v_mfma_f32_32x32x16_bf16 v[64:79], a[176:179], v[240:243], v[64:79]
  ds_read_b64_tr_b16 a[200:201], v102 offset:24576
  ds_read_b64_tr_b16 a[202:203], v102 offset:25088
  s_add_u32 m0, s61, 24576
  v_mfma_f32_32x32x16_bf16 v[64:79], a[180:183], v[244:247], v[64:79]
  ds_read_b64_tr_b16 a[204:205], v102 offset:26624
  ds_read_b64_tr_b16 a[206:207], v102 offset:27136
  buffer_load_dwordx4 v13, s[20:23], s62 offen offset:0 lds
  v_mfma_f32_32x32x16_bf16 v[64:79], a[184:187], v[248:251], v[64:79]
  ds_read_b64_tr_b16 a[176:177], v99 offset:32768
  ds_read_b64_tr_b16 a[178:179], v99 offset:33280
  buffer_load_dwordx4 v14, s[20:23], s62 offen offset:1024 lds
  v_mfma_f32_32x32x16_bf16 v[64:79], a[188:191], v[252:255], v[64:79]
  ds_read_b64_tr_b16 a[180:181], v99 offset:34816
  ds_read_b64_tr_b16 a[182:183], v99 offset:35328
  buffer_load_dwordx4 v15, s[20:23], s62 offen offset:2048 lds
  s_waitcnt lgkmcnt(4)
  v_mfma_f32_32x32x16_bf16 v[80:95], a[192:195], v[112:115], 0
  ds_read_b64_tr_b16 a[184:185], v102 offset:32768
  ds_read_b64_tr_b16 a[186:187], v102 offset:33280
  v_mfma_f32_32x32x16_bf16 v[80:95], a[196:199], v[116:119], v[80:95]
  ds_read_b64_tr_b16 a[188:189], v102 offset:34816
  ds_read_b64_tr_b16 a[190:191], v102 offset:35328
  s_add_u32 s62, s63, 249472
  v_mfma_f32_32x32x16_bf16 v[80:95], a[200:203], v[120:123], v[80:95]
  ds_read_b64_tr_b16 a[192:193], v99 offset:40960
  ds_read_b64_tr_b16 a[194:195], v99 offset:41472
  s_add_u32 m0, s61, 27648
  v_mfma_f32_32x32x16_bf16 v[80:95], a[204:207], v[124:127], v[80:95]
  ds_read_b64_tr_b16 a[196:197], v99 offset:43008
  ds_read_b64_tr_b16 a[198:199], v99 offset:43520
  buffer_load_dwordx4 v13, s[20:23], s62 offen offset:0 lds
  v_cvt_pk_bf16_f32 v56, v64, v65
  s_waitcnt lgkmcnt(4)
  v_mfma_f32_32x32x16_bf16 v[80:95], a[176:179], v[128:131], v[80:95]
  ds_read_b64_tr_b16 a[200:201], v102 offset:40960
  ds_read_b64_tr_b16 a[202:203], v102 offset:41472
  buffer_load_dwordx4 v14, s[20:23], s62 offen offset:1024 lds
  v_cvt_pk_bf16_f32 v57, v66, v67
  v_mfma_f32_32x32x16_bf16 v[80:95], a[180:183], v[132:135], v[80:95]
  ds_read_b64_tr_b16 a[204:205], v102 offset:43008
  ds_read_b64_tr_b16 a[206:207], v102 offset:43520
  buffer_load_dwordx4 v15, s[20:23], s62 offen offset:2048 lds
  v_cvt_pk_bf16_f32 v58, v68, v69
  v_mfma_f32_32x32x16_bf16 v[80:95], a[184:187], v[136:139], v[80:95]
  s_waitcnt vmcnt(20)
  s_barrier
  ds_read_b64_tr_b16 a[176:177], v100 offset:0
  ds_read_b64_tr_b16 a[178:179], v100 offset:512
  v_cvt_pk_bf16_f32 v59, v70, v71
  v_mfma_f32_32x32x16_bf16 v[80:95], a[188:191], v[140:143], v[80:95]
  ds_read_b64_tr_b16 a[180:181], v100 offset:2048
  ds_read_b64_tr_b16 a[182:183], v100 offset:2560
  s_add_u32 s62, s63, 443008
  buffer_store_dwordx4 v[56:59], v18, s[32:35], s60 offen sc1
  s_waitcnt lgkmcnt(4)
  v_mfma_f32_32x32x16_bf16 v[80:95], a[192:195], v[144:147], v[80:95]
  ds_read_b64_tr_b16 a[184:185], v103 offset:0
  ds_read_b64_tr_b16 a[186:187], v103 offset:512
  s_add_u32 m0, s61, 49152
  v_cvt_pk_bf16_f32 v60, v72, v73
  v_cvt_pk_bf16_f32 v61, v74, v75
  v_mfma_f32_32x32x16_bf16 v[80:95], a[196:199], v[148:151], v[80:95]
  ds_read_b64_tr_b16 a[188:189], v103 offset:2048
  ds_read_b64_tr_b16 a[190:191], v103 offset:2560
  buffer_load_dwordx4 v13, s[20:23], s62 offen offset:0 lds
  v_cvt_pk_bf16_f32 v62, v76, v77
  v_mfma_f32_32x32x16_bf16 v[80:95], a[200:203], v[152:155], v[80:95]
  ds_read_b64_tr_b16 a[192:193], v100 offset:8192
  ds_read_b64_tr_b16 a[194:195], v100 offset:8704
  buffer_load_dwordx4 v14, s[20:23], s62 offen offset:1024 lds
  v_cvt_pk_bf16_f32 v63, v78, v79
  v_mfma_f32_32x32x16_bf16 v[80:95], a[204:207], v[156:159], v[80:95]
  ds_read_b64_tr_b16 a[196:197], v100 offset:10240
  ds_read_b64_tr_b16 a[198:199], v100 offset:10752
  buffer_load_dwordx4 v15, s[20:23], s62 offen offset:2048 lds
  buffer_store_dwordx4 v[60:63], v18, s[32:35], s60 offen offset:256 sc1
  s_waitcnt lgkmcnt(4)
  v_mfma_f32_32x32x16_bf16 v[80:95], a[176:179], v[160:163], v[80:95]
  ds_read_b64_tr_b16 a[200:201], v103 offset:8192
  ds_read_b64_tr_b16 a[202:203], v103 offset:8704
  s_add_u32 s60, s60, 1024
  v_mfma_f32_32x32x16_bf16 v[80:95], a[180:183], v[164:167], v[80:95]
  ds_read_b64_tr_b16 a[204:205], v103 offset:10240
  ds_read_b64_tr_b16 a[206:207], v103 offset:10752
  s_add_u32 s62, s63, 470656
  v_mfma_f32_32x32x16_bf16 v[80:95], a[184:187], v[168:171], v[80:95]
  ds_read_b64_tr_b16 a[176:177], v100 offset:16384
  ds_read_b64_tr_b16 a[178:179], v100 offset:16896
  s_add_u32 m0, s61, 52224
  v_mfma_f32_32x32x16_bf16 v[80:95], a[188:191], v[172:175], v[80:95]
  ds_read_b64_tr_b16 a[180:181], v100 offset:18432
  ds_read_b64_tr_b16 a[182:183], v100 offset:18944
  buffer_load_dwordx4 v13, s[20:23], s62 offen offset:0 lds
  s_waitcnt lgkmcnt(4)
  v_mfma_f32_32x32x16_bf16 v[80:95], a[192:195], v[176:179], v[80:95]
  ds_read_b64_tr_b16 a[184:185], v103 offset:16384
  ds_read_b64_tr_b16 a[186:187], v103 offset:16896
  buffer_load_dwordx4 v14, s[20:23], s62 offen offset:1024 lds
  v_mfma_f32_32x32x16_bf16 v[80:95], a[196:199], v[180:183], v[80:95]
  ds_read_b64_tr_b16 a[188:189], v103 offset:18432
  ds_read_b64_tr_b16 a[190:191], v103 offset:18944
  buffer_load_dwordx4 v15, s[20:23], s62 offen offset:2048 lds
  v_mfma_f32_32x32x16_bf16 v[80:95], a[200:203], v[184:187], v[80:95]
  s_waitcnt vmcnt(20)
  s_barrier
  ds_read_b64_tr_b16 a[192:193], v100 offset:24576
  ds_read_b64_tr_b16 a[194:195], v100 offset:25088
  v_mfma_f32_32x32x16_bf16 v[80:95], a[204:207], v[188:191], v[80:95]
  ds_read_b64_tr_b16 a[196:197], v100 offset:26624
  ds_read_b64_tr_b16 a[198:199], v100 offset:27136
  s_add_u32 s62, s63, 768
  s_waitcnt lgkmcnt(4)
  v_mfma_f32_32x32x16_bf16 v[80:95], a[176:179], v[192:195], v[80:95]
  ds_read_b64_tr_b16 a[200:201], v103 offset:24576
  ds_read_b64_tr_b16 a[202:203], v103 offset:25088
  s_add_u32 m0, s61, 73728
  v_mfma_f32_32x32x16_bf16 v[80:95], a[180:183], v[196:199], v[80:95]
  ds_read_b64_tr_b16 a[204:205], v103 offset:26624
  ds_read_b64_tr_b16 a[206:207], v103 offset:27136
  buffer_load_dwordx4 v13, s[20:23], s62 offen offset:0 lds
  v_mfma_f32_32x32x16_bf16 v[80:95], a[184:187], v[200:203], v[80:95]
  ds_read_b64_tr_b16 a[176:177], v100 offset:32768
  ds_read_b64_tr_b16 a[178:179], v100 offset:33280
  buffer_load_dwordx4 v14, s[20:23], s62 offen offset:1024 lds
  v_mfma_f32_32x32x16_bf16 v[80:95], a[188:191], v[204:207], v[80:95]
  ds_read_b64_tr_b16 a[180:181], v100 offset:34816
  ds_read_b64_tr_b16 a[182:183], v100 offset:35328
  buffer_load_dwordx4 v15, s[20:23], s62 offen offset:2048 lds
  s_waitcnt lgkmcnt(4)
  v_mfma_f32_32x32x16_bf16 v[80:95], a[192:195], v[208:211], v[80:95]
  ds_read_b64_tr_b16 a[184:185], v103 offset:32768
  ds_read_b64_tr_b16 a[186:187], v103 offset:33280
  v_mfma_f32_32x32x16_bf16 v[80:95], a[196:199], v[212:215], v[80:95]
  ds_read_b64_tr_b16 a[188:189], v103 offset:34816
  ds_read_b64_tr_b16 a[190:191], v103 offset:35328
  s_add_u32 s62, s63, 28416
  v_mfma_f32_32x32x16_bf16 v[80:95], a[200:203], v[216:219], v[80:95]
  ds_read_b64_tr_b16 a[192:193], v100 offset:40960
  ds_read_b64_tr_b16 a[194:195], v100 offset:41472
  s_add_u32 m0, s61, 76800
  v_mfma_f32_32x32x16_bf16 v[80:95], a[204:207], v[220:223], v[80:95]
  ds_read_b64_tr_b16 a[196:197], v100 offset:43008
  ds_read_b64_tr_b16 a[198:199], v100 offset:43520
  buffer_load_dwordx4 v13, s[20:23], s62 offen offset:0 lds
  s_waitcnt lgkmcnt(4)
  v_mfma_f32_32x32x16_bf16 v[80:95], a[176:179], v[224:227], v[80:95]
  ds_read_b64_tr_b16 a[200:201], v103 offset:40960
  ds_read_b64_tr_b16 a[202:203], v103 offset:41472
  buffer_load_dwordx4 v14, s[20:23], s62 offen offset:1024 lds
  v_mfma_f32_32x32x16_bf16 v[80:95], a[180:183], v[228:231], v[80:95]
  ds_read_b64_tr_b16 a[204:205], v103 offset:43008
  ds_read_b64_tr_b16 a[206:207], v103 offset:43520
  buffer_load_dwordx4 v15, s[20:23], s62 offen offset:2048 lds
  v_mfma_f32_32x32x16_bf16 v[80:95], a[184:187], v[232:235], v[80:95]
  s_waitcnt vmcnt(20)
  s_barrier
  ds_read_b64_tr_b16 a[176:177], v98 offset:0
  ds_read_b64_tr_b16 a[178:179], v98 offset:512
  v_mfma_f32_32x32x16_bf16 v[80:95], a[188:191], v[236:239], v[80:95]
  ds_read_b64_tr_b16 a[180:181], v98 offset:2048
  ds_read_b64_tr_b16 a[182:183], v98 offset:2560
  s_add_u32 s62, s63, 221952
  s_waitcnt lgkmcnt(4)
  v_mfma_f32_32x32x16_bf16 v[80:95], a[192:195], v[240:243], v[80:95]
  ds_read_b64_tr_b16 a[184:185], v101 offset:0
  ds_read_b64_tr_b16 a[186:187], v101 offset:512
  s_add_u32 m0, s61, 98304
  v_mfma_f32_32x32x16_bf16 v[80:95], a[196:199], v[244:247], v[80:95]
  ds_read_b64_tr_b16 a[188:189], v101 offset:2048
  ds_read_b64_tr_b16 a[190:191], v101 offset:2560
  buffer_load_dwordx4 v13, s[20:23], s62 offen offset:0 lds
  v_mfma_f32_32x32x16_bf16 v[80:95], a[200:203], v[248:251], v[80:95]
  ds_read_b64_tr_b16 a[192:193], v98 offset:8192
  ds_read_b64_tr_b16 a[194:195], v98 offset:8704
  buffer_load_dwordx4 v14, s[20:23], s62 offen offset:1024 lds
  v_mfma_f32_32x32x16_bf16 v[80:95], a[204:207], v[252:255], v[80:95]
  ds_read_b64_tr_b16 a[196:197], v98 offset:10240
  ds_read_b64_tr_b16 a[198:199], v98 offset:10752
  buffer_load_dwordx4 v15, s[20:23], s62 offen offset:2048 lds
  s_waitcnt lgkmcnt(4)
  v_mfma_f32_32x32x16_bf16 v[64:79], a[176:179], v[112:115], 0
  ds_read_b64_tr_b16 a[200:201], v101 offset:8192
  ds_read_b64_tr_b16 a[202:203], v101 offset:8704
  v_mfma_f32_32x32x16_bf16 v[64:79], a[180:183], v[116:119], v[64:79]
  ds_read_b64_tr_b16 a[204:205], v101 offset:10240
  ds_read_b64_tr_b16 a[206:207], v101 offset:10752
  s_add_u32 s62, s63, 249600
  v_mfma_f32_32x32x16_bf16 v[64:79], a[184:187], v[120:123], v[64:79]
  ds_read_b64_tr_b16 a[176:177], v98 offset:16384
  ds_read_b64_tr_b16 a[178:179], v98 offset:16896
  s_add_u32 m0, s61, 101376
  v_mfma_f32_32x32x16_bf16 v[64:79], a[188:191], v[124:127], v[64:79]
  ds_read_b64_tr_b16 a[180:181], v98 offset:18432
  ds_read_b64_tr_b16 a[182:183], v98 offset:18944
  buffer_load_dwordx4 v13, s[20:23], s62 offen offset:0 lds
  v_cvt_pk_bf16_f32 v56, v80, v81
  s_waitcnt lgkmcnt(4)
  v_mfma_f32_32x32x16_bf16 v[64:79], a[192:195], v[128:131], v[64:79]
  ds_read_b64_tr_b16 a[184:185], v101 offset:16384
  ds_read_b64_tr_b16 a[186:187], v101 offset:16896
  buffer_load_dwordx4 v14, s[20:23], s62 offen offset:1024 lds
  v_cvt_pk_bf16_f32 v57, v82, v83
  v_mfma_f32_32x32x16_bf16 v[64:79], a[196:199], v[132:135], v[64:79]
  ds_read_b64_tr_b16 a[188:189], v101 offset:18432
  ds_read_b64_tr_b16 a[190:191], v101 offset:18944
  buffer_load_dwordx4 v15, s[20:23], s62 offen offset:2048 lds
  v_cvt_pk_bf16_f32 v58, v84, v85
  v_mfma_f32_32x32x16_bf16 v[64:79], a[200:203], v[136:139], v[64:79]
  s_waitcnt vmcnt(20)
  s_barrier
  ds_read_b64_tr_b16 a[192:193], v98 offset:24576
  ds_read_b64_tr_b16 a[194:195], v98 offset:25088
  v_cvt_pk_bf16_f32 v59, v86, v87
  v_mfma_f32_32x32x16_bf16 v[64:79], a[204:207], v[140:143], v[64:79]
  ds_read_b64_tr_b16 a[196:197], v98 offset:26624
  ds_read_b64_tr_b16 a[198:199], v98 offset:27136
  s_add_u32 s62, s63, 443136
  buffer_store_dwordx4 v[56:59], v18, s[32:35], s60 offen sc1
  s_waitcnt lgkmcnt(4)
  v_mfma_f32_32x32x16_bf16 v[64:79], a[176:179], v[144:147], v[64:79]
  ds_read_b64_tr_b16 a[200:201], v101 offset:24576
  ds_read_b64_tr_b16 a[202:203], v101 offset:25088
  s_add_u32 m0, s61, 122880
  v_cvt_pk_bf16_f32 v60, v88, v89
  v_cvt_pk_bf16_f32 v61, v90, v91
  v_mfma_f32_32x32x16_bf16 v[64:79], a[180:183], v[148:151], v[64:79]
  ds_read_b64_tr_b16 a[204:205], v101 offset:26624
  ds_read_b64_tr_b16 a[206:207], v101 offset:27136
  buffer_load_dwordx4 v13, s[20:23], s62 offen offset:0 lds
  v_cvt_pk_bf16_f32 v62, v92, v93
  v_mfma_f32_32x32x16_bf16 v[64:79], a[184:187], v[152:155], v[64:79]
  ds_read_b64_tr_b16 a[176:177], v98 offset:32768
  ds_read_b64_tr_b16 a[178:179], v98 offset:33280
  buffer_load_dwordx4 v14, s[20:23], s62 offen offset:1024 lds
  v_cvt_pk_bf16_f32 v63, v94, v95
  v_mfma_f32_32x32x16_bf16 v[64:79], a[188:191], v[156:159], v[64:79]
  ds_read_b64_tr_b16 a[180:181], v98 offset:34816
  ds_read_b64_tr_b16 a[182:183], v98 offset:35328
  buffer_load_dwordx4 v15, s[20:23], s62 offen offset:2048 lds
  buffer_store_dwordx4 v[60:63], v18, s[32:35], s60 offen offset:256 sc1
  s_waitcnt lgkmcnt(4)
  v_mfma_f32_32x32x16_bf16 v[64:79], a[192:195], v[160:163], v[64:79]
  ds_read_b64_tr_b16 a[184:185], v101 offset:32768
  ds_read_b64_tr_b16 a[186:187], v101 offset:33280
  s_add_u32 s60, s60, 1024
  v_mfma_f32_32x32x16_bf16 v[64:79], a[196:199], v[164:167], v[64:79]
  ds_read_b64_tr_b16 a[188:189], v101 offset:34816
  ds_read_b64_tr_b16 a[190:191], v101 offset:35328
  s_add_u32 s62, s63, 470784
  v_mfma_f32_32x32x16_bf16 v[64:79], a[200:203], v[168:171], v[64:79]
  ds_read_b64_tr_b16 a[192:193], v98 offset:40960
  ds_read_b64_tr_b16 a[194:195], v98 offset:41472
  s_add_u32 m0, s61, 125952
  v_mfma_f32_32x32x16_bf16 v[64:79], a[204:207], v[172:175], v[64:79]
  ds_read_b64_tr_b16 a[196:197], v98 offset:43008
  ds_read_b64_tr_b16 a[198:199], v98 offset:43520
  buffer_load_dwordx4 v13, s[20:23], s62 offen offset:0 lds
  s_waitcnt lgkmcnt(4)
  v_mfma_f32_32x32x16_bf16 v[64:79], a[176:179], v[176:179], v[64:79]
  ds_read_b64_tr_b16 a[200:201], v101 offset:40960
  ds_read_b64_tr_b16 a[202:203], v101 offset:41472
  buffer_load_dwordx4 v14, s[20:23], s62 offen offset:1024 lds
  v_mfma_f32_32x32x16_bf16 v[64:79], a[180:183], v[180:183], v[64:79]
  ds_read_b64_tr_b16 a[204:205], v101 offset:43008
  ds_read_b64_tr_b16 a[206:207], v101 offset:43520
  buffer_load_dwordx4 v15, s[20:23], s62 offen offset:2048 lds
  v_mfma_f32_32x32x16_bf16 v[64:79], a[184:187], v[184:187], v[64:79]
  s_waitcnt vmcnt(20)
  s_barrier
  ds_read_b64_tr_b16 a[176:177], v99 offset:0
  ds_read_b64_tr_b16 a[178:179], v99 offset:512
  v_mfma_f32_32x32x16_bf16 v[64:79], a[188:191], v[188:191], v[64:79]
  ds_read_b64_tr_b16 a[180:181], v99 offset:2048
  ds_read_b64_tr_b16 a[182:183], v99 offset:2560
  s_add_u32 s62, s63, 896
  s_waitcnt lgkmcnt(4)
  v_mfma_f32_32x32x16_bf16 v[64:79], a[192:195], v[192:195], v[64:79]
  ds_read_b64_tr_b16 a[184:185], v102 offset:0
  ds_read_b64_tr_b16 a[186:187], v102 offset:512
  s_add_u32 m0, s61, 0
  v_mfma_f32_32x32x16_bf16 v[64:79], a[196:199], v[196:199], v[64:79]
  ds_read_b64_tr_b16 a[188:189], v102 offset:2048
  ds_read_b64_tr_b16 a[190:191], v102 offset:2560
  buffer_load_dwordx4 v13, s[20:23], s62 offen offset:0 lds
  v_mfma_f32_32x32x16_bf16 v[64:79], a[200:203], v[200:203], v[64:79]
  ds_read_b64_tr_b16 a[192:193], v99 offset:8192
  ds_read_b64_tr_b16 a[194:195], v99 offset:8704
  buffer_load_dwordx4 v14, s[20:23], s62 offen offset:1024 lds
  v_mfma_f32_32x32x16_bf16 v[64:79], a[204:207], v[204:207], v[64:79]
  ds_read_b64_tr_b16 a[196:197], v99 offset:10240
  ds_read_b64_tr_b16 a[198:199], v99 offset:10752
  buffer_load_dwordx4 v15, s[20:23], s62 offen offset:2048 lds
  s_waitcnt lgkmcnt(4)
  v_mfma_f32_32x32x16_bf16 v[64:79], a[176:179], v[208:211], v[64:79]
  ds_read_b64_tr_b16 a[200:201], v102 offset:8192
  ds_read_b64_tr_b16 a[202:203], v102 offset:8704
  v_mfma_f32_32x32x16_bf16 v[64:79], a[180:183], v[212:215], v[64:79]
  ds_read_b64_tr_b16 a[204:205], v102 offset:10240
  ds_read_b64_tr_b16 a[206:207], v102 offset:10752
  s_add_u32 s62, s63, 28544
  v_mfma_f32_32x32x16_bf16 v[64:79], a[184:187], v[216:219], v[64:79]
  ds_read_b64_tr_b16 a[176:177], v99 offset:16384
  ds_read_b64_tr_b16 a[178:179], v99 offset:16896
  s_add_u32 m0, s61, 3072
  v_mfma_f32_32x32x16_bf16 v[64:79], a[188:191], v[220:223], v[64:79]
  ds_read_b64_tr_b16 a[180:181], v99 offset:18432
  ds_read_b64_tr_b16 a[182:183], v99 offset:18944
  buffer_load_dwordx4 v13, s[20:23], s62 offen offset:0 lds
  s_waitcnt lgkmcnt(4)
  v_mfma_f32_32x32x16_bf16 v[64:79], a[192:195], v[224:227], v[64:79]
  ds_read_b64_tr_b16 a[184:185], v102 offset:16384
  ds_read_b64_tr_b16 a[186:187], v102 offset:16896
  buffer_load_dwordx4 v14, s[20:23], s62 offen offset:1024 lds
  v_mfma_f32_32x32x16_bf16 v[64:79], a[196:199], v[228:231], v[64:79]
  ds_read_b64_tr_b16 a[188:189], v102 offset:18432
  ds_read_b64_tr_b16 a[190:191], v102 offset:18944
  buffer_load_dwordx4 v15, s[20:23], s62 offen offset:2048 lds
  v_mfma_f32_32x32x16_bf16 v[64:79], a[200:203], v[232:235], v[64:79]
  s_waitcnt vmcnt(20)
  s_barrier
  ds_read_b64_tr_b16 a[192:193], v99 offset:24576
  ds_read_b64_tr_b16 a[194:195], v99 offset:25088
  v_mfma_f32_32x32x16_bf16 v[64:79], a[204:207], v[236:239], v[64:79]
  ds_read_b64_tr_b16 a[196:197], v99 offset:26624
  ds_read_b64_tr_b16 a[198:199], v99 offset:27136
  s_add_u32 s62, s63, 222080
  s_waitcnt lgkmcnt(4)
  v_mfma_f32_32x32x16_bf16 v[64:79], a[176:179], v[240:243], v[64:79]
  ds_read_b64_tr_b16 a[200:201], v102 offset:24576
  ds_read_b64_tr_b16 a[202:203], v102 offset:25088
  s_add_u32 m0, s61, 24576
  v_mfma_f32_32x32x16_bf16 v[64:79], a[180:183], v[244:247], v[64:79]
  ds_read_b64_tr_b16 a[204:205], v102 offset:26624
  ds_read_b64_tr_b16 a[206:207], v102 offset:27136
  buffer_load_dwordx4 v13, s[20:23], s62 offen offset:0 lds
  v_mfma_f32_32x32x16_bf16 v[64:79], a[184:187], v[248:251], v[64:79]
  ds_read_b64_tr_b16 a[176:177], v99 offset:32768
  ds_read_b64_tr_b16 a[178:179], v99 offset:33280
  buffer_load_dwordx4 v14, s[20:23], s62 offen offset:1024 lds
  v_mfma_f32_32x32x16_bf16 v[64:79], a[188:191], v[252:255], v[64:79]
  ds_read_b64_tr_b16 a[180:181], v99 offset:34816
  ds_read_b64_tr_b16 a[182:183], v99 offset:35328
  buffer_load_dwordx4 v15, s[20:23], s62 offen offset:2048 lds
  s_waitcnt lgkmcnt(4)
  v_mfma_f32_32x32x16_bf16 v[80:95], a[192:195], v[112:115], 0
  ds_read_b64_tr_b16 a[184:185], v102 offset:32768
  ds_read_b64_tr_b16 a[186:187], v102 offset:33280
  v_mfma_f32_32x32x16_bf16 v[80:95], a[196:199], v[116:119], v[80:95]
  ds_read_b64_tr_b16 a[188:189], v102 offset:34816
  ds_read_b64_tr_b16 a[190:191], v102 offset:35328
  s_add_u32 s62, s63, 249728
  v_mfma_f32_32x32x16_bf16 v[80:95], a[200:203], v[120:123], v[80:95]
  ds_read_b64_tr_b16 a[192:193], v99 offset:40960
  ds_read_b64_tr_b16 a[194:195], v99 offset:41472
  s_add_u32 m0, s61, 27648
  v_mfma_f32_32x32x16_bf16 v[80:95], a[204:207], v[124:127], v[80:95]
  ds_read_b64_tr_b16 a[196:197], v99 offset:43008
  ds_read_b64_tr_b16 a[198:199], v99 offset:43520
  buffer_load_dwordx4 v13, s[20:23], s62 offen offset:0 lds
  v_cvt_pk_bf16_f32 v56, v64, v65
  s_waitcnt lgkmcnt(4)
  v_mfma_f32_32x32x16_bf16 v[80:95], a[176:179], v[128:131], v[80:95]
  ds_read_b64_tr_b16 a[200:201], v102 offset:40960
  ds_read_b64_tr_b16 a[202:203], v102 offset:41472
  buffer_load_dwordx4 v14, s[20:23], s62 offen offset:1024 lds
  v_cvt_pk_bf16_f32 v57, v66, v67
  v_mfma_f32_32x32x16_bf16 v[80:95], a[180:183], v[132:135], v[80:95]
  ds_read_b64_tr_b16 a[204:205], v102 offset:43008
  ds_read_b64_tr_b16 a[206:207], v102 offset:43520
  buffer_load_dwordx4 v15, s[20:23], s62 offen offset:2048 lds
  v_cvt_pk_bf16_f32 v58, v68, v69
  v_mfma_f32_32x32x16_bf16 v[80:95], a[184:187], v[136:139], v[80:95]
  s_waitcnt vmcnt(20)
  s_barrier
  ds_read_b64_tr_b16 a[176:177], v100 offset:0
  ds_read_b64_tr_b16 a[178:179], v100 offset:512
  v_cvt_pk_bf16_f32 v59, v70, v71
  v_mfma_f32_32x32x16_bf16 v[80:95], a[188:191], v[140:143], v[80:95]
  ds_read_b64_tr_b16 a[180:181], v100 offset:2048
  ds_read_b64_tr_b16 a[182:183], v100 offset:2560
  s_add_u32 s62, s63, 443264
  buffer_store_dwordx4 v[56:59], v18, s[32:35], s60 offen sc1
  s_waitcnt lgkmcnt(4)
  v_mfma_f32_32x32x16_bf16 v[80:95], a[192:195], v[144:147], v[80:95]
  ds_read_b64_tr_b16 a[184:185], v103 offset:0
  ds_read_b64_tr_b16 a[186:187], v103 offset:512
  s_add_u32 m0, s61, 49152
  v_cvt_pk_bf16_f32 v60, v72, v73
  v_cvt_pk_bf16_f32 v61, v74, v75
  v_mfma_f32_32x32x16_bf16 v[80:95], a[196:199], v[148:151], v[80:95]
  ds_read_b64_tr_b16 a[188:189], v103 offset:2048
  ds_read_b64_tr_b16 a[190:191], v103 offset:2560
  buffer_load_dwordx4 v13, s[20:23], s62 offen offset:0 lds
  v_cvt_pk_bf16_f32 v62, v76, v77
  v_mfma_f32_32x32x16_bf16 v[80:95], a[200:203], v[152:155], v[80:95]
  ds_read_b64_tr_b16 a[192:193], v100 offset:8192
  ds_read_b64_tr_b16 a[194:195], v100 offset:8704
  buffer_load_dwordx4 v14, s[20:23], s62 offen offset:1024 lds
  v_cvt_pk_bf16_f32 v63, v78, v79
  v_mfma_f32_32x32x16_bf16 v[80:95], a[204:207], v[156:159], v[80:95]
  ds_read_b64_tr_b16 a[196:197], v100 offset:10240
  ds_read_b64_tr_b16 a[198:199], v100 offset:10752
  buffer_load_dwordx4 v15, s[20:23], s62 offen offset:2048 lds
  buffer_store_dwordx4 v[60:63], v18, s[32:35], s60 offen offset:256 sc1
  s_waitcnt lgkmcnt(4)
  v_mfma_f32_32x32x16_bf16 v[80:95], a[176:179], v[160:163], v[80:95]
  ds_read_b64_tr_b16 a[200:201], v103 offset:8192
  ds_read_b64_tr_b16 a[202:203], v103 offset:8704
  s_add_u32 s60, s60, 1024
  v_mfma_f32_32x32x16_bf16 v[80:95], a[180:183], v[164:167], v[80:95]
  ds_read_b64_tr_b16 a[204:205], v103 offset:10240
  ds_read_b64_tr_b16 a[206:207], v103 offset:10752
  s_add_u32 s62, s63, 470912
  v_mfma_f32_32x32x16_bf16 v[80:95], a[184:187], v[168:171], v[80:95]
  ds_read_b64_tr_b16 a[176:177], v100 offset:16384
  ds_read_b64_tr_b16 a[178:179], v100 offset:16896
  s_add_u32 m0, s61, 52224
  v_mfma_f32_32x32x16_bf16 v[80:95], a[188:191], v[172:175], v[80:95]
  ds_read_b64_tr_b16 a[180:181], v100 offset:18432
  ds_read_b64_tr_b16 a[182:183], v100 offset:18944
  buffer_load_dwordx4 v13, s[20:23], s62 offen offset:0 lds
  s_waitcnt lgkmcnt(4)
  v_mfma_f32_32x32x16_bf16 v[80:95], a[192:195], v[176:179], v[80:95]
  ds_read_b64_tr_b16 a[184:185], v103 offset:16384
  ds_read_b64_tr_b16 a[186:187], v103 offset:16896
  buffer_load_dwordx4 v14, s[20:23], s62 offen offset:1024 lds
  v_mfma_f32_32x32x16_bf16 v[80:95], a[196:199], v[180:183], v[80:95]
  ds_read_b64_tr_b16 a[188:189], v103 offset:18432
  ds_read_b64_tr_b16 a[190:191], v103 offset:18944
  buffer_load_dwordx4 v15, s[20:23], s62 offen offset:2048 lds
  v_mfma_f32_32x32x16_bf16 v[80:95], a[200:203], v[184:187], v[80:95]
  s_waitcnt vmcnt(20)
  s_barrier
  ds_read_b64_tr_b16 a[192:193], v100 offset:24576
  ds_read_b64_tr_b16 a[194:195], v100 offset:25088
  v_mfma_f32_32x32x16_bf16 v[80:95], a[204:207], v[188:191], v[80:95]
  ds_read_b64_tr_b16 a[196:197], v100 offset:26624
  ds_read_b64_tr_b16 a[198:199], v100 offset:27136
  s_add_u32 s62, s63, 1024
  s_waitcnt lgkmcnt(4)
  v_mfma_f32_32x32x16_bf16 v[80:95], a[176:179], v[192:195], v[80:95]
  ds_read_b64_tr_b16 a[200:201], v103 offset:24576
  ds_read_b64_tr_b16 a[202:203], v103 offset:25088
  s_add_u32 m0, s61, 73728
  v_mfma_f32_32x32x16_bf16 v[80:95], a[180:183], v[196:199], v[80:95]
  ds_read_b64_tr_b16 a[204:205], v103 offset:26624
  ds_read_b64_tr_b16 a[206:207], v103 offset:27136
  buffer_load_dwordx4 v13, s[20:23], s62 offen offset:0 lds
  v_mfma_f32_32x32x16_bf16 v[80:95], a[184:187], v[200:203], v[80:95]
  ds_read_b64_tr_b16 a[176:177], v100 offset:32768
  ds_read_b64_tr_b16 a[178:179], v100 offset:33280
  buffer_load_dwordx4 v14, s[20:23], s62 offen offset:1024 lds
  v_mfma_f32_32x32x16_bf16 v[80:95], a[188:191], v[204:207], v[80:95]
  ds_read_b64_tr_b16 a[180:181], v100 offset:34816
  ds_read_b64_tr_b16 a[182:183], v100 offset:35328
  buffer_load_dwordx4 v15, s[20:23], s62 offen offset:2048 lds
  s_waitcnt lgkmcnt(4)
  v_mfma_f32_32x32x16_bf16 v[80:95], a[192:195], v[208:211], v[80:95]
  ds_read_b64_tr_b16 a[184:185], v103 offset:32768
  ds_read_b64_tr_b16 a[186:187], v103 offset:33280
  v_mfma_f32_32x32x16_bf16 v[80:95], a[196:199], v[212:215], v[80:95]
  ds_read_b64_tr_b16 a[188:189], v103 offset:34816
  ds_read_b64_tr_b16 a[190:191], v103 offset:35328
  s_add_u32 s62, s63, 28672
  v_mfma_f32_32x32x16_bf16 v[80:95], a[200:203], v[216:219], v[80:95]
  ds_read_b64_tr_b16 a[192:193], v100 offset:40960
  ds_read_b64_tr_b16 a[194:195], v100 offset:41472
  s_add_u32 m0, s61, 76800
  v_mfma_f32_32x32x16_bf16 v[80:95], a[204:207], v[220:223], v[80:95]
  ds_read_b64_tr_b16 a[196:197], v100 offset:43008
  ds_read_b64_tr_b16 a[198:199], v100 offset:43520
  buffer_load_dwordx4 v13, s[20:23], s62 offen offset:0 lds
  s_waitcnt lgkmcnt(4)
  v_mfma_f32_32x32x16_bf16 v[80:95], a[176:179], v[224:227], v[80:95]
  ds_read_b64_tr_b16 a[200:201], v103 offset:40960
  ds_read_b64_tr_b16 a[202:203], v103 offset:41472
  buffer_load_dwordx4 v14, s[20:23], s62 offen offset:1024 lds
  v_mfma_f32_32x32x16_bf16 v[80:95], a[180:183], v[228:231], v[80:95]
  ds_read_b64_tr_b16 a[204:205], v103 offset:43008
  ds_read_b64_tr_b16 a[206:207], v103 offset:43520
  buffer_load_dwordx4 v15, s[20:23], s62 offen offset:2048 lds
  v_mfma_f32_32x32x16_bf16 v[80:95], a[184:187], v[232:235], v[80:95]
  s_waitcnt vmcnt(20)
  s_barrier
  ds_read_b64_tr_b16 a[176:177], v98 offset:0
  ds_read_b64_tr_b16 a[178:179], v98 offset:512
  v_mfma_f32_32x32x16_bf16 v[80:95], a[188:191], v[236:239], v[80:95]
  ds_read_b64_tr_b16 a[180:181], v98 offset:2048
  ds_read_b64_tr_b16 a[182:183], v98 offset:2560
  s_add_u32 s62, s63, 222208
  s_waitcnt lgkmcnt(4)
  v_mfma_f32_32x32x16_bf16 v[80:95], a[192:195], v[240:243], v[80:95]
  ds_read_b64_tr_b16 a[184:185], v101 offset:0
  ds_read_b64_tr_b16 a[186:187], v101 offset:512
  s_add_u32 m0, s61, 98304
  v_mfma_f32_32x32x16_bf16 v[80:95], a[196:199], v[244:247], v[80:95]
  ds_read_b64_tr_b16 a[188:189], v101 offset:2048
  ds_read_b64_tr_b16 a[190:191], v101 offset:2560
  buffer_load_dwordx4 v13, s[20:23], s62 offen offset:0 lds
  v_mfma_f32_32x32x16_bf16 v[80:95], a[200:203], v[248:251], v[80:95]
  ds_read_b64_tr_b16 a[192:193], v98 offset:8192
  ds_read_b64_tr_b16 a[194:195], v98 offset:8704
  buffer_load_dwordx4 v14, s[20:23], s62 offen offset:1024 lds
  v_mfma_f32_32x32x16_bf16 v[80:95], a[204:207], v[252:255], v[80:95]
  ds_read_b64_tr_b16 a[196:197], v98 offset:10240
  ds_read_b64_tr_b16 a[198:199], v98 offset:10752
  buffer_load_dwordx4 v15, s[20:23], s62 offen offset:2048 lds
  s_waitcnt lgkmcnt(4)
  v_mfma_f32_32x32x16_bf16 v[64:79], a[176:179], v[112:115], 0
  ds_read_b64_tr_b16 a[200:201], v101 offset:8192
  ds_read_b64_tr_b16 a[202:203], v101 offset:8704
  v_mfma_f32_32x32x16_bf16 v[64:79], a[180:183], v[116:119], v[64:79]
  ds_read_b64_tr_b16 a[204:205], v101 offset:10240
  ds_read_b64_tr_b16 a[206:207], v101 offset:10752
  s_add_u32 s62, s63, 249856
  v_mfma_f32_32x32x16_bf16 v[64:79], a[184:187], v[120:123], v[64:79]
  ds_read_b64_tr_b16 a[176:177], v98 offset:16384
  ds_read_b64_tr_b16 a[178:179], v98 offset:16896
  s_add_u32 m0, s61, 101376
  v_mfma_f32_32x32x16_bf16 v[64:79], a[188:191], v[124:127], v[64:79]
  ds_read_b64_tr_b16 a[180:181], v98 offset:18432
  ds_read_b64_tr_b16 a[182:183], v98 offset:18944
  buffer_load_dwordx4 v13, s[20:23], s62 offen offset:0 lds
  v_cvt_pk_bf16_f32 v56, v80, v81
  s_waitcnt lgkmcnt(4)
  v_mfma_f32_32x32x16_bf16 v[64:79], a[192:195], v[128:131], v[64:79]
  ds_read_b64_tr_b16 a[184:185], v101 offset:16384
  ds_read_b64_tr_b16 a[186:187], v101 offset:16896
  buffer_load_dwordx4 v14, s[20:23], s62 offen offset:1024 lds
  v_cvt_pk_bf16_f32 v57, v82, v83
  v_mfma_f32_32x32x16_bf16 v[64:79], a[196:199], v[132:135], v[64:79]
  ds_read_b64_tr_b16 a[188:189], v101 offset:18432
  ds_read_b64_tr_b16 a[190:191], v101 offset:18944
  buffer_load_dwordx4 v15, s[20:23], s62 offen offset:2048 lds
  v_cvt_pk_bf16_f32 v58, v84, v85
  v_mfma_f32_32x32x16_bf16 v[64:79], a[200:203], v[136:139], v[64:79]
  s_waitcnt vmcnt(20)
  s_barrier
  ds_read_b64_tr_b16 a[192:193], v98 offset:24576
  ds_read_b64_tr_b16 a[194:195], v98 offset:25088
  v_cvt_pk_bf16_f32 v59, v86, v87
  v_mfma_f32_32x32x16_bf16 v[64:79], a[204:207], v[140:143], v[64:79]
  ds_read_b64_tr_b16 a[196:197], v98 offset:26624
  ds_read_b64_tr_b16 a[198:199], v98 offset:27136
  s_add_u32 s62, s63, 443392
  buffer_store_dwordx4 v[56:59], v18, s[32:35], s60 offen sc1
  s_waitcnt lgkmcnt(4)
  v_mfma_f32_32x32x16_bf16 v[64:79], a[176:179], v[144:147], v[64:79]
  ds_read_b64_tr_b16 a[200:201], v101 offset:24576
  ds_read_b64_tr_b16 a[202:203], v101 offset:25088
  s_add_u32 m0, s61, 122880
  v_cvt_pk_bf16_f32 v60, v88, v89
  v_cvt_pk_bf16_f32 v61, v90, v91
  v_mfma_f32_32x32x16_bf16 v[64:79], a[180:183], v[148:151], v[64:79]
  ds_read_b64_tr_b16 a[204:205], v101 offset:26624
  ds_read_b64_tr_b16 a[206:207], v101 offset:27136
  buffer_load_dwordx4 v13, s[20:23], s62 offen offset:0 lds
  v_cvt_pk_bf16_f32 v62, v92, v93
  v_mfma_f32_32x32x16_bf16 v[64:79], a[184:187], v[152:155], v[64:79]
  ds_read_b64_tr_b16 a[176:177], v98 offset:32768
  ds_read_b64_tr_b16 a[178:179], v98 offset:33280
  buffer_load_dwordx4 v14, s[20:23], s62 offen offset:1024 lds
  v_cvt_pk_bf16_f32 v63, v94, v95
  v_mfma_f32_32x32x16_bf16 v[64:79], a[188:191], v[156:159], v[64:79]
  ds_read_b64_tr_b16 a[180:181], v98 offset:34816
  ds_read_b64_tr_b16 a[182:183], v98 offset:35328
  buffer_load_dwordx4 v15, s[20:23], s62 offen offset:2048 lds
  buffer_store_dwordx4 v[60:63], v18, s[32:35], s60 offen offset:256 sc1
  s_waitcnt lgkmcnt(4)
  v_mfma_f32_32x32x16_bf16 v[64:79], a[192:195], v[160:163], v[64:79]
  ds_read_b64_tr_b16 a[184:185], v101 offset:32768
  ds_read_b64_tr_b16 a[186:187], v101 offset:33280
  s_add_u32 s60, s60, 1024
  v_mfma_f32_32x32x16_bf16 v[64:79], a[196:199], v[164:167], v[64:79]
  ds_read_b64_tr_b16 a[188:189], v101 offset:34816
  ds_read_b64_tr_b16 a[190:191], v101 offset:35328
  s_add_u32 s62, s63, 471040
  v_mfma_f32_32x32x16_bf16 v[64:79], a[200:203], v[168:171], v[64:79]
  ds_read_b64_tr_b16 a[192:193], v98 offset:40960
  ds_read_b64_tr_b16 a[194:195], v98 offset:41472
  s_add_u32 m0, s61, 125952
  v_mfma_f32_32x32x16_bf16 v[64:79], a[204:207], v[172:175], v[64:79]
  ds_read_b64_tr_b16 a[196:197], v98 offset:43008
  ds_read_b64_tr_b16 a[198:199], v98 offset:43520
  buffer_load_dwordx4 v13, s[20:23], s62 offen offset:0 lds
  s_waitcnt lgkmcnt(4)
  v_mfma_f32_32x32x16_bf16 v[64:79], a[176:179], v[176:179], v[64:79]
  ds_read_b64_tr_b16 a[200:201], v101 offset:40960
  ds_read_b64_tr_b16 a[202:203], v101 offset:41472
  buffer_load_dwordx4 v14, s[20:23], s62 offen offset:1024 lds
  v_mfma_f32_32x32x16_bf16 v[64:79], a[180:183], v[180:183], v[64:79]
  ds_read_b64_tr_b16 a[204:205], v101 offset:43008
  ds_read_b64_tr_b16 a[206:207], v101 offset:43520
  buffer_load_dwordx4 v15, s[20:23], s62 offen offset:2048 lds
  v_mfma_f32_32x32x16_bf16 v[64:79], a[184:187], v[184:187], v[64:79]
  s_waitcnt vmcnt(20)
  s_barrier
  s_cmp_lg_u32 s46, 0
  s_cbranch_scc1 Lsa
  s_mov_b64 exec, 1
  buffer_store_dword v96, v19, s[32:35], s68 offen sc1
  s_mov_b64 exec, -1
Lsa:
  ds_read_b64_tr_b16 a[176:177], v99 offset:0
  ds_read_b64_tr_b16 a[178:179], v99 offset:512
  v_mfma_f32_32x32x16_bf16 v[64:79], a[188:191], v[188:191], v[64:79]
  ds_read_b64_tr_b16 a[180:181], v99 offset:2048
  ds_read_b64_tr_b16 a[182:183], v99 offset:2560
  s_waitcnt lgkmcnt(4)
  v_mfma_f32_32x32x16_bf16 v[64:79], a[192:195], v[192:195], v[64:79]
  ds_read_b64_tr_b16 a[184:185], v102 offset:0
  ds_read_b64_tr_b16 a[186:187], v102 offset:512
  v_mfma_f32_32x32x16_bf16 v[64:79], a[196:199], v[196:199], v[64:79]
  ds_read_b64_tr_b16 a[188:189], v102 offset:2048
  ds_read_b64_tr_b16 a[190:191], v102 offset:2560
  v_mfma_f32_32x32x16_bf16 v[64:79], a[200:203], v[200:203], v[64:79]
  ds_read_b64_tr_b16 a[192:193], v99 offset:8192
  ds_read_b64_tr_b16 a[194:195], v99 offset:8704
  v_mfma_f32_32x32x16_bf16 v[64:79], a[204:207], v[204:207], v[64:79]
  ds_read_b64_tr_b16 a[196:197], v99 offset:10240
  ds_read_b64_tr_b16 a[198:199], v99 offset:10752
  s_waitcnt lgkmcnt(4)
  v_mfma_f32_32x32x16_bf16 v[64:79], a[176:179], v[208:211], v[64:79]
  ds_read_b64_tr_b16 a[200:201], v102 offset:8192
  ds_read_b64_tr_b16 a[202:203], v102 offset:8704
  v_mfma_f32_32x32x16_bf16 v[64:79], a[180:183], v[212:215], v[64:79]
  ds_read_b64_tr_b16 a[204:205], v102 offset:10240
  ds_read_b64_tr_b16 a[206:207], v102 offset:10752
  v_mfma_f32_32x32x16_bf16 v[64:79], a[184:187], v[216:219], v[64:79]
  ds_read_b64_tr_b16 a[176:177], v99 offset:16384
  ds_read_b64_tr_b16 a[178:179], v99 offset:16896
  v_mfma_f32_32x32x16_bf16 v[64:79], a[188:191], v[220:223], v[64:79]
  ds_read_b64_tr_b16 a[180:181], v99 offset:18432
  ds_read_b64_tr_b16 a[182:183], v99 offset:18944
  s_waitcnt lgkmcnt(4)
  v_mfma_f32_32x32x16_bf16 v[64:79], a[192:195], v[224:227], v[64:79]
  ds_read_b64_tr_b16 a[184:185], v102 offset:16384
  ds_read_b64_tr_b16 a[186:187], v102 offset:16896
  v_lshrrev_b32 v47, 7, v1
  v_bfe_u32 v48, v1, 4, 3
  v_lshlrev_b32 v44, 10, v47
  v_lshl_add_u32 v44, v48, 4, v44
  v_lshlrev_b32 v45, 4, v47
  v_mul_u32_u24 v46, 1152, v48
  v_add_u32 v46, v46, v45
  v_mfma_f32_32x32x16_bf16 v[64:79], a[196:199], v[228:231], v[64:79]
  ds_read_b64_tr_b16 a[188:189], v102 offset:18432
  ds_read_b64_tr_b16 a[190:191], v102 offset:18944
  s_mul_i32 s54, s44, 73728
  s_mul_i32 s55, s46, 8192
  s_add_u32 s54, s54, s55
  s_lshl_b32 s55, s45, 7
  s_add_u32 s54, s54, s55
  s_add_u32 s54, s54, s50
  s_add_u32 s54, s54, 9175040
  s_mul_i32 s55, s46, 128
  v_mfma_f32_32x32x16_bf16 v[64:79], a[200:203], v[232:235], v[64:79]
  s_waitcnt vmcnt(14)
  s_barrier
  ds_read_b64_tr_b16 a[192:193], v99 offset:24576
  ds_read_b64_tr_b16 a[194:195], v99 offset:25088
  s_lshl_b32 s56, s44, 3
  s_add_u32 s56, s56, s45
  s_mul_i32 s57, s56, 9216
  s_add_u32 s57, s57, s55
  s_mul_i32 s56, s56, 73728
  s_mul_i32 s66, s46, 1024
  s_add_u32 s56, s56, s66
  s_add_u32 s56, s56, s50
  s_add_u32 s56, s56, 13893632
  v_mfma_f32_32x32x16_bf16 v[64:79], a[204:207], v[236:239], v[64:79]
  ds_read_b64_tr_b16 a[196:197], v99 offset:26624
  ds_read_b64_tr_b16 a[198:199], v99 offset:27136
  s_mov_b32 s58, 0x3f80
  s_mov_b32 s59, 0x3f800000
  s_waitcnt lgkmcnt(4)
  v_mfma_f32_32x32x16_bf16 v[64:79], a[176:179], v[240:243], v[64:79]
  ds_read_b64_tr_b16 a[200:201], v102 offset:24576
  ds_read_b64_tr_b16 a[202:203], v102 offset:25088
  v_mfma_f32_32x32x16_bf16 v[64:79], a[180:183], v[244:247], v[64:79]
  ds_read_b64_tr_b16 a[204:205], v102 offset:26624
  ds_read_b64_tr_b16 a[206:207], v102 offset:27136
  v_mfma_f32_32x32x16_bf16 v[64:79], a[184:187], v[248:251], v[64:79]
  ds_read_b64_tr_b16 a[176:177], v99 offset:32768
  ds_read_b64_tr_b16 a[178:179], v99 offset:33280
  v_mfma_f32_32x32x16_bf16 v[64:79], a[188:191], v[252:255], v[64:79]
  ds_read_b64_tr_b16 a[180:181], v99 offset:34816
  ds_read_b64_tr_b16 a[182:183], v99 offset:35328
  s_waitcnt lgkmcnt(4)
  v_mfma_f32_32x32x16_bf16 v[80:95], a[192:195], v[112:115], 0
  ds_read_b64_tr_b16 a[184:185], v102 offset:32768
  ds_read_b64_tr_b16 a[186:187], v102 offset:33280
  v_mfma_f32_32x32x16_bf16 v[80:95], a[196:199], v[116:119], v[80:95]
  ds_read_b64_tr_b16 a[188:189], v102 offset:34816
  ds_read_b64_tr_b16 a[190:191], v102 offset:35328
  v_mfma_f32_32x32x16_bf16 v[80:95], a[200:203], v[120:123], v[80:95]
  ds_read_b64_tr_b16 a[192:193], v99 offset:40960
  ds_read_b64_tr_b16 a[194:195], v99 offset:41472
  v_mfma_f32_32x32x16_bf16 v[80:95], a[204:207], v[124:127], v[80:95]
  ds_read_b64_tr_b16 a[196:197], v99 offset:43008
  ds_read_b64_tr_b16 a[198:199], v99 offset:43520
  v_cvt_pk_bf16_f32 v56, v64, v65
  s_waitcnt lgkmcnt(4)
  v_mfma_f32_32x32x16_bf16 v[80:95], a[176:179], v[128:131], v[80:95]
  ds_read_b64_tr_b16 a[200:201], v102 offset:40960
  ds_read_b64_tr_b16 a[202:203], v102 offset:41472
  v_cvt_pk_bf16_f32 v57, v66, v67
  v_mfma_f32_32x32x16_bf16 v[80:95], a[180:183], v[132:135], v[80:95]
  ds_read_b64_tr_b16 a[204:205], v102 offset:43008
  ds_read_b64_tr_b16 a[206:207], v102 offset:43520
  v_cvt_pk_bf16_f32 v58, v68, v69
  v_mfma_f32_32x32x16_bf16 v[80:95], a[184:187], v[136:139], v[80:95]
  s_waitcnt vmcnt(8)
  s_barrier
  ds_read_b64_tr_b16 a[176:177], v100 offset:0
  ds_read_b64_tr_b16 a[178:179], v100 offset:512
  v_cvt_pk_bf16_f32 v59, v70, v71
  v_mfma_f32_32x32x16_bf16 v[80:95], a[188:191], v[140:143], v[80:95]
  ds_read_b64_tr_b16 a[180:181], v100 offset:2048
  ds_read_b64_tr_b16 a[182:183], v100 offset:2560
  buffer_store_dwordx4 v[56:59], v18, s[32:35], s60 offen sc1
  s_waitcnt lgkmcnt(4)
  v_mfma_f32_32x32x16_bf16 v[80:95], a[192:195], v[144:147], v[80:95]
  ds_read_b64_tr_b16 a[184:185], v103 offset:0
  ds_read_b64_tr_b16 a[186:187], v103 offset:512
  v_cvt_pk_bf16_f32 v60, v72, v73
  v_cvt_pk_bf16_f32 v61, v74, v75
  v_mfma_f32_32x32x16_bf16 v[80:95], a[196:199], v[148:151], v[80:95]
  ds_read_b64_tr_b16 a[188:189], v103 offset:2048
  ds_read_b64_tr_b16 a[190:191], v103 offset:2560
  v_cvt_pk_bf16_f32 v62, v76, v77
  v_mfma_f32_32x32x16_bf16 v[80:95], a[200:203], v[152:155], v[80:95]
  ds_read_b64_tr_b16 a[192:193], v100 offset:8192
  ds_read_b64_tr_b16 a[194:195], v100 offset:8704
  v_cvt_pk_bf16_f32 v63, v78, v79
  v_mfma_f32_32x32x16_bf16 v[80:95], a[204:207], v[156:159], v[80:95]
  ds_read_b64_tr_b16 a[196:197], v100 offset:10240
  ds_read_b64_tr_b16 a[198:199], v100 offset:10752
  buffer_store_dwordx4 v[60:63], v18, s[32:35], s60 offen offset:256 sc1
  s_waitcnt lgkmcnt(4)
  v_mfma_f32_32x32x16_bf16 v[80:95], a[176:179], v[160:163], v[80:95]
  ds_read_b64_tr_b16 a[200:201], v103 offset:8192
  ds_read_b64_tr_b16 a[202:203], v103 offset:8704
  s_add_u32 s60, s60, 1024
  v_mfma_f32_32x32x16_bf16 v[80:95], a[180:183], v[164:167], v[80:95]
  ds_read_b64_tr_b16 a[204:205], v103 offset:10240
  ds_read_b64_tr_b16 a[206:207], v103 offset:10752
  buffer_load_dwordx4 v[64:67], v44, s[32:35], s54 offen sc1
  buffer_load_dwordx4 v[32:35], v45, s[28:31], s55 offen offset:0
  s_add_u32 s54, s54, 24576
  v_mfma_f32_32x32x16_bf16 v[80:95], a[184:187], v[168:171], v[80:95]
  ds_read_b64_tr_b16 a[176:177], v100 offset:16384
  ds_read_b64_tr_b16 a[178:179], v100 offset:16896
  buffer_load_dwordx4 v[68:71], v44, s[32:35], s54 offen sc1
  buffer_load_dwordx4 v[36:39], v45, s[28:31], s55 offen offset:384
  s_add_u32 s54, s54, 24576
  v_mfma_f32_32x32x16_bf16 v[80:95], a[188:191], v[172:175], v[80:95]
  ds_read_b64_tr_b16 a[180:181], v100 offset:18432
  ds_read_b64_tr_b16 a[182:183], v100 offset:18944
  buffer_load_dwordx4 v[72:75], v44, s[32:35], s54 offen sc1
  buffer_load_dwordx4 v[40:43], v45, s[28:31], s55 offen offset:768
  s_add_u32 s54, s54, 24576
  s_waitcnt lgkmcnt(4)
  v_mfma_f32_32x32x16_bf16 v[80:95], a[192:195], v[176:179], v[80:95]
  ds_read_b64_tr_b16 a[184:185], v103 offset:16384
  ds_read_b64_tr_b16 a[186:187], v103 offset:16896
  v_mfma_f32_32x32x16_bf16 v[80:95], a[196:199], v[180:183], v[80:95]
  ds_read_b64_tr_b16 a[188:189], v103 offset:18432
  ds_read_b64_tr_b16 a[190:191], v103 offset:18944
  v_mfma_f32_32x32x16_bf16 v[80:95], a[200:203], v[184:187], v[80:95]
  s_waitcnt vmcnt(8)
  s_barrier
  ds_read_b64_tr_b16 a[192:193], v100 offset:24576
  ds_read_b64_tr_b16 a[194:195], v100 offset:25088
  v_mfma_f32_32x32x16_bf16 v[80:95], a[204:207], v[188:191], v[80:95]
  ds_read_b64_tr_b16 a[196:197], v100 offset:26624
  ds_read_b64_tr_b16 a[198:199], v100 offset:27136
  s_waitcnt lgkmcnt(4)
  v_mfma_f32_32x32x16_bf16 v[80:95], a[176:179], v[192:195], v[80:95]
  ds_read_b64_tr_b16 a[200:201], v103 offset:24576
  ds_read_b64_tr_b16 a[202:203], v103 offset:25088
  v_mfma_f32_32x32x16_bf16 v[80:95], a[180:183], v[196:199], v[80:95]
  ds_read_b64_tr_b16 a[204:205], v103 offset:26624
  ds_read_b64_tr_b16 a[206:207], v103 offset:27136
  v_mfma_f32_32x32x16_bf16 v[80:95], a[184:187], v[200:203], v[80:95]
  ds_read_b64_tr_b16 a[176:177], v100 offset:32768
  ds_read_b64_tr_b16 a[178:179], v100 offset:33280
  v_mfma_f32_32x32x16_bf16 v[80:95], a[188:191], v[204:207], v[80:95]
  ds_read_b64_tr_b16 a[180:181], v100 offset:34816
  ds_read_b64_tr_b16 a[182:183], v100 offset:35328
  s_waitcnt lgkmcnt(4)
  v_mfma_f32_32x32x16_bf16 v[80:95], a[192:195], v[208:211], v[80:95]
  ds_read_b64_tr_b16 a[184:185], v103 offset:32768
  ds_read_b64_tr_b16 a[186:187], v103 offset:33280
  v_mfma_f32_32x32x16_bf16 v[80:95], a[196:199], v[212:215], v[80:95]
  ds_read_b64_tr_b16 a[188:189], v103 offset:34816
  ds_read_b64_tr_b16 a[190:191], v103 offset:35328
  v_mfma_f32_32x32x16_bf16 v[80:95], a[200:203], v[216:219], v[80:95]
  ds_read_b64_tr_b16 a[192:193], v100 offset:40960
  ds_read_b64_tr_b16 a[194:195], v100 offset:41472
  v_mfma_f32_32x32x16_bf16 v[80:95], a[204:207], v[220:223], v[80:95]
  ds_read_b64_tr_b16 a[196:197], v100 offset:43008
  ds_read_b64_tr_b16 a[198:199], v100 offset:43520
  s_waitcnt lgkmcnt(4)
  v_mfma_f32_32x32x16_bf16 v[80:95], a[176:179], v[224:227], v[80:95]
  ds_read_b64_tr_b16 a[200:201], v103 offset:40960
  ds_read_b64_tr_b16 a[202:203], v103 offset:41472
  s_sub_u32 s67, s68, s53
  s_mov_b64 exec, 0xff
  buffer_load_dword v97, v19, s[32:35], s67 offen sc1
  s_mov_b64 exec, -1
  v_mfma_f32_32x32x16_bf16 v[80:95], a[180:183], v[228:231], v[80:95]
  ds_read_b64_tr_b16 a[204:205], v103 offset:43008
  ds_read_b64_tr_b16 a[206:207], v103 offset:43520
  v_mfma_f32_32x32x16_bf16 v[80:95], a[184:187], v[232:235], v[80:95]
  v_mfma_f32_32x32x16_bf16 v[80:95], a[188:191], v[236:239], v[80:95]
  s_waitcnt lgkmcnt(0)
  v_mfma_f32_32x32x16_bf16 v[80:95], a[192:195], v[240:243], v[80:95]
  v_mfma_f32_32x32x16_bf16 v[80:95], a[196:199], v[244:247], v[80:95]
  v_mfma_f32_32x32x16_bf16 v[80:95], a[200:203], v[248:251], v[80:95]
  v_mfma_f32_32x32x16_bf16 v[80:95], a[204:207], v[252:255], v[80:95]
  s_nop 11
  v_cvt_pk_bf16_f32 v56, v80, v81
  v_cvt_pk_bf16_f32 v57, v82, v83
  v_cvt_pk_bf16_f32 v58, v84, v85
  v_cvt_pk_bf16_f32 v59, v86, v87
  buffer_store_dwordx4 v[56:59], v18, s[32:35], s60 offen sc1
  v_cvt_pk_bf16_f32 v60, v88, v89
  v_cvt_pk_bf16_f32 v61, v90, v91
  v_cvt_pk_bf16_f32 v62, v92, v93
  v_cvt_pk_bf16_f32 v63, v94, v95
  buffer_store_dwordx4 v[60:63], v18, s[32:35], s60 offen offset:256 sc1
  s_add_u32 s60, s60, 1024
  s_waitcnt vmcnt(0)
  s_mul_i32 s68, s49, 196608
  s_lshl_b32 s69, s44, 10
  s_add_u32 s68, s68, s69
  s_add_u32 s68, s68, 98304
  s_lshl_b32 s69, s45, 7
  s_add_u32 s68, s68, s69
  s_barrier
  s_cmp_lg_u32 s46, 0
  s_cbranch_scc1 Lsig8
  s_mov_b32 exec_lo, 1
  s_mov_b32 exec_hi, 0
  v_mov_b32 v62, 1
  buffer_store_dword v62, v19, s[32:35], s68 offen sc1
  s_mov_b64 exec, -1
Lsig8:
  s_cmp_eq_u32 s46, 3
  s_cbranch_scc1 Lw3
  s_mov_b32 exec_lo, 255
  s_mov_b32 exec_hi, 0
  v_cmp_ne_u32 vcc, 1, v97
  s_nop 1
  s_cbranch_vccz Lq9
Lp9:
  buffer_load_dword v62, v19, s[32:35], s67 offen sc1
  s_waitcnt vmcnt(0)
  v_cmp_ne_u32 vcc, 1, v62
  s_cmp_eq_u32 s51, 0
  s_cbranch_scc1 Lq9
  s_sub_u32 s51, s51, 1
  s_cbranch_vccnz Lp9
Lq9:
  s_mov_b64 exec, -1
  buffer_load_dwordx4 v[112:115], v1, s[32:35], s56 offen offset:0 sc1
  buffer_load_dwordx4 v[116:119], v1, s[32:35], s56 offen offset:3072 sc1
  s_add_u32 s56, s56, 9216
  buffer_load_dwordx4 v[120:123], v1, s[32:35], s56 offen offset:0 sc1
  buffer_load_dwordx4 v[124:127], v1, s[32:35], s56 offen offset:3072 sc1
  s_add_u32 s56, s56, 9216
  buffer_load_dwordx4 v[128:131], v1, s[32:35], s56 offen offset:0 sc1
  buffer_load_dwordx4 v[132:135], v1, s[32:35], s56 offen offset:3072 sc1
  s_add_u32 s56, s56, 9216
  buffer_load_dwordx4 v[136:139], v1, s[32:35], s56 offen offset:0 sc1
  buffer_load_dwordx4 v[140:143], v1, s[32:35], s56 offen offset:3072 sc1
  s_add_u32 s56, s56, 9216
  buffer_load_dwordx4 v[144:147], v1, s[32:35], s56 offen offset:0 sc1
  buffer_load_dwordx4 v[148:151], v1, s[32:35], s56 offen offset:3072 sc1
  s_add_u32 s56, s56, 9216
  buffer_load_dwordx4 v[152:155], v1, s[32:35], s56 offen offset:0 sc1
  buffer_load_dwordx4 v[156:159], v1, s[32:35], s56 offen offset:3072 sc1
  s_add_u32 s56, s56, 9216
  buffer_load_dwordx4 v[160:163], v1, s[32:35], s56 offen offset:0 sc1
  buffer_load_dwordx4 v[164:167], v1, s[32:35], s56 offen offset:3072 sc1
  s_add_u32 s56, s56, 9216
  buffer_load_dwordx4 v[168:171], v1, s[32:35], s56 offen offset:0 sc1
  buffer_load_dwordx4 v[172:175], v1, s[32:35], s56 offen offset:3072 sc1
  s_add_u32 s56, s56, 9216
  s_sub_u32 s56, s56, 67584
  v_lshlrev_b32 v88, 16, v32
  v_and_b32 v89, 0xffff0000, v32
  v_lshlrev_b32 v90, 16, v33
  v_and_b32 v91, 0xffff0000, v33
  v_lshlrev_b32 v92, 16, v34
  v_and_b32 v93, 0xffff0000, v34
  v_lshlrev_b32 v94, 16, v35
  v_and_b32 v95, 0xffff0000, v35
  v_lshlrev_b32 v96, 16, v36
  v_and_b32 v97, 0xffff0000, v36
  v_lshlrev_b32 v98, 16, v37
  v_and_b32 v99, 0xffff0000, v37
  v_lshlrev_b32 v100, 16, v38
  v_and_b32 v101, 0xffff0000, v38
  v_lshlrev_b32 v102, 16, v39
  v_and_b32 v103, 0xffff0000, v39
  v_lshlrev_b32 v104, 16, v40
  v_and_b32 v105, 0xffff0000, v40
  v_lshlrev_b32 v106, 16, v41
  v_and_b32 v107, 0xffff0000, v41
  v_lshlrev_b32 v108, 16, v42
  v_and_b32 v109, 0xffff0000, v42
  v_lshlrev_b32 v110, 16, v43
  v_and_b32 v111, 0xffff0000, v43
  v_dot2_f32_bf16 v88, v64, s58, v88
  v_dot2_f32_bf16 v90, v65, s58, v90
  v_dot2_f32_bf16 v92, v66, s58, v92
  v_dot2_f32_bf16 v94, v67, s58, v94
  v_dot2_f32_bf16 v96, v68, s58, v96
  v_dot2_f32_bf16 v98, v69, s58, v98
  v_dot2_f32_bf16 v100, v70, s58, v100
  v_dot2_f32_bf16 v102, v71, s58, v102
  v_dot2_f32_bf16 v104, v72, s58, v104
  v_dot2_f32_bf16 v106, v73, s58, v106
  v_dot2_f32_bf16 v108, v74, s58, v108
  v_dot2_f32_bf16 v110, v75, s58, v110
  v_dot2_f32_bf16 v89, v64, s59, v89
  v_dot2_f32_bf16 v91, v65, s59, v91
  v_dot2_f32_bf16 v93, v66, s59, v93
  v_dot2_f32_bf16 v95, v67, s59, v95
  v_dot2_f32_bf16 v97, v68, s59, v97
  v_dot2_f32_bf16 v99, v69, s59, v99
  v_dot2_f32_bf16 v101, v70, s59, v101
  v_dot2_f32_bf16 v103, v71, s59, v103
  v_dot2_f32_bf16 v105, v72, s59, v105
  v_dot2_f32_bf16 v107, v73, s59, v107
  v_dot2_f32_bf16 v109, v74, s59, v109
  v_dot2_f32_bf16 v111, v75, s59, v111
  s_mul_i32 s67, s49, 196608
  s_lshl_b32 s69, s44, 10
  s_add_u32 s67, s67, s69
  s_add_u32 s67, s67, 98304
  s_mov_b32 exec_lo, 255
  s_mov_b32 exec_hi, 0
Lp10:
  buffer_load_dword v62, v19, s[32:35], s67 offen sc1
  s_waitcnt vmcnt(0)
  v_cmp_ne_u32 vcc, 1, v62
  s_cmp_eq_u32 s51, 0
  s_cbranch_scc1 Lq10
  s_sub_u32 s51, s51, 1
  s_cbranch_vccnz Lp10
Lq10:
  s_mov_b64 exec, -1
  buffer_load_dwordx4 v[176:179], v1, s[32:35], s56 offen sc1
  s_add_u32 s56, s56, 9216
  buffer_load_dwordx4 v[180:183], v1, s[32:35], s56 offen sc1
  s_add_u32 s56, s56, 9216
  buffer_load_dwordx4 v[184:187], v1, s[32:35], s56 offen sc1
  s_add_u32 s56, s56, 9216
  buffer_load_dwordx4 v[188:191], v1, s[32:35], s56 offen sc1
  s_add_u32 s56, s56, 9216
  buffer_load_dwordx4 v[192:195], v1, s[32:35], s56 offen sc1
  s_add_u32 s56, s56, 9216
  buffer_load_dwordx4 v[196:199], v1, s[32:35], s56 offen sc1
  s_add_u32 s56, s56, 9216
  buffer_load_dwordx4 v[200:203], v1, s[32:35], s56 offen sc1
  s_add_u32 s56, s56, 9216
  buffer_load_dwordx4 v[204:207], v1, s[32:35], s56 offen sc1
  s_add_u32 s56, s56, 9216
  v_dot2_f32_bf16 v88, v112, s58, v88
  v_dot2_f32_bf16 v90, v113, s58, v90
  v_dot2_f32_bf16 v92, v114, s58, v92
  v_dot2_f32_bf16 v94, v115, s58, v94
  v_dot2_f32_bf16 v96, v116, s58, v96
  v_dot2_f32_bf16 v98, v117, s58, v98
  v_dot2_f32_bf16 v100, v118, s58, v100
  v_dot2_f32_bf16 v102, v119, s58, v102
  v_dot2_f32_bf16 v89, v112, s59, v89
  v_dot2_f32_bf16 v91, v113, s59, v91
  v_dot2_f32_bf16 v93, v114, s59, v93
  v_dot2_f32_bf16 v95, v115, s59, v95
  v_dot2_f32_bf16 v97, v116, s59, v97
  v_dot2_f32_bf16 v99, v117, s59, v99
  v_dot2_f32_bf16 v101, v118, s59, v101
  v_dot2_f32_bf16 v103, v119, s59, v103
  v_dot2_f32_bf16 v88, v120, s58, v88
  v_dot2_f32_bf16 v90, v121, s58, v90
  v_dot2_f32_bf16 v92, v122, s58, v92
  v_dot2_f32_bf16 v94, v123, s58, v94
  v_dot2_f32_bf16 v96, v124, s58, v96
  v_dot2_f32_bf16 v98, v125, s58, v98
  v_dot2_f32_bf16 v100, v126, s58, v100
  v_dot2_f32_bf16 v102, v127, s58, v102
  v_dot2_f32_bf16 v89, v120, s59, v89
  v_dot2_f32_bf16 v91, v121, s59, v91
  v_dot2_f32_bf16 v93, v122, s59, v93
  v_dot2_f32_bf16 v95, v123, s59, v95
  v_dot2_f32_bf16 v97, v124, s59, v97
  v_dot2_f32_bf16 v99, v125, s59, v99
  v_dot2_f32_bf16 v101, v126, s59, v101
  v_dot2_f32_bf16 v103, v127, s59, v103
  v_dot2_f32_bf16 v88, v128, s58, v88
  v_dot2_f32_bf16 v90, v129, s58, v90
  v_dot2_f32_bf16 v92, v130, s58, v92
  v_dot2_f32_bf16 v94, v131, s58, v94
  v_dot2_f32_bf16 v96, v132, s58, v96
  v_dot2_f32_bf16 v98, v133, s58, v98
  v_dot2_f32_bf16 v100, v134, s58, v100
  v_dot2_f32_bf16 v102, v135, s58, v102
  v_dot2_f32_bf16 v89, v128, s59, v89
  v_dot2_f32_bf16 v91, v129, s59, v91
  v_dot2_f32_bf16 v93, v130, s59, v93
  v_dot2_f32_bf16 v95, v131, s59, v95
  v_dot2_f32_bf16 v97, v132, s59, v97
  v_dot2_f32_bf16 v99, v133, s59, v99
  v_dot2_f32_bf16 v101, v134, s59, v101
  v_dot2_f32_bf16 v103, v135, s59, v103
  v_dot2_f32_bf16 v88, v136, s58, v88
  v_dot2_f32_bf16 v90, v137, s58, v90
  v_dot2_f32_bf16 v92, v138, s58, v92
  v_dot2_f32_bf16 v94, v139, s58, v94
  v_dot2_f32_bf16 v96, v140, s58, v96
  v_dot2_f32_bf16 v98, v141, s58, v98
  v_dot2_f32_bf16 v100, v142, s58, v100
  v_dot2_f32_bf16 v102, v143, s58, v102
  v_dot2_f32_bf16 v89, v136, s59, v89
  v_dot2_f32_bf16 v91, v137, s59, v91
  v_dot2_f32_bf16 v93, v138, s59, v93
  v_dot2_f32_bf16 v95, v139, s59, v95
  v_dot2_f32_bf16 v97, v140, s59, v97
  v_dot2_f32_bf16 v99, v141, s59, v99
  v_dot2_f32_bf16 v101, v142, s59, v101
  v_dot2_f32_bf16 v103, v143, s59, v103
  v_dot2_f32_bf16 v88, v144, s58, v88
  v_dot2_f32_bf16 v90, v145, s58, v90
  v_dot2_f32_bf16 v92, v146, s58, v92
  v_dot2_f32_bf16 v94, v147, s58, v94
  v_dot2_f32_bf16 v96, v148, s58, v96
  v_dot2_f32_bf16 v98, v149, s58, v98
  v_dot2_f32_bf16 v100, v150, s58, v100
  v_dot2_f32_bf16 v102, v151, s58, v102
  v_dot2_f32_bf16 v89, v144, s59, v89
  v_dot2_f32_bf16 v91, v145, s59, v91
  v_dot2_f32_bf16 v93, v146, s59, v93
  v_dot2_f32_bf16 v95, v147, s59, v95
  v_dot2_f32_bf16 v97, v148, s59, v97
  v_dot2_f32_bf16 v99, v149, s59, v99
  v_dot2_f32_bf16 v101, v150, s59, v101
  v_dot2_f32_bf16 v103, v151, s59, v103
  v_dot2_f32_bf16 v88, v152, s58, v88
  v_dot2_f32_bf16 v90, v153, s58, v90
  v_dot2_f32_bf16 v92, v154, s58, v92
  v_dot2_f32_bf16 v94, v155, s58, v94
  v_dot2_f32_bf16 v96, v156, s58, v96
  v_dot2_f32_bf16 v98, v157, s58, v98
  v_dot2_f32_bf16 v100, v158, s58, v100
  v_dot2_f32_bf16 v102, v159, s58, v102
  v_dot2_f32_bf16 v89, v152, s59, v89
  v_dot2_f32_bf16 v91, v153, s59, v91
  v_dot2_f32_bf16 v93, v154, s59, v93
  v_dot2_f32_bf16 v95, v155, s59, v95
  v_dot2_f32_bf16 v97, v156, s59, v97
  v_dot2_f32_bf16 v99, v157, s59, v99
  v_dot2_f32_bf16 v101, v158, s59, v101
  v_dot2_f32_bf16 v103, v159, s59, v103
  v_dot2_f32_bf16 v88, v160, s58, v88
  v_dot2_f32_bf16 v90, v161, s58, v90
  v_dot2_f32_bf16 v92, v162, s58, v92
  v_dot2_f32_bf16 v94, v163, s58, v94
  v_dot2_f32_bf16 v96, v164, s58, v96
  v_dot2_f32_bf16 v98, v165, s58, v98
  v_dot2_f32_bf16 v100, v166, s58, v100
  v_dot2_f32_bf16 v102, v167, s58, v102
  v_dot2_f32_bf16 v89, v160, s59, v89
  v_dot2_f32_bf16 v91, v161, s59, v91
  v_dot2_f32_bf16 v93, v162, s59, v93
  v_dot2_f32_bf16 v95, v163, s59, v95
  v_dot2_f32_bf16 v97, v164, s59, v97
  v_dot2_f32_bf16 v99, v165, s59, v99
  v_dot2_f32_bf16 v101, v166, s59, v101
  v_dot2_f32_bf16 v103, v167, s59, v103
  v_dot2_f32_bf16 v88, v168, s58, v88
  v_dot2_f32_bf16 v90, v169, s58, v90
  v_dot2_f32_bf16 v92, v170, s58, v92
  v_dot2_f32_bf16 v94, v171, s58, v94
  v_dot2_f32_bf16 v96, v172, s58, v96
  v_dot2_f32_bf16 v98, v173, s58, v98
  v_dot2_f32_bf16 v100, v174, s58, v100
  v_dot2_f32_bf16 v102, v175, s58, v102
  v_dot2_f32_bf16 v89, v168, s59, v89
  v_dot2_f32_bf16 v91, v169, s59, v91
  v_dot2_f32_bf16 v93, v170, s59, v93
  v_dot2_f32_bf16 v95, v171, s59, v95
  v_dot2_f32_bf16 v97, v172, s59, v97
  v_dot2_f32_bf16 v99, v173, s59, v99
  v_dot2_f32_bf16 v101, v174, s59, v101
  v_dot2_f32_bf16 v103, v175, s59, v103
LrC:
  s_waitcnt vmcnt(7)
  v_dot2_f32_bf16 v104, v176, s58, v104
  v_dot2_f32_bf16 v106, v177, s58, v106
  v_dot2_f32_bf16 v108, v178, s58, v108
  v_dot2_f32_bf16 v110, v179, s58, v110
  v_dot2_f32_bf16 v105, v176, s59, v105
  v_dot2_f32_bf16 v107, v177, s59, v107
  v_dot2_f32_bf16 v109, v178, s59, v109
  v_dot2_f32_bf16 v111, v179, s59, v111
  s_waitcnt vmcnt(6)
  v_dot2_f32_bf16 v104, v180, s58, v104
  v_dot2_f32_bf16 v106, v181, s58, v106
  v_dot2_f32_bf16 v108, v182, s58, v108
  v_dot2_f32_bf16 v110, v183, s58, v110
  v_dot2_f32_bf16 v105, v180, s59, v105
  v_dot2_f32_bf16 v107, v181, s59, v107
  v_dot2_f32_bf16 v109, v182, s59, v109
  v_dot2_f32_bf16 v111, v183, s59, v111
  s_waitcnt vmcnt(5)
  v_dot2_f32_bf16 v104, v184, s58, v104
  v_dot2_f32_bf16 v106, v185, s58, v106
  v_dot2_f32_bf16 v108, v186, s58, v108
  v_dot2_f32_bf16 v110, v187, s58, v110
  v_dot2_f32_bf16 v105, v184, s59, v105
  v_dot2_f32_bf16 v107, v185, s59, v107
  v_dot2_f32_bf16 v109, v186, s59, v109
  v_dot2_f32_bf16 v111, v187, s59, v111
  s_waitcnt vmcnt(4)
  v_dot2_f32_bf16 v104, v188, s58, v104
  v_dot2_f32_bf16 v106, v189, s58, v106
  v_dot2_f32_bf16 v108, v190, s58, v108
  v_dot2_f32_bf16 v110, v191, s58, v110
  v_dot2_f32_bf16 v105, v188, s59, v105
  v_dot2_f32_bf16 v107, v189, s59, v107
  v_dot2_f32_bf16 v109, v190, s59, v109
  v_dot2_f32_bf16 v111, v191, s59, v111
  s_waitcnt vmcnt(3)
  v_dot2_f32_bf16 v104, v192, s58, v104
  v_dot2_f32_bf16 v106, v193, s58, v106
  v_dot2_f32_bf16 v108, v194, s58, v108
  v_dot2_f32_bf16 v110, v195, s58, v110
  v_dot2_f32_bf16 v105, v192, s59, v105
  v_dot2_f32_bf16 v107, v193, s59, v107
  v_dot2_f32_bf16 v109, v194, s59, v109
  v_dot2_f32_bf16 v111, v195, s59, v111
  s_waitcnt vmcnt(2)
  v_dot2_f32_bf16 v104, v196, s58, v104
  v_dot2_f32_bf16 v106, v197, s58, v106
  v_dot2_f32_bf16 v108, v198, s58, v108
  v_dot2_f32_bf16 v110, v199, s58, v110
  v_dot2_f32_bf16 v105, v196, s59, v105
  v_dot2_f32_bf16 v107, v197, s59, v107
  v_dot2_f32_bf16 v109, v198, s59, v109
  v_dot2_f32_bf16 v111, v199, s59, v111
  s_waitcnt vmcnt(1)
  v_dot2_f32_bf16 v104, v200, s58, v104
  v_dot2_f32_bf16 v106, v201, s58, v106
  v_dot2_f32_bf16 v108, v202, s58, v108
  v_dot2_f32_bf16 v110, v203, s58, v110
  v_dot2_f32_bf16 v105, v200, s59, v105
  v_dot2_f32_bf16 v107, v201, s59, v107
  v_dot2_f32_bf16 v109, v202, s59, v109
  v_dot2_f32_bf16 v111, v203, s59, v111
  s_waitcnt vmcnt(0)
  v_dot2_f32_bf16 v104, v204, s58, v104
  v_dot2_f32_bf16 v106, v205, s58, v106
  v_dot2_f32_bf16 v108, v206, s58, v108
  v_dot2_f32_bf16 v110, v207, s58, v110
  v_dot2_f32_bf16 v105, v204, s59, v105
  v_dot2_f32_bf16 v107, v205, s59, v107
  v_dot2_f32_bf16 v109, v206, s59, v109
  v_dot2_f32_bf16 v111, v207, s59, v111
  v_cvt_pk_bf16_f32 v64, v88, v89
  v_cvt_pk_bf16_f32 v65, v90, v91
  v_cvt_pk_bf16_f32 v66, v92, v93
  v_cvt_pk_bf16_f32 v67, v94, v95
  v_cvt_pk_bf16_f32 v68, v96, v97
  v_cvt_pk_bf16_f32 v69, v98, v99
  v_cvt_pk_bf16_f32 v70, v100, v101
  v_cvt_pk_bf16_f32 v71, v102, v103
  v_cvt_pk_bf16_f32 v72, v104, v105
  v_cvt_pk_bf16_f32 v73, v106, v107
  v_cvt_pk_bf16_f32 v74, v108, v109
  v_cvt_pk_bf16_f32 v75, v110, v111
  s_cmp_eq_u32 s49, 0
  s_cbranch_scc1 Lrs2
  buffer_store_dwordx4 v[64:67], v46, s[36:39], s57 offen offset:0
  buffer_store_dwordx4 v[68:71], v46, s[36:39], s57 offen offset:384
  buffer_store_dwordx4 v[72:75], v46, s[36:39], s57 offen offset:768
  s_branch Lfin
Lrs2:
  buffer_store_dwordx4 v[64:67], v46, s[36:39], s57 offen offset:0 sc1
  buffer_store_dwordx4 v[68:71], v46, s[36:39], s57 offen offset:384 sc1
  buffer_store_dwordx4 v[72:75], v46, s[36:39], s57 offen offset:768 sc1
  v_add_f32 v56, v88, v89
  v_mul_f32 v57, v88, v88
  v_fmac_f32 v57, v89, v89
  v_add_f32 v76, v90, v91
  v_mul_f32 v77, v90, v90
  v_fmac_f32 v77, v91, v91
  v_add_f32 v76, v76, v92
  v_fmac_f32 v77, v92, v92
  v_add_f32 v56, v56, v93
  v_fmac_f32 v57, v93, v93
  v_add_f32 v76, v76, v94
  v_fmac_f32 v77, v94, v94
  v_add_f32 v56, v56, v95
  v_fmac_f32 v57, v95, v95
  v_add_f32 v76, v76, v96
  v_fmac_f32 v77, v96, v96
  v_add_f32 v56, v56, v97
  v_fmac_f32 v57, v97, v97
  v_add_f32 v76, v76, v98
  v_fmac_f32 v77, v98, v98
  v_add_f32 v56, v56, v99
  v_fmac_f32 v57, v99, v99
  v_add_f32 v76, v76, v100
  v_fmac_f32 v77, v100, v100
  v_add_f32 v56, v56, v101
  v_fmac_f32 v57, v101, v101
  v_add_f32 v76, v76, v102
  v_fmac_f32 v77, v102, v102
  v_add_f32 v56, v56, v103
  v_fmac_f32 v57, v103, v103
  v_add_f32 v76, v76, v104
  v_fmac_f32 v77, v104, v104
  v_add_f32 v56, v56, v105
  v_fmac_f32 v57, v105, v105
  v_add_f32 v76, v76, v106
  v_fmac_f32 v77, v106, v106
  v_add_f32 v56, v56, v107
  v_fmac_f32 v57, v107, v107
  v_add_f32 v76, v76, v108
  v_fmac_f32 v77, v108, v108
  v_add_f32 v56, v56, v109
  v_fmac_f32 v57, v109, v109
  v_add_f32 v76, v76, v110
  v_fmac_f32 v77, v110, v110
  v_add_f32 v56, v56, v111
  v_fmac_f32 v57, v111, v111
  v_add_f32 v56, v56, v76
  v_add_f32 v57, v57, v77
  s_nop 0
  v_add_f32_dpp v56, v56, v56 row_ror:8 row_mask:0xf bank_mask:0xf
  v_add_f32_dpp v57, v57, v57 row_ror:8 row_mask:0xf bank_mask:0xf
  v_mov_b32 v76, v56
  v_mov_b32 v77, v57
  s_nop 0
  v_permlane16_swap_b32 v56, v76
  v_permlane16_swap_b32 v57, v77
  v_add_f32 v56, v56, v76
  v_add_f32 v57, v57, v77
  v_mov_b32 v76, v56
  v_mov_b32 v77, v57
  s_nop 0
  v_permlane32_swap_b32 v56, v76
  v_permlane32_swap_b32 v57, v77
  v_add_f32 v56, v56, v76
  v_add_f32 v57, v57, v77
  v_lshrrev_b32 v76, 1, v1
  v_and_b32 v76, 56, v76
  v_add_u32 v76, 163584, v76
  s_lshl_b32 s54, s46, 6
  v_add_u32 v77, s54, v76
  ds_write_b64 v77, v[56:57]
  s_waitcnt lgkmcnt(0)
  s_barrier
  ds_read_b64 v[78:79], v76
  ds_read_b64 v[80:81], v76 offset:64
  ds_read_b64 v[82:83], v76 offset:128
  s_mul_i32 s54, s44, 73728
  s_mul_i32 s55, s46, 8192
  s_add_u32 s54, s54, s55
  s_lshl_b32 s55, s45, 7
  s_add_u32 s54, s54, s55
  s_add_u32 s54, s54, 46137344
  s_mul_i32 s68, s49, 196608
  s_lshl_b32 s69, s44, 10
  s_add_u32 s68, s68, s69
  s_add_u32 s68, s68, 131072
  s_lshl_b32 s69, s45, 7
  s_add_u32 s68, s68, s69
  s_lshl_b32 s55, s46, 2
  s_add_u32 s68, s68, s55
  s_waitcnt lgkmcnt(0)
  v_add_f32 v56, v78, v80
  v_add_f32 v57, v79, v81
  v_add_f32 v56, v56, v82
  v_add_f32 v57, v57, v83
  v_mul_f32 v56, 0x3ae38e39, v56
  v_mul_f32 v57, 0x3ae38e39, v57
  v_fma_f32 v57, -v56, v56, v57
  v_max_f32 v57, 0, v57
  v_add_f32 v57, 0x3727c5ac, v57
  v_rsq_f32 v57, v57
  s_nop 0
  v_mul_f32 v56, v56, v57
  v_fma_f32 v88, v88, v57, -v56
  v_fma_f32 v89, v89, v57, -v56
  v_fma_f32 v90, v90, v57, -v56
  v_fma_f32 v91, v91, v57, -v56
  v_fma_f32 v92, v92, v57, -v56
  v_fma_f32 v93, v93, v57, -v56
  v_fma_f32 v94, v94, v57, -v56
  v_fma_f32 v95, v95, v57, -v56
  v_cvt_pk_bf16_f32 v76, v88, v89
  v_cvt_pk_bf16_f32 v77, v90, v91
  v_cvt_pk_bf16_f32 v78, v92, v93
  v_cvt_pk_bf16_f32 v79, v94, v95
  buffer_store_dwordx4 v[76:79], v44, s[32:35], s54 offen sc1
  s_add_u32 s54, s54, 24576
  v_fma_f32 v96, v96, v57, -v56
  v_fma_f32 v97, v97, v57, -v56
  v_fma_f32 v98, v98, v57, -v56
  v_fma_f32 v99, v99, v57, -v56
  v_fma_f32 v100, v100, v57, -v56
  v_fma_f32 v101, v101, v57, -v56
  v_fma_f32 v102, v102, v57, -v56
  v_fma_f32 v103, v103, v57, -v56
  v_cvt_pk_bf16_f32 v80, v96, v97
  v_cvt_pk_bf16_f32 v81, v98, v99
  v_cvt_pk_bf16_f32 v82, v100, v101
  v_cvt_pk_bf16_f32 v83, v102, v103
  buffer_store_dwordx4 v[80:83], v44, s[32:35], s54 offen sc1
  s_add_u32 s54, s54, 24576
  v_fma_f32 v104, v104, v57, -v56
  v_fma_f32 v105, v105, v57, -v56
  v_fma_f32 v106, v106, v57, -v56
  v_fma_f32 v107, v107, v57, -v56
  v_fma_f32 v108, v108, v57, -v56
  v_fma_f32 v109, v109, v57, -v56
  v_fma_f32 v110, v110, v57, -v56
  v_fma_f32 v111, v111, v57, -v56
  v_cvt_pk_bf16_f32 v84, v104, v105
  v_cvt_pk_bf16_f32 v85, v106, v107
  v_cvt_pk_bf16_f32 v86, v108, v109
  v_cvt_pk_bf16_f32 v87, v110, v111
  buffer_store_dwordx4 v[84:87], v44, s[32:35], s54 offen sc1
  s_add_u32 s54, s54, 24576
  s_waitcnt vmcnt(0)
  s_mov_b32 exec_lo, 1
  s_mov_b32 exec_hi, 0
  v_mov_b32 v62, 1
  buffer_store_dword v62, v19, s[32:35], s68 offen sc1
  s_mov_b64 exec, -1
  s_branch Lw3e
Lw3:
  s_cmp_eq_u32 s49, 1
  s_cbranch_scc1 Lfin
  s_mul_i32 s54, s45, 144
  s_mov_b32 m0, 0
  s_nop 0
  buffer_load_dwordx4 v24, s[8:11], s54 offen offset:0 lds
  buffer_load_dwordx4 v25, s[8:11], s54 offen offset:1024 lds
  buffer_load_dwordx4 v26, s[8:11], s54 offen offset:2048 lds
  buffer_load_dwordx4 v27, s[8:11], s54 offen offset:3072 lds
  s_mov_b32 m0, 4096
  s_nop 0
  buffer_load_dwordx4 v28, s[8:11], s54 offen offset:0 lds
  buffer_load_dwordx4 v29, s[8:11], s54 offen offset:1024 lds
  buffer_load_dwordx4 v30, s[8:11], s54 offen offset:2048 lds
  s_add_u32 s54, s54, 55296
  s_mov_b32 m0, 7168
  s_nop 0
  buffer_load_dwordx4 v24, s[8:11], s54 offen offset:0 lds
  buffer_load_dwordx4 v25, s[8:11], s54 offen offset:1024 lds
  buffer_load_dwordx4 v26, s[8:11], s54 offen offset:2048 lds
  buffer_load_dwordx4 v27, s[8:11], s54 offen offset:3072 lds
  s_mov_b32 m0, 11264
  s_nop 0
  buffer_load_dwordx4 v28, s[8:11], s54 offen offset:0 lds
  buffer_load_dwordx4 v29, s[8:11], s54 offen offset:1024 lds
  buffer_load_dwordx4 v30, s[8:11], s54 offen offset:2048 lds
  s_add_u32 s54, s54, 55296
  s_mov_b32 m0, 14336
  s_nop 0
  buffer_load_dwordx4 v24, s[8:11], s54 offen offset:0 lds
  buffer_load_dwordx4 v25, s[8:11], s54 offen offset:1024 lds
  buffer_load_dwordx4 v26, s[8:11], s54 offen offset:2048 lds
  buffer_load_dwordx4 v27, s[8:11], s54 offen offset:3072 lds
  s_mov_b32 m0, 18432
  s_nop 0
  buffer_load_dwordx4 v28, s[8:11], s54 offen offset:0 lds
  buffer_load_dwordx4 v29, s[8:11], s54 offen offset:1024 lds
  buffer_load_dwordx4 v30, s[8:11], s54 offen offset:2048 lds
  s_add_u32 s54, s54, 55296
  s_mov_b32 m0, 21504
  s_nop 0
  buffer_load_dwordx4 v24, s[8:11], s54 offen offset:0 lds
  buffer_load_dwordx4 v25, s[8:11], s54 offen offset:1024 lds
  buffer_load_dwordx4 v26, s[8:11], s54 offen offset:2048 lds
  buffer_load_dwordx4 v27, s[8:11], s54 offen offset:3072 lds
  s_mov_b32 m0, 25600
  s_nop 0
  buffer_load_dwordx4 v28, s[8:11], s54 offen offset:0 lds
  buffer_load_dwordx4 v29, s[8:11], s54 offen offset:1024 lds
  buffer_load_dwordx4 v30, s[8:11], s54 offen offset:2048 lds
  s_add_u32 s54, s54, 55296
  s_waitcnt vmcnt(28)
  s_mov_b32 m0, 28672
  s_nop 0
  buffer_load_dwordx4 v24, s[8:11], s54 offen offset:0 lds
  buffer_load_dwordx4 v25, s[8:11], s54 offen offset:1024 lds
  buffer_load_dwordx4 v26, s[8:11], s54 offen offset:2048 lds
  buffer_load_dwordx4 v27, s[8:11], s54 offen offset:3072 lds
  s_mov_b32 m0, 32768
  s_nop 0
  buffer_load_dwordx4 v28, s[8:11], s54 offen offset:0 lds
  buffer_load_dwordx4 v29, s[8:11], s54 offen offset:1024 lds
  buffer_load_dwordx4 v30, s[8:11], s54 offen offset:2048 lds
  s_add_u32 s54, s54, 55296
  s_mov_b32 m0, 35840
  s_nop 0
  buffer_load_dwordx4 v24, s[8:11], s54 offen offset:0 lds
  buffer_load_dwordx4 v25, s[8:11], s54 offen offset:1024 lds
  buffer_load_dwordx4 v26, s[8:11], s54 offen offset:2048 lds
  buffer_load_dwordx4 v27, s[8:11], s54 offen offset:3072 lds
  s_mov_b32 m0, 39936
  s_nop 0
  buffer_load_dwordx4 v28, s[8:11], s54 offen offset:0 lds
  buffer_load_dwordx4 v29, s[8:11], s54 offen offset:1024 lds
  buffer_load_dwordx4 v30, s[8:11], s54 offen offset:2048 lds
  s_add_u32 s54, s54, 55296
  s_mov_b32 m0, 43008
  s_nop 0
  buffer_load_dwordx4 v24, s[8:11], s54 offen offset:0 lds
  buffer_load_dwordx4 v25, s[8:11], s54 offen offset:1024 lds
  buffer_load_dwordx4 v26, s[8:11], s54 offen offset:2048 lds
  buffer_load_dwordx4 v27, s[8:11], s54 offen offset:3072 lds
  s_mov_b32 m0, 47104
  s_nop 0
  buffer_load_dwordx4 v28, s[8:11], s54 offen offset:0 lds
  buffer_load_dwordx4 v29, s[8:11], s54 offen offset:1024 lds
  buffer_load_dwordx4 v30, s[8:11], s54 offen offset:2048 lds
  s_add_u32 s54, s54, 55296
  s_mov_b32 m0, 50176
  s_nop 0
  buffer_load_dwordx4 v24, s[8:11], s54 offen offset:0 lds
  buffer_load_dwordx4 v25, s[8:11], s54 offen offset:1024 lds
  buffer_load_dwordx4 v26, s[8:11], s54 offen offset:2048 lds
  buffer_load_dwordx4 v27, s[8:11], s54 offen offset:3072 lds
  s_mov_b32 m0, 54272
  s_nop 0
  buffer_load_dwordx4 v28, s[8:11], s54 offen offset:0 lds
  buffer_load_dwordx4 v29, s[8:11], s54 offen offset:1024 lds
  buffer_load_dwordx4 v30, s[8:11], s54 offen offset:2048 lds
  s_add_u32 s54, s54, 55296
  s_waitcnt vmcnt(28)
  s_mov_b32 m0, 57344
  s_nop 0
  buffer_load_dwordx4 v24, s[8:11], s54 offen offset:0 lds
  buffer_load_dwordx4 v25, s[8:11], s54 offen offset:1024 lds
  buffer_load_dwordx4 v26, s[8:11], s54 offen offset:2048 lds
  buffer_load_dwordx4 v27, s[8:11], s54 offen offset:3072 lds
  s_mov_b32 m0, 61440
  s_nop 0
  buffer_load_dwordx4 v28, s[8:11], s54 offen offset:0 lds
  buffer_load_dwordx4 v29, s[8:11], s54 offen offset:1024 lds
  buffer_load_dwordx4 v30, s[8:11], s54 offen offset:2048 lds
  s_add_u32 s54, s54, 55296
  s_mov_b32 m0, 64512
  s_nop 0
  buffer_load_dwordx4 v24, s[8:11], s54 offen offset:0 lds
  buffer_load_dwordx4 v25, s[8:11], s54 offen offset:1024 lds
  buffer_load_dwordx4 v26, s[8:11], s54 offen offset:2048 lds
  buffer_load_dwordx4 v27, s[8:11], s54 offen offset:3072 lds
  s_mov_b32 m0, 68608
  s_nop 0
  buffer_load_dwordx4 v28, s[8:11], s54 offen offset:0 lds
  buffer_load_dwordx4 v29, s[8:11], s54 offen offset:1024 lds
  buffer_load_dwordx4 v30, s[8:11], s54 offen offset:2048 lds
  s_add_u32 s54, s54, 55296
  s_mov_b32 m0, 71680
  s_nop 0
  buffer_load_dwordx4 v24, s[8:11], s54 offen offset:0 lds
  buffer_load_dwordx4 v25, s[8:11], s54 offen offset:1024 lds
  buffer_load_dwordx4 v26, s[8:11], s54 offen offset:2048 lds
  buffer_load_dwordx4 v27, s[8:11], s54 offen offset:3072 lds
  s_mov_b32 m0, 75776
  s_nop 0
  buffer_load_dwordx4 v28, s[8:11], s54 offen offset:0 lds
  buffer_load_dwordx4 v29, s[8:11], s54 offen offset:1024 lds
  buffer_load_dwordx4 v30, s[8:11], s54 offen offset:2048 lds
  s_add_u32 s54, s54, 55296
  s_mov_b32 m0, 78848
  s_nop 0
  buffer_load_dwordx4 v24, s[8:11], s54 offen offset:0 lds
  buffer_load_dwordx4 v25, s[8:11], s54 offen offset:1024 lds
  buffer_load_dwordx4 v26, s[8:11], s54 offen offset:2048 lds
  buffer_load_dwordx4 v27, s[8:11], s54 offen offset:3072 lds
  s_mov_b32 m0, 82944
  s_nop 0
  buffer_load_dwordx4 v28, s[8:11], s54 offen offset:0 lds
  buffer_load_dwordx4 v29, s[8:11], s54 offen offset:1024 lds
  buffer_load_dwordx4 v30, s[8:11], s54 offen offset:2048 lds
  s_add_u32 s54, s54, 55296
  s_waitcnt vmcnt(28)
  s_barrier
Lw3e:
  s_mov_b32 s4, s36
  s_mov_b32 s5, s37
  s_mov_b32 s36, s92
  s_mov_b32 s37, s93
  s_mul_i32 s64, s46, 55296
  s_mul_i32 s65, s45, 144
  s_add_u32 s64, s64, s65
  s_add_u32 s64, s64, 442368
  s_mul_i32 s65, s46, 7168
  s_add_u32 s64, s64, 221184
  s_add_u32 m0, s65, 86016
  s_nop 0
  buffer_load_dwordx4 v24, s[8:11], s64 offen offset:0 lds
  buffer_load_dwordx4 v25, s[8:11], s64 offen offset:1024 lds
  buffer_load_dwordx4 v26, s[8:11], s64 offen offset:2048 lds
  buffer_load_dwordx4 v27, s[8:11], s64 offen offset:3072 lds
  s_add_u32 m0, s65, 90112
  s_nop 0
  buffer_load_dwordx4 v28, s[8:11], s64 offen offset:0 lds
  buffer_load_dwordx4 v29, s[8:11], s64 offen offset:1024 lds
  buffer_load_dwordx4 v30, s[8:11], s64 offen offset:2048 lds
  s_add_u32 s64, s64, 221184
  s_add_u32 m0, s65, 114688
  s_nop 0
  buffer_load_dwordx4 v24, s[8:11], s64 offen offset:0 lds
  buffer_load_dwordx4 v25, s[8:11], s64 offen offset:1024 lds
  buffer_load_dwordx4 v26, s[8:11], s64 offen offset:2048 lds
  buffer_load_dwordx4 v27, s[8:11], s64 offen offset:3072 lds
  s_add_u32 m0, s65, 118784
  s_nop 0
  buffer_load_dwordx4 v28, s[8:11], s64 offen offset:0 lds
  buffer_load_dwordx4 v29, s[8:11], s64 offen offset:1024 lds
  buffer_load_dwordx4 v30, s[8:11], s64 offen offset:2048 lds
  s_mul_i32 s54, s44, 73728
  s_lshl_b32 s55, s47, 9
  s_add_u32 s54, s54, s55
  s_add_u32 s56, s54, 46137344
  v_lshlrev_b32 v56, 4, v2
  v_lshl_add_u32 v56, v3, 10, v56
  v_lshrrev_b32 v57, 6, v1
  v_bfe_u32 v58, v1, 4, 2
  v_lshlrev_b32 v57, 7, v57
  v_lshl_add_u32 v57, v58, 2, v57
  s_mul_i32 s67, s49, 196608
  s_lshl_b32 s69, s44, 10
  s_add_u32 s67, s67, s69
  s_add_u32 s67, s67, 131072
  s_mov_b32 exec_lo, 2004318071
  s_mov_b32 exec_hi, 0
Lp11:
  buffer_load_dword v62, v57, s[32:35], s67 offen sc1
  s_waitcnt vmcnt(0)
  v_cmp_ne_u32 vcc, 1, v62
  s_cmp_eq_u32 s51, 0
  s_cbranch_scc1 Lq11
  s_sub_u32 s51, s51, 1
  s_cbranch_vccnz Lp11
Lq11:
  s_mov_b64 exec, -1
  s_mov_b32 s49, 1
  s_mov_b32 s50, 34603008
  buffer_load_dwordx4 a[0:3], v56, s[32:35], s56 offen offset:0
  buffer_load_dwordx4 a[4:7], v56, s[32:35], s56 offen offset:2048
  s_add_u32 s56, s56, 4096
  buffer_load_dwordx4 a[8:11], v56, s[32:35], s56 offen offset:0
  buffer_load_dwordx4 a[12:15], v56, s[32:35], s56 offen offset:2048
  s_add_u32 s56, s56, 4096
  buffer_load_dwordx4 a[16:19], v56, s[32:35], s56 offen offset:0
  buffer_load_dwordx4 a[20:23], v56, s[32:35], s56 offen offset:2048
  s_add_u32 s56, s56, 4096
  buffer_load_dwordx4 a[24:27], v56, s[32:35], s56 offen offset:0
  buffer_load_dwordx4 a[28:31], v56, s[32:35], s56 offen offset:2048
  s_add_u32 s56, s56, 4096
  buffer_load_dwordx4 a[32:35], v56, s[32:35], s56 offen offset:0
  buffer_load_dwordx4 a[36:39], v56, s[32:35], s56 offen offset:2048
  s_add_u32 s56, s56, 4096
  buffer_load_dwordx4 a[40:43], v56, s[32:35], s56 offen offset:0
  buffer_load_dwordx4 a[44:47], v56, s[32:35], s56 offen offset:2048
  s_add_u32 s56, s56, 4096
  v_add_u32 v160, 0, v21
  v_add_u32 v161, 0, v22
  v_add_u32 v162, 0, v23
  v_add_u32 v163, 57344, v21
  v_add_u32 v164, 57344, v22
  v_add_u32 v165, 57344, v23
  v_add_u32 v166, 114688, v21
  v_add_u32 v167, 114688, v22
  v_add_u32 v168, 114688, v23
  s_barrier
  ds_read_b64_tr_b16 v[128:129], v160 offset:0
  ds_read_b64_tr_b16 v[130:131], v160 offset:1792
  ds_read_b64_tr_b16 v[132:133], v160 offset:40
  ds_read_b64_tr_b16 v[134:135], v160 offset:1832
  ds_read_b64_tr_b16 v[136:137], v161 offset:0
  ds_read_b64_tr_b16 v[138:139], v161 offset:1792
  ds_read_b64_tr_b16 v[140:141], v162 offset:0
  ds_read_b64_tr_b16 v[142:143], v162 offset:1792
  s_waitcnt vmcnt(11) lgkmcnt(4)
  v_mfma_f32_32x32x16_bf16 v[64:79], v[128:131], a[0:3], 0
  ds_read_b64_tr_b16 v[144:145], v160 offset:7168
  ds_read_b64_tr_b16 v[146:147], v160 offset:8960
  v_mfma_f32_32x32x16_bf16 v[80:95], v[132:135], a[0:3], 0
  ds_read_b64_tr_b16 v[148:149], v160 offset:7208
  ds_read_b64_tr_b16 v[150:151], v160 offset:9000
  buffer_load_dwordx4 a[48:51], v56, s[32:35], s56 offen offset:0
  s_waitcnt lgkmcnt(4)
  v_mfma_f32_32x32x16_bf16 v[96:111], a[0:3], v[136:139], 0
  ds_read_b64_tr_b16 v[152:153], v161 offset:7168
  ds_read_b64_tr_b16 v[154:155], v161 offset:8960
  v_mfma_f32_32x32x16_bf16 v[112:127], a[0:3], v[140:143], 0
  ds_read_b64_tr_b16 v[156:157], v162 offset:7168
  ds_read_b64_tr_b16 v[158:159], v162 offset:8960
  buffer_load_dwordx4 a[52:55], v56, s[32:35], s56 offen offset:2048
  s_add_u32 s56, s56, 4096
  s_waitcnt vmcnt(12) lgkmcnt(4)
  v_mfma_f32_32x32x16_bf16 v[64:79], v[144:147], a[4:7], v[64:79]
  ds_read_b64_tr_b16 v[128:129], v160 offset:14336
  ds_read_b64_tr_b16 v[130:131], v160 offset:16128
  v_mfma_f32_32x32x16_bf16 v[80:95], v[148:151], a[4:7], v[80:95]
  ds_read_b64_tr_b16 v[132:133], v160 offset:14376
  ds_read_b64_tr_b16 v[134:135], v160 offset:16168
  buffer_load_dwordx4 a[56:59], v56, s[32:35], s56 offen offset:0
  s_waitcnt lgkmcnt(4)
  v_mfma_f32_32x32x16_bf16 v[96:111], a[4:7], v[152:155], v[96:111]
  ds_read_b64_tr_b16 v[136:137], v161 offset:14336
  ds_read_b64_tr_b16 v[138:139], v161 offset:16128
  v_mfma_f32_32x32x16_bf16 v[112:127], a[4:7], v[156:159], v[112:127]
  ds_read_b64_tr_b16 v[140:141], v162 offset:14336
  ds_read_b64_tr_b16 v[142:143], v162 offset:16128
  buffer_load_dwordx4 a[60:63], v56, s[32:35], s56 offen offset:2048
  s_add_u32 s56, s56, 4096
  s_waitcnt vmcnt(13) lgkmcnt(4)
  v_mfma_f32_32x32x16_bf16 v[64:79], v[128:131], a[8:11], v[64:79]
  ds_read_b64_tr_b16 v[144:145], v160 offset:21504
  ds_read_b64_tr_b16 v[146:147], v160 offset:23296
  v_mfma_f32_32x32x16_bf16 v[80:95], v[132:135], a[8:11], v[80:95]
  ds_read_b64_tr_b16 v[148:149], v160 offset:21544
  ds_read_b64_tr_b16 v[150:151], v160 offset:23336
  buffer_load_dwordx4 a[64:67], v56, s[32:35], s56 offen offset:0
  s_waitcnt lgkmcnt(4)
  v_mfma_f32_32x32x16_bf16 v[96:111], a[8:11], v[136:139], v[96:111]
  ds_read_b64_tr_b16 v[152:153], v161 offset:21504
  ds_read_b64_tr_b16 v[154:155], v161 offset:23296
  v_mfma_f32_32x32x16_bf16 v[112:127], a[8:11], v[140:143], v[112:127]
  ds_read_b64_tr_b16 v[156:157], v162 offset:21504
  ds_read_b64_tr_b16 v[158:159], v162 offset:23296
  buffer_load_dwordx4 a[68:71], v56, s[32:35], s56 offen offset:2048
  s_add_u32 s56, s56, 4096
  s_waitcnt vmcnt(14) lgkmcnt(4)
  v_mfma_f32_32x32x16_bf16 v[64:79], v[144:147], a[12:15], v[64:79]
  s_barrier
  ds_read_b64_tr_b16 v[128:129], v160 offset:28672
  ds_read_b64_tr_b16 v[130:131], v160 offset:30464
  v_mfma_f32_32x32x16_bf16 v[80:95], v[148:151], a[12:15], v[80:95]
  ds_read_b64_tr_b16 v[132:133], v160 offset:28712
  ds_read_b64_tr_b16 v[134:135], v160 offset:30504
  buffer_load_dwordx4 a[72:75], v56, s[32:35], s56 offen offset:0
  s_waitcnt lgkmcnt(4)
  v_mfma_f32_32x32x16_bf16 v[96:111], a[12:15], v[152:155], v[96:111]
  ds_read_b64_tr_b16 v[136:137], v161 offset:28672
  ds_read_b64_tr_b16 v[138:139], v161 offset:30464
  v_mfma_f32_32x32x16_bf16 v[112:127], a[12:15], v[156:159], v[112:127]
  ds_read_b64_tr_b16 v[140:141], v162 offset:28672
  ds_read_b64_tr_b16 v[142:143], v162 offset:30464
  buffer_load_dwordx4 a[76:79], v56, s[32:35], s56 offen offset:2048
  s_add_u32 s56, s56, 4096
  s_waitcnt vmcnt(15) lgkmcnt(4)
  v_mfma_f32_32x32x16_bf16 v[64:79], v[128:131], a[16:19], v[64:79]
  ds_read_b64_tr_b16 v[144:145], v160 offset:35840
  ds_read_b64_tr_b16 v[146:147], v160 offset:37632
  v_mfma_f32_32x32x16_bf16 v[80:95], v[132:135], a[16:19], v[80:95]
  ds_read_b64_tr_b16 v[148:149], v160 offset:35880
  ds_read_b64_tr_b16 v[150:151], v160 offset:37672
  buffer_load_dwordx4 a[80:83], v56, s[32:35], s56 offen offset:0
  s_waitcnt lgkmcnt(4)
  v_mfma_f32_32x32x16_bf16 v[96:111], a[16:19], v[136:139], v[96:111]
  ds_read_b64_tr_b16 v[152:153], v161 offset:35840
  ds_read_b64_tr_b16 v[154:155], v161 offset:37632
  v_mfma_f32_32x32x16_bf16 v[112:127], a[16:19], v[140:143], v[112:127]
  ds_read_b64_tr_b16 v[156:157], v162 offset:35840
  ds_read_b64_tr_b16 v[158:159], v162 offset:37632
  buffer_load_dwordx4 a[84:87], v56, s[32:35], s56 offen offset:2048
  s_add_u32 s56, s56, 4096
  s_waitcnt vmcnt(16) lgkmcnt(4)
  v_mfma_f32_32x32x16_bf16 v[64:79], v[144:147], a[20:23], v[64:79]
  ds_read_b64_tr_b16 v[128:129], v160 offset:43008
  ds_read_b64_tr_b16 v[130:131], v160 offset:44800
  v_mfma_f32_32x32x16_bf16 v[80:95], v[148:151], a[20:23], v[80:95]
  ds_read_b64_tr_b16 v[132:133], v160 offset:43048
  ds_read_b64_tr_b16 v[134:135], v160 offset:44840
  buffer_load_dwordx4 a[88:91], v56, s[32:35], s56 offen offset:0
  s_waitcnt lgkmcnt(4)
  v_mfma_f32_32x32x16_bf16 v[96:111], a[20:23], v[152:155], v[96:111]
  ds_read_b64_tr_b16 v[136:137], v161 offset:43008
  ds_read_b64_tr_b16 v[138:139], v161 offset:44800
  v_mfma_f32_32x32x16_bf16 v[112:127], a[20:23], v[156:159], v[112:127]
  ds_read_b64_tr_b16 v[140:141], v162 offset:43008
  ds_read_b64_tr_b16 v[142:143], v162 offset:44800
  buffer_load_dwordx4 a[92:95], v56, s[32:35], s56 offen offset:2048
  s_add_u32 s56, s56, 4096
  s_waitcnt vmcnt(17) lgkmcnt(4)
  v_mfma_f32_32x32x16_bf16 v[64:79], v[128:131], a[24:27], v[64:79]
  ds_read_b64_tr_b16 v[144:145], v160 offset:50176
  ds_read_b64_tr_b16 v[146:147], v160 offset:51968
  v_mfma_f32_32x32x16_bf16 v[80:95], v[132:135], a[24:27], v[80:95]
  ds_read_b64_tr_b16 v[148:149], v160 offset:50216
  ds_read_b64_tr_b16 v[150:151], v160 offset:52008
  buffer_load_dwordx4 a[96:99], v56, s[32:35], s56 offen offset:0
  s_waitcnt lgkmcnt(4)
  v_mfma_f32_32x32x16_bf16 v[96:111], a[24:27], v[136:139], v[96:111]
  ds_read_b64_tr_b16 v[152:153], v161 offset:50176
  ds_read_b64_tr_b16 v[154:155], v161 offset:51968
  v_mfma_f32_32x32x16_bf16 v[112:127], a[24:27], v[140:143], v[112:127]
  ds_read_b64_tr_b16 v[156:157], v162 offset:50176
  ds_read_b64_tr_b16 v[158:159], v162 offset:51968
  buffer_load_dwordx4 a[100:103], v56, s[32:35], s56 offen offset:2048
  s_add_u32 s56, s56, 4096
  s_waitcnt vmcnt(18) lgkmcnt(4)
  v_mfma_f32_32x32x16_bf16 v[64:79], v[144:147], a[28:31], v[64:79]
  s_barrier
  ds_read_b64_tr_b16 v[128:129], v163 offset:0
  ds_read_b64_tr_b16 v[130:131], v163 offset:1792
  v_mfma_f32_32x32x16_bf16 v[80:95], v[148:151], a[28:31], v[80:95]
  ds_read_b64_tr_b16 v[132:133], v163 offset:40
  ds_read_b64_tr_b16 v[134:135], v163 offset:1832
  s_add_u32 s64, s64, 221184
  buffer_load_dwordx4 a[104:107], v56, s[32:35], s56 offen offset:0
  s_waitcnt lgkmcnt(4)
  v_mfma_f32_32x32x16_bf16 v[96:111], a[28:31], v[152:155], v[96:111]
  ds_read_b64_tr_b16 v[136:137], v164 offset:0
  ds_read_b64_tr_b16 v[138:139], v164 offset:1792
  v_mfma_f32_32x32x16_bf16 v[112:127], a[28:31], v[156:159], v[112:127]
  ds_read_b64_tr_b16 v[140:141], v165 offset:0
  ds_read_b64_tr_b16 v[142:143], v165 offset:1792
  s_add_u32 m0, s65, 0
  buffer_load_dwordx4 a[108:111], v56, s[32:35], s56 offen offset:2048
  s_add_u32 s56, s56, 4096
  s_waitcnt vmcnt(19) lgkmcnt(4)
  v_mfma_f32_32x32x16_bf16 v[64:79], v[128:131], a[32:35], v[64:79]
  ds_read_b64_tr_b16 v[144:145], v163 offset:7168
  ds_read_b64_tr_b16 v[146:147], v163 offset:8960
  buffer_load_dwordx4 v24, s[8:11], s64 offen offset:0 lds
  v_mfma_f32_32x32x16_bf16 v[80:95], v[132:135], a[32:35], v[80:95]
  ds_read_b64_tr_b16 v[148:149], v163 offset:7208
  ds_read_b64_tr_b16 v[150:151], v163 offset:9000
  buffer_load_dwordx4 v25, s[8:11], s64 offen offset:1024 lds
  buffer_load_dwordx4 a[112:115], v56, s[32:35], s56 offen offset:0
  s_waitcnt lgkmcnt(4)
  v_mfma_f32_32x32x16_bf16 v[96:111], a[32:35], v[136:139], v[96:111]
  ds_read_b64_tr_b16 v[152:153], v164 offset:7168
  ds_read_b64_tr_b16 v[154:155], v164 offset:8960
  v_mfma_f32_32x32x16_bf16 v[112:127], a[32:35], v[140:143], v[112:127]
  ds_read_b64_tr_b16 v[156:157], v165 offset:7168
  ds_read_b64_tr_b16 v[158:159], v165 offset:8960
  buffer_load_dwordx4 v26, s[8:11], s64 offen offset:2048 lds
  buffer_load_dwordx4 a[116:119], v56, s[32:35], s56 offen offset:2048
  s_add_u32 s56, s56, 4096
  s_waitcnt vmcnt(23) lgkmcnt(4)
  v_mfma_f32_32x32x16_bf16 v[64:79], v[144:147], a[36:39], v[64:79]
  ds_read_b64_tr_b16 v[128:129], v163 offset:14336
  ds_read_b64_tr_b16 v[130:131], v163 offset:16128
  buffer_load_dwordx4 v27, s[8:11], s64 offen offset:3072 lds
  v_mfma_f32_32x32x16_bf16 v[80:95], v[148:151], a[36:39], v[80:95]
  ds_read_b64_tr_b16 v[132:133], v163 offset:14376
  ds_read_b64_tr_b16 v[134:135], v163 offset:16168
  buffer_load_dwordx4 a[120:123], v56, s[32:35], s56 offen offset:0
  s_waitcnt lgkmcnt(4)
  v_mfma_f32_32x32x16_bf16 v[96:111], a[36:39], v[152:155], v[96:111]
  ds_read_b64_tr_b16 v[136:137], v164 offset:14336
  ds_read_b64_tr_b16 v[138:139], v164 offset:16128
  s_add_u32 m0, s65, 4096
  v_mfma_f32_32x32x16_bf16 v[112:127], a[36:39], v[156:159], v[112:127]
  ds_read_b64_tr_b16 v[140:141], v165 offset:14336
  ds_read_b64_tr_b16 v[142:143], v165 offset:16128
  buffer_load_dwordx4 v28, s[8:11], s64 offen offset:0 lds
  buffer_load_dwordx4 a[124:127], v56, s[32:35], s56 offen offset:2048
  s_add_u32 s56, s56, 4096
  s_waitcnt vmcnt(26) lgkmcnt(4)
  v_mfma_f32_32x32x16_bf16 v[64:79], v[128:131], a[40:43], v[64:79]
  ds_read_b64_tr_b16 v[144:145], v163 offset:21504
  ds_read_b64_tr_b16 v[146:147], v163 offset:23296
  buffer_load_dwordx4 v29, s[8:11], s64 offen offset:1024 lds
  v_mfma_f32_32x32x16_bf16 v[80:95], v[132:135], a[40:43], v[80:95]
  ds_read_b64_tr_b16 v[148:149], v163 offset:21544
  ds_read_b64_tr_b16 v[150:151], v163 offset:23336
  buffer_load_dwordx4 a[128:131], v56, s[32:35], s56 offen offset:0
  s_waitcnt lgkmcnt(4)
  v_mfma_f32_32x32x16_bf16 v[96:111], a[40:43], v[136:139], v[96:111]
  ds_read_b64_tr_b16 v[152:153], v164 offset:21504
  ds_read_b64_tr_b16 v[154:155], v164 offset:23296
  buffer_load_dwordx4 v30, s[8:11], s64 offen offset:2048 lds
  v_mfma_f32_32x32x16_bf16 v[112:127], a[40:43], v[140:143], v[112:127]
  ds_read_b64_tr_b16 v[156:157], v165 offset:21504
  ds_read_b64_tr_b16 v[158:159], v165 offset:23296
  buffer_load_dwordx4 a[132:135], v56, s[32:35], s56 offen offset:2048
  s_add_u32 s56, s56, 4096
  s_waitcnt vmcnt(29) lgkmcnt(4)
  v_mfma_f32_32x32x16_bf16 v[64:79], v[144:147], a[44:47], v[64:79]
  s_barrier
  ds_read_b64_tr_b16 v[128:129], v163 offset:28672
  ds_read_b64_tr_b16 v[130:131], v163 offset:30464
  v_mfma_f32_32x32x16_bf16 v[80:95], v[148:151], a[44:47], v[80:95]
  ds_read_b64_tr_b16 v[132:133], v163 offset:28712
  ds_read_b64_tr_b16 v[134:135], v163 offset:30504
  s_add_u32 s64, s64, 221184
  buffer_load_dwordx4 a[136:139], v56, s[32:35], s56 offen offset:0
  s_waitcnt lgkmcnt(4)
  v_mfma_f32_32x32x16_bf16 v[96:111], a[44:47], v[152:155], v[96:111]
  ds_read_b64_tr_b16 v[136:137], v164 offset:28672
  ds_read_b64_tr_b16 v[138:139], v164 offset:30464
  v_mfma_f32_32x32x16_bf16 v[112:127], a[44:47], v[156:159], v[112:127]
  ds_read_b64_tr_b16 v[140:141], v165 offset:28672
  ds_read_b64_tr_b16 v[142:143], v165 offset:30464
  s_add_u32 m0, s65, 28672
  buffer_load_dwordx4 a[140:143], v56, s[32:35], s56 offen offset:2048
  s_add_u32 s56, s56, 4096
  s_waitcnt vmcnt(30) lgkmcnt(4)
  v_mfma_f32_32x32x16_bf16 v[64:79], v[128:131], a[48:51], v[64:79]
  ds_read_b64_tr_b16 v[144:145], v163 offset:35840
  ds_read_b64_tr_b16 v[146:147], v163 offset:37632
  buffer_load_dwordx4 v24, s[8:11], s64 offen offset:0 lds
  v_mfma_f32_32x32x16_bf16 v[80:95], v[132:135], a[48:51], v[80:95]
  ds_read_b64_tr_b16 v[148:149], v163 offset:35880
  ds_read_b64_tr_b16 v[150:151], v163 offset:37672
  buffer_load_dwordx4 v25, s[8:11], s64 offen offset:1024 lds
  s_waitcnt lgkmcnt(4)
  v_mfma_f32_32x32x16_bf16 v[96:111], a[48:51], v[136:139], v[96:111]
  ds_read_b64_tr_b16 v[152:153], v164 offset:35840
  ds_read_b64_tr_b16 v[154:155], v164 offset:37632
  v_mfma_f32_32x32x16_bf16 v[112:127], a[48:51], v[140:143], v[112:127]
  ds_read_b64_tr_b16 v[156:157], v165 offset:35840
  ds_read_b64_tr_b16 v[158:159], v165 offset:37632
  buffer_load_dwordx4 v26, s[8:11], s64 offen offset:2048 lds
  s_waitcnt vmcnt(32) lgkmcnt(4)
  v_mfma_f32_32x32x16_bf16 v[64:79], v[144:147], a[52:55], v[64:79]
  ds_read_b64_tr_b16 v[128:129], v163 offset:43008
  ds_read_b64_tr_b16 v[130:131], v163 offset:44800
  buffer_load_dwordx4 v27, s[8:11], s64 offen offset:3072 lds
  v_mfma_f32_32x32x16_bf16 v[80:95], v[148:151], a[52:55], v[80:95]
  ds_read_b64_tr_b16 v[132:133], v163 offset:43048
  ds_read_b64_tr_b16 v[134:135], v163 offset:44840
  s_waitcnt lgkmcnt(4)
  v_mfma_f32_32x32x16_bf16 v[96:111], a[52:55], v[152:155], v[96:111]
  ds_read_b64_tr_b16 v[136:137], v164 offset:43008
  ds_read_b64_tr_b16 v[138:139], v164 offset:44800
  s_add_u32 m0, s65, 32768
  v_mfma_f32_32x32x16_bf16 v[112:127], a[52:55], v[156:159], v[112:127]
  ds_read_b64_tr_b16 v[140:141], v165 offset:43008
  ds_read_b64_tr_b16 v[142:143], v165 offset:44800
  buffer_load_dwordx4 v28, s[8:11], s64 offen offset:0 lds
  s_waitcnt vmcnt(33) lgkmcnt(4)
  v_mfma_f32_32x32x16_bf16 v[64:79], v[128:131], a[56:59], v[64:79]
  ds_read_b64_tr_b16 v[144:145], v163 offset:50176
  ds_read_b64_tr_b16 v[146:147], v163 offset:51968
  buffer_load_dwordx4 v29, s[8:11], s64 offen offset:1024 lds
  v_mfma_f32_32x32x16_bf16 v[80:95], v[132:135], a[56:59], v[80:95]
  ds_read_b64_tr_b16 v[148:149], v163 offset:50216
  ds_read_b64_tr_b16 v[150:151], v163 offset:52008
  s_waitcnt lgkmcnt(4)
  v_mfma_f32_32x32x16_bf16 v[96:111], a[56:59], v[136:139], v[96:111]
  ds_read_b64_tr_b16 v[152:153], v164 offset:50176
  ds_read_b64_tr_b16 v[154:155], v164 offset:51968
  buffer_load_dwordx4 v30, s[8:11], s64 offen offset:2048 lds
  v_mfma_f32_32x32x16_bf16 v[112:127], a[56:59], v[140:143], v[112:127]
  ds_read_b64_tr_b16 v[156:157], v165 offset:50176
  ds_read_b64_tr_b16 v[158:159], v165 offset:51968
  s_waitcnt vmcnt(34) lgkmcnt(4)
  v_mfma_f32_32x32x16_bf16 v[64:79], v[144:147], a[60:63], v[64:79]
  s_barrier
  ds_read_b64_tr_b16 v[128:129], v166 offset:0
  ds_read_b64_tr_b16 v[130:131], v166 offset:1792
  v_mfma_f32_32x32x16_bf16 v[80:95], v[148:151], a[60:63], v[80:95]
  ds_read_b64_tr_b16 v[132:133], v166 offset:40
  ds_read_b64_tr_b16 v[134:135], v166 offset:1832
  s_add_u32 s64, s64, 221184
  s_waitcnt lgkmcnt(4)
  v_mfma_f32_32x32x16_bf16 v[96:111], a[60:63], v[152:155], v[96:111]
  ds_read_b64_tr_b16 v[136:137], v167 offset:0
  ds_read_b64_tr_b16 v[138:139], v167 offset:1792
  v_mfma_f32_32x32x16_bf16 v[112:127], a[60:63], v[156:159], v[112:127]
  ds_read_b64_tr_b16 v[140:141], v168 offset:0
  ds_read_b64_tr_b16 v[142:143], v168 offset:1792
  s_add_u32 m0, s65, 57344
  s_waitcnt vmcnt(33) lgkmcnt(4)
  v_mfma_f32_32x32x16_bf16 v[64:79], v[128:131], a[64:67], v[64:79]
  ds_read_b64_tr_b16 v[144:145], v166 offset:7168
  ds_read_b64_tr_b16 v[146:147], v166 offset:8960
  buffer_load_dwordx4 v24, s[8:11], s64 offen offset:0 lds
  v_mfma_f32_32x32x16_bf16 v[80:95], v[132:135], a[64:67], v[80:95]
  ds_read_b64_tr_b16 v[148:149], v166 offset:7208
  ds_read_b64_tr_b16 v[150:151], v166 offset:9000
  buffer_load_dwordx4 v25, s[8:11], s64 offen offset:1024 lds
  s_waitcnt lgkmcnt(4)
  v_mfma_f32_32x32x16_bf16 v[96:111], a[64:67], v[136:139], v[96:111]
  ds_read_b64_tr_b16 v[152:153], v167 offset:7168
  ds_read_b64_tr_b16 v[154:155], v167 offset:8960
  v_mfma_f32_32x32x16_bf16 v[112:127], a[64:67], v[140:143], v[112:127]
  ds_read_b64_tr_b16 v[156:157], v168 offset:7168
  ds_read_b64_tr_b16 v[158:159], v168 offset:8960
  buffer_load_dwordx4 v26, s[8:11], s64 offen offset:2048 lds
  s_waitcnt vmcnt(35) lgkmcnt(4)
  v_mfma_f32_32x32x16_bf16 v[64:79], v[144:147], a[68:71], v[64:79]
  ds_read_b64_tr_b16 v[128:129], v166 offset:14336
  ds_read_b64_tr_b16 v[130:131], v166 offset:16128
  buffer_load_dwordx4 v27, s[8:11], s64 offen offset:3072 lds
  v_mfma_f32_32x32x16_bf16 v[80:95], v[148:151], a[68:71], v[80:95]
  ds_read_b64_tr_b16 v[132:133], v166 offset:14376
  ds_read_b64_tr_b16 v[134:135], v166 offset:16168
  s_waitcnt lgkmcnt(4)
  v_mfma_f32_32x32x16_bf16 v[96:111], a[68:71], v[152:155], v[96:111]
  ds_read_b64_tr_b16 v[136:137], v167 offset:14336
  ds_read_b64_tr_b16 v[138:139], v167 offset:16128
  s_add_u32 m0, s65, 61440
  v_mfma_f32_32x32x16_bf16 v[112:127], a[68:71], v[156:159], v[112:127]
  ds_read_b64_tr_b16 v[140:141], v168 offset:14336
  ds_read_b64_tr_b16 v[142:143], v168 offset:16128
  buffer_load_dwordx4 v28, s[8:11], s64 offen offset:0 lds
  s_waitcnt vmcnt(36) lgkmcnt(4)
  v_mfma_f32_32x32x16_bf16 v[64:79], v[128:131], a[72:75], v[64:79]
  ds_read_b64_tr_b16 v[144:145], v166 offset:21504
  ds_read_b64_tr_b16 v[146:147], v166 offset:23296
  buffer_load_dwordx4 v29, s[8:11], s64 offen offset:1024 lds
  v_mfma_f32_32x32x16_bf16 v[80:95], v[132:135], a[72:75], v[80:95]
  ds_read_b64_tr_b16 v[148:149], v166 offset:21544
  ds_read_b64_tr_b16 v[150:151], v166 offset:23336
  s_waitcnt lgkmcnt(4)
  v_mfma_f32_32x32x16_bf16 v[96:111], a[72:75], v[136:139], v[96:111]
  ds_read_b64_tr_b16 v[152:153], v167 offset:21504
  ds_read_b64_tr_b16 v[154:155], v167 offset:23296
  buffer_load_dwordx4 v30, s[8:11], s64 offen offset:2048 lds
  v_mfma_f32_32x32x16_bf16 v[112:127], a[72:75], v[140:143], v[112:127]
  ds_read_b64_tr_b16 v[156:157], v168 offset:21504
  ds_read_b64_tr_b16 v[158:159], v168 offset:23296
  s_waitcnt vmcnt(37) lgkmcnt(4)
  v_mfma_f32_32x32x16_bf16 v[64:79], v[144:147], a[76:79], v[64:79]
  s_waitcnt vmcnt(17)
  s_barrier
  ds_read_b64_tr_b16 v[128:129], v160 offset:0
  ds_read_b64_tr_b16 v[130:131], v160 offset:1792
  v_mfma_f32_32x32x16_bf16 v[80:95], v[148:151], a[76:79], v[80:95]
  ds_read_b64_tr_b16 v[132:133], v160 offset:40
  ds_read_b64_tr_b16 v[134:135], v160 offset:1832
  s_add_u32 s64, s64, 221184
  s_waitcnt lgkmcnt(4)
  v_mfma_f32_32x32x16_bf16 v[96:111], a[76:79], v[152:155], v[96:111]
  ds_read_b64_tr_b16 v[136:137], v161 offset:0
  ds_read_b64_tr_b16 v[138:139], v161 offset:1792
  v_mfma_f32_32x32x16_bf16 v[112:127], a[76:79], v[156:159], v[112:127]
  ds_read_b64_tr_b16 v[140:141], v162 offset:0
  ds_read_b64_tr_b16 v[142:143], v162 offset:1792
  s_add_u32 m0, s65, 86016
  s_waitcnt lgkmcnt(4)
  v_mfma_f32_32x32x16_bf16 v[64:79], v[128:131], a[80:83], v[64:79]
  ds_read_b64_tr_b16 v[144:145], v160 offset:7168
  ds_read_b64_tr_b16 v[146:147], v160 offset:8960
  buffer_load_dwordx4 v24, s[8:11], s64 offen offset:0 lds
  v_mfma_f32_32x32x16_bf16 v[80:95], v[132:135], a[80:83], v[80:95]
  ds_read_b64_tr_b16 v[148:149], v160 offset:7208
  ds_read_b64_tr_b16 v[150:151], v160 offset:9000
  buffer_load_dwordx4 v25, s[8:11], s64 offen offset:1024 lds
  s_waitcnt lgkmcnt(4)
  v_mfma_f32_32x32x16_bf16 v[96:111], a[80:83], v[136:139], v[96:111]
  ds_read_b64_tr_b16 v[152:153], v161 offset:7168
  ds_read_b64_tr_b16 v[154:155], v161 offset:8960
  v_mfma_f32_32x32x16_bf16 v[112:127], a[80:83], v[140:143], v[112:127]
  ds_read_b64_tr_b16 v[156:157], v162 offset:7168
  ds_read_b64_tr_b16 v[158:159], v162 offset:8960
  buffer_load_dwordx4 v26, s[8:11], s64 offen offset:2048 lds
  s_waitcnt lgkmcnt(4)
  v_mfma_f32_32x32x16_bf16 v[64:79], v[144:147], a[84:87], v[64:79]
  ds_read_b64_tr_b16 v[128:129], v160 offset:14336
  ds_read_b64_tr_b16 v[130:131], v160 offset:16128
  buffer_load_dwordx4 v27, s[8:11], s64 offen offset:3072 lds
  v_mfma_f32_32x32x16_bf16 v[80:95], v[148:151], a[84:87], v[80:95]
  ds_read_b64_tr_b16 v[132:133], v160 offset:14376
  ds_read_b64_tr_b16 v[134:135], v160 offset:16168
  s_waitcnt lgkmcnt(4)
  v_mfma_f32_32x32x16_bf16 v[96:111], a[84:87], v[152:155], v[96:111]
  ds_read_b64_tr_b16 v[136:137], v161 offset:14336
  ds_read_b64_tr_b16 v[138:139], v161 offset:16128
  s_add_u32 m0, s65, 90112
  v_mfma_f32_32x32x16_bf16 v[112:127], a[84:87], v[156:159], v[112:127]
  ds_read_b64_tr_b16 v[140:141], v162 offset:14336
  ds_read_b64_tr_b16 v[142:143], v162 offset:16128
  buffer_load_dwordx4 v28, s[8:11], s64 offen offset:0 lds
  s_waitcnt lgkmcnt(4)
  v_mfma_f32_32x32x16_bf16 v[64:79], v[128:131], a[88:91], v[64:79]
  ds_read_b64_tr_b16 v[144:145], v160 offset:21504
  ds_read_b64_tr_b16 v[146:147], v160 offset:23296
  buffer_load_dwordx4 v29, s[8:11], s64 offen offset:1024 lds
  v_mfma_f32_32x32x16_bf16 v[80:95], v[132:135], a[88:91], v[80:95]
  ds_read_b64_tr_b16 v[148:149], v160 offset:21544
  ds_read_b64_tr_b16 v[150:151], v160 offset:23336
  s_waitcnt lgkmcnt(4)
  v_mfma_f32_32x32x16_bf16 v[96:111], a[88:91], v[136:139], v[96:111]
  ds_read_b64_tr_b16 v[152:153], v161 offset:21504
  ds_read_b64_tr_b16 v[154:155], v161 offset:23296
  buffer_load_dwordx4 v30, s[8:11], s64 offen offset:2048 lds
  v_mfma_f32_32x32x16_bf16 v[112:127], a[88:91], v[140:143], v[112:127]
  ds_read_b64_tr_b16 v[156:157], v162 offset:21504
  ds_read_b64_tr_b16 v[158:159], v162 offset:23296
  s_waitcnt lgkmcnt(4)
  v_mfma_f32_32x32x16_bf16 v[64:79], v[144:147], a[92:95], v[64:79]
  s_waitcnt vmcnt(14)
  s_barrier
  ds_read_b64_tr_b16 v[128:129], v160 offset:28672
  ds_read_b64_tr_b16 v[130:131], v160 offset:30464
  v_mfma_f32_32x32x16_bf16 v[80:95], v[148:151], a[92:95], v[80:95]
  ds_read_b64_tr_b16 v[132:133], v160 offset:28712
  ds_read_b64_tr_b16 v[134:135], v160 offset:30504
  s_waitcnt lgkmcnt(4)
  v_mfma_f32_32x32x16_bf16 v[96:111], a[92:95], v[152:155], v[96:111]
  ds_read_b64_tr_b16 v[136:137], v161 offset:28672
  ds_read_b64_tr_b16 v[138:139], v161 offset:30464
  v_mfma_f32_32x32x16_bf16 v[112:127], a[92:95], v[156:159], v[112:127]
  ds_read_b64_tr_b16 v[140:141], v162 offset:28672
  ds_read_b64_tr_b16 v[142:143], v162 offset:30464
  s_waitcnt lgkmcnt(4)
  v_mfma_f32_32x32x16_bf16 v[64:79], v[128:131], a[96:99], v[64:79]
  ds_read_b64_tr_b16 v[144:145], v160 offset:35840
  ds_read_b64_tr_b16 v[146:147], v160 offset:37632
  v_mfma_f32_32x32x16_bf16 v[80:95], v[132:135], a[96:99], v[80:95]
  ds_read_b64_tr_b16 v[148:149], v160 offset:35880
  ds_read_b64_tr_b16 v[150:151], v160 offset:37672
  s_waitcnt lgkmcnt(4)
  v_mfma_f32_32x32x16_bf16 v[96:111], a[96:99], v[136:139], v[96:111]
  ds_read_b64_tr_b16 v[152:153], v161 offset:35840
  ds_read_b64_tr_b16 v[154:155], v161 offset:37632
  v_mfma_f32_32x32x16_bf16 v[112:127], a[96:99], v[140:143], v[112:127]
  ds_read_b64_tr_b16 v[156:157], v162 offset:35840
  ds_read_b64_tr_b16 v[158:159], v162 offset:37632
  s_waitcnt lgkmcnt(4)
  v_mfma_f32_32x32x16_bf16 v[64:79], v[144:147], a[100:103], v[64:79]
  ds_read_b64_tr_b16 v[128:129], v160 offset:43008
  ds_read_b64_tr_b16 v[130:131], v160 offset:44800
  v_mfma_f32_32x32x16_bf16 v[80:95], v[148:151], a[100:103], v[80:95]
  ds_read_b64_tr_b16 v[132:133], v160 offset:43048
  ds_read_b64_tr_b16 v[134:135], v160 offset:44840
  s_waitcnt lgkmcnt(4)
  v_mfma_f32_32x32x16_bf16 v[96:111], a[100:103], v[152:155], v[96:111]
  ds_read_b64_tr_b16 v[136:137], v161 offset:43008
  ds_read_b64_tr_b16 v[138:139], v161 offset:44800
  v_mfma_f32_32x32x16_bf16 v[112:127], a[100:103], v[156:159], v[112:127]
  ds_read_b64_tr_b16 v[140:141], v162 offset:43008
  ds_read_b64_tr_b16 v[142:143], v162 offset:44800
  s_waitcnt lgkmcnt(4)
  v_mfma_f32_32x32x16_bf16 v[64:79], v[128:131], a[104:107], v[64:79]
  ds_read_b64_tr_b16 v[144:145], v160 offset:50176
  ds_read_b64_tr_b16 v[146:147], v160 offset:51968
  v_mfma_f32_32x32x16_bf16 v[80:95], v[132:135], a[104:107], v[80:95]
  ds_read_b64_tr_b16 v[148:149], v160 offset:50216
  ds_read_b64_tr_b16 v[150:151], v160 offset:52008
  s_waitcnt lgkmcnt(4)
  v_mfma_f32_32x32x16_bf16 v[96:111], a[104:107], v[136:139], v[96:111]
  ds_read_b64_tr_b16 v[152:153], v161 offset:50176
  ds_read_b64_tr_b16 v[154:155], v161 offset:51968
  v_mfma_f32_32x32x16_bf16 v[112:127], a[104:107], v[140:143], v[112:127]
  ds_read_b64_tr_b16 v[156:157], v162 offset:50176
  ds_read_b64_tr_b16 v[158:159], v162 offset:51968
  s_waitcnt lgkmcnt(4)
  v_mfma_f32_32x32x16_bf16 v[64:79], v[144:147], a[108:111], v[64:79]
  s_waitcnt vmcnt(7)
  s_barrier
  ds_read_b64_tr_b16 v[128:129], v163 offset:0
  ds_read_b64_tr_b16 v[130:131], v163 offset:1792
  v_mfma_f32_32x32x16_bf16 v[80:95], v[148:151], a[108:111], v[80:95]
  ds_read_b64_tr_b16 v[132:133], v163 offset:40
  ds_read_b64_tr_b16 v[134:135], v163 offset:1832
  s_waitcnt lgkmcnt(4)
  v_mfma_f32_32x32x16_bf16 v[96:111], a[108:111], v[152:155], v[96:111]
  ds_read_b64_tr_b16 v[136:137], v164 offset:0
  ds_read_b64_tr_b16 v[138:139], v164 offset:1792
  s_lshl_b32 s54, s44, 2
  s_sub_u32 s54, s54, 16
  v_lshrrev_b32 v254, 2, v1
  v_add_u32 v254, s54, v254
  buffer_load_dword v255, v254, s[40:43], 0 offen sc1
  v_mfma_f32_32x32x16_bf16 v[112:127], a[108:111], v[156:159], v[112:127]
  ds_read_b64_tr_b16 v[140:141], v165 offset:0
  ds_read_b64_tr_b16 v[142:143], v165 offset:1792
  s_waitcnt lgkmcnt(4)
  v_mfma_f32_32x32x16_bf16 v[64:79], v[128:131], a[112:115], v[64:79]
  ds_read_b64_tr_b16 v[144:145], v163 offset:7168
  ds_read_b64_tr_b16 v[146:147], v163 offset:8960
  v_mfma_f32_32x32x16_bf16 v[80:95], v[132:135], a[112:115], v[80:95]
  ds_read_b64_tr_b16 v[148:149], v163 offset:7208
  ds_read_b64_tr_b16 v[150:151], v163 offset:9000
  s_waitcnt lgkmcnt(4)
  v_mfma_f32_32x32x16_bf16 v[96:111], a[112:115], v[136:139], v[96:111]
  ds_read_b64_tr_b16 v[152:153], v164 offset:7168
  ds_read_b64_tr_b16 v[154:155], v164 offset:8960
  v_mfma_f32_32x32x16_bf16 v[112:127], a[112:115], v[140:143], v[112:127]
  ds_read_b64_tr_b16 v[156:157], v165 offset:7168
  ds_read_b64_tr_b16 v[158:159], v165 offset:8960
  s_waitcnt lgkmcnt(4)
  v_mfma_f32_32x32x16_bf16 v[64:79], v[144:147], a[116:119], v[64:79]
  ds_read_b64_tr_b16 v[128:129], v163 offset:14336
  ds_read_b64_tr_b16 v[130:131], v163 offset:16128
  v_mfma_f32_32x32x16_bf16 v[80:95], v[148:151], a[116:119], v[80:95]
  ds_read_b64_tr_b16 v[132:133], v163 offset:14376
  ds_read_b64_tr_b16 v[134:135], v163 offset:16168
  s_waitcnt lgkmcnt(4)
  v_mfma_f32_32x32x16_bf16 v[96:111], a[116:119], v[152:155], v[96:111]
  ds_read_b64_tr_b16 v[136:137], v164 offset:14336
  ds_read_b64_tr_b16 v[138:139], v164 offset:16128
  v_mfma_f32_32x32x16_bf16 v[112:127], a[116:119], v[156:159], v[112:127]
  ds_read_b64_tr_b16 v[140:141], v165 offset:14336
  ds_read_b64_tr_b16 v[142:143], v165 offset:16128
  s_waitcnt lgkmcnt(4)
  v_mfma_f32_32x32x16_bf16 v[64:79], v[128:131], a[120:123], v[64:79]
  ds_read_b64_tr_b16 v[144:145], v163 offset:21504
  ds_read_b64_tr_b16 v[146:147], v163 offset:23296
  v_mfma_f32_32x32x16_bf16 v[80:95], v[132:135], a[120:123], v[80:95]
  ds_read_b64_tr_b16 v[148:149], v163 offset:21544
  ds_read_b64_tr_b16 v[150:151], v163 offset:23336
  s_waitcnt lgkmcnt(4)
  v_mfma_f32_32x32x16_bf16 v[96:111], a[120:123], v[136:139], v[96:111]
  ds_read_b64_tr_b16 v[152:153], v164 offset:21504
  ds_read_b64_tr_b16 v[154:155], v164 offset:23296
  v_mfma_f32_32x32x16_bf16 v[112:127], a[120:123], v[140:143], v[112:127]
  ds_read_b64_tr_b16 v[156:157], v165 offset:21504
  ds_read_b64_tr_b16 v[158:159], v165 offset:23296
  s_waitcnt lgkmcnt(4)
  v_mfma_f32_32x32x16_bf16 v[64:79], v[144:147], a[124:127], v[64:79]
  s_waitcnt vmcnt(1)
  s_barrier
  ds_read_b64_tr_b16 v[128:129], v163 offset:28672
  ds_read_b64_tr_b16 v[130:131], v163 offset:30464
  v_mfma_f32_32x32x16_bf16 v[80:95], v[148:151], a[124:127], v[80:95]
  ds_read_b64_tr_b16 v[132:133], v163 offset:28712
  ds_read_b64_tr_b16 v[134:135], v163 offset:30504
  s_waitcnt lgkmcnt(4)
  v_mfma_f32_32x32x16_bf16 v[96:111], a[124:127], v[152:155], v[96:111]
  ds_read_b64_tr_b16 v[136:137], v164 offset:28672
  ds_read_b64_tr_b16 v[138:139], v164 offset:30464
  v_mfma_f32_32x32x16_bf16 v[112:127], a[124:127], v[156:159], v[112:127]
  ds_read_b64_tr_b16 v[140:141], v165 offset:28672
  ds_read_b64_tr_b16 v[142:143], v165 offset:30464
  s_waitcnt lgkmcnt(4)
  v_mfma_f32_32x32x16_bf16 v[64:79], v[128:131], a[128:131], v[64:79]
  ds_read_b64_tr_b16 v[144:145], v163 offset:35840
  ds_read_b64_tr_b16 v[146:147], v163 offset:37632
  v_mfma_f32_32x32x16_bf16 v[80:95], v[132:135], a[128:131], v[80:95]
  ds_read_b64_tr_b16 v[148:149], v163 offset:35880
  ds_read_b64_tr_b16 v[150:151], v163 offset:37672
  s_waitcnt lgkmcnt(4)
  v_mfma_f32_32x32x16_bf16 v[96:111], a[128:131], v[136:139], v[96:111]
  ds_read_b64_tr_b16 v[152:153], v164 offset:35840
  ds_read_b64_tr_b16 v[154:155], v164 offset:37632
  v_mfma_f32_32x32x16_bf16 v[112:127], a[128:131], v[140:143], v[112:127]
  ds_read_b64_tr_b16 v[156:157], v165 offset:35840
  ds_read_b64_tr_b16 v[158:159], v165 offset:37632
  s_waitcnt lgkmcnt(4)
  v_mfma_f32_32x32x16_bf16 v[64:79], v[144:147], a[132:135], v[64:79]
  ds_read_b64_tr_b16 v[128:129], v163 offset:43008
  ds_read_b64_tr_b16 v[130:131], v163 offset:44800
  v_mfma_f32_32x32x16_bf16 v[80:95], v[148:151], a[132:135], v[80:95]
  ds_read_b64_tr_b16 v[132:133], v163 offset:43048
  ds_read_b64_tr_b16 v[134:135], v163 offset:44840
  s_waitcnt lgkmcnt(4)
  v_mfma_f32_32x32x16_bf16 v[96:111], a[132:135], v[152:155], v[96:111]
  ds_read_b64_tr_b16 v[136:137], v164 offset:43008
  ds_read_b64_tr_b16 v[138:139], v164 offset:44800
  v_mfma_f32_32x32x16_bf16 v[112:127], a[132:135], v[156:159], v[112:127]
  ds_read_b64_tr_b16 v[140:141], v165 offset:43008
  ds_read_b64_tr_b16 v[142:143], v165 offset:44800
  s_waitcnt lgkmcnt(4)
  v_mfma_f32_32x32x16_bf16 v[64:79], v[128:131], a[136:139], v[64:79]
  ds_read_b64_tr_b16 v[144:145], v163 offset:50176
  ds_read_b64_tr_b16 v[146:147], v163 offset:51968
  v_mfma_f32_32x32x16_bf16 v[80:95], v[132:135], a[136:139], v[80:95]
  ds_read_b64_tr_b16 v[148:149], v163 offset:50216
  ds_read_b64_tr_b16 v[150:151], v163 offset:52008
  s_waitcnt lgkmcnt(4)
  v_mfma_f32_32x32x16_bf16 v[96:111], a[136:139], v[136:139], v[96:111]
  ds_read_b64_tr_b16 v[152:153], v164 offset:50176
  ds_read_b64_tr_b16 v[154:155], v164 offset:51968
  v_mfma_f32_32x32x16_bf16 v[112:127], a[136:139], v[140:143], v[112:127]
  ds_read_b64_tr_b16 v[156:157], v165 offset:50176
  ds_read_b64_tr_b16 v[158:159], v165 offset:51968
  s_waitcnt lgkmcnt(4)
  v_mfma_f32_32x32x16_bf16 v[64:79], v[144:147], a[140:143], v[64:79]
  v_mfma_f32_32x32x16_bf16 v[80:95], v[148:151], a[140:143], v[80:95]
  s_waitcnt lgkmcnt(0)
  v_mfma_f32_32x32x16_bf16 v[96:111], a[140:143], v[152:155], v[96:111]
  v_mfma_f32_32x32x16_bf16 v[112:127], a[140:143], v[156:159], v[112:127]
  s_branch Llayer
Lfin:
Lend:
  s_endpgm
.section .rodata,"a"
.p2align 6
.amdhsa_kernel interleave_layers__sliding_block__mixer_channel_mlp__prompt_kernel
  .amdhsa_next_free_vgpr 512
  .amdhsa_next_free_sgpr 102
  .amdhsa_accum_offset 256
  .amdhsa_group_segment_fixed_size 0
  .amdhsa_kernarg_size 88
  .amdhsa_user_sgpr_count 2
  .amdhsa_user_sgpr_kernarg_segment_ptr 1
  .amdhsa_system_sgpr_workgroup_id_x 1
.end_amdhsa_kernel
```
